```python
import torch

def _softmax(x, axis=-1):
    return torch.softmax(x, dim=axis)

def _gelu(x):
    return torch.nn.functional.gelu(x, approximate='tanh')

def _silu(x):
    return torch.nn.functional.silu(x)

def _sigmoid(x):
    return torch.sigmoid(x)

def _layernorm(x, axis=-1, eps=1e-05):
    m = x.mean(dim=axis, keepdim=True)
    v = x.var(dim=axis, keepdim=True, unbiased=False)
    return (x - m) / torch.sqrt(v + eps)

def _scatter_add(tgt, idx, src, axis=0):
    return tgt.clone().index_add_(axis, idx, src)

def _segment_sum(src, seg, n):
    out = torch.zeros((n,) + src.shape[1:], dtype=src.dtype)
    return out.index_add_(0, seg, src)

def _pad(x, pw):
    flat = tuple((v for pair in reversed(pw) for v in pair))
    return torch.nn.functional.pad(x, flat)
kernel_name = 'recurrent_scan__memory_aug_recurrent_mem_tr__mixer_channel_mlp__prompt'

def setup_inputs():

    _w = lambda a: (lambda t: t.to(torch.bfloat16) if t.is_floating_point() else t)(torch.as_tensor(a))

    def _A_setup():
        B, S, Dm = (1, 2048, 640)
        H, Dh = (32, 192)
        M, seg = (8, 32)
        seg = min(seg, S)
        S = S // seg * seg
        return {'x': _w((lambda *s: torch.randn(*s, dtype=torch.bfloat16) * 0.05)(B, S, Dm)), 'mem0': _w((lambda *s: torch.randn(*s, dtype=torch.bfloat16) * 0.8)(B, M, Dm)), 'Wq': _w((lambda *s: torch.randn(*s, dtype=torch.bfloat16) * 0.8)(Dm, H, Dh) * Dm ** (-0.5)), 'Wk': _w((lambda *s: torch.randn(*s, dtype=torch.bfloat16) * 0.8)(Dm, H, Dh) * Dm ** (-0.5)), 'Wv': _w((lambda *s: torch.randn(*s, dtype=torch.bfloat16) * 0.8)(Dm, H, Dh) * Dm ** (-0.5)), 'Wo': _w((lambda *s: torch.randn(*s, dtype=torch.bfloat16) * 0.8)(H, Dh, Dm) * (H * Dh) ** (-0.5)), 'seg_len': seg}
    _A_in = _A_setup()

    def _B_setup():
        B, S, D, F = (1, 2048, 640, 1536)
        return {'x': _w((lambda *s: torch.randn(*s, dtype=torch.bfloat16) * 0.05)(B, S, D)), 'w1': _w((lambda *s: torch.randn(*s, dtype=torch.bfloat16) * 1.6)(D, F) * D ** (-0.5)), 'b1': _w((lambda *s: torch.randn(*s, dtype=torch.bfloat16) * 0.4)(F)), 'w2': _w((lambda *s: torch.randn(*s, dtype=torch.bfloat16) * 0.2)(F, D) * F ** (-0.5)), 'b2': _w((lambda *s: torch.randn(*s, dtype=torch.bfloat16) * 0.2)(D))}
    _B_in = _B_setup()
    return {'A_x': _A_in['x'], 'A_mem0': _A_in['mem0'], 'A_Wq': _A_in['Wq'], 'A_Wk': _A_in['Wk'], 'A_Wv': _A_in['Wv'], 'A_Wo': _A_in['Wo'], 'A_seg_len': _A_in['seg_len'], 'B_x': _B_in['x'], 'B_w1': _B_in['w1'], 'B_b1': _B_in['b1'], 'B_w2': _B_in['w2'], 'B_b2': _B_in['b2']}

def reference(A_x, A_mem0, A_Wq, A_Wk, A_Wv, A_Wo, A_seg_len, B_x, B_w1, B_b1, B_w2, B_b2):

    def _A_ref(x, mem0, Wq, Wk, Wv, Wo, seg_len):
        B, S, Dm = x.shape
        H, Dh = (Wq.shape[1], Wq.shape[2])
        M = mem0.shape[1]
        scale = Dh ** (-0.5)
        n_seg = S // seg_len
        L = M + seg_len
        idx = torch.arange(L)
        mask = (idx[:, None] < M) | (idx[:, None] >= idx[None, :])
        mem = mem0
        outs = []
        for s in range(n_seg):
            xs = x[:, s * seg_len:(s + 1) * seg_len, :].clone()
            h = torch.concatenate([mem, xs], axis=1)
            q = torch.einsum('btd,dhe->bhte', h, Wq)
            k = torch.einsum('btd,dhe->bhte', h, Wk)
            v = torch.einsum('btd,dhe->bhte', h, Wv)
            scores = torch.einsum('bhqe,bhke->bhqk', q, k) * scale
            scores = torch.where(mask[None, None], scores, -1000000000.0)
            p = _softmax(scores, axis=-1)
            o = torch.einsum('bhqk,bhke->bhqe', p, v)
            o = torch.einsum('bhte,hed->btd', o, Wo)
            mem = o[:, :M, :].clone()
            outs.append(o[:, M:, :])
        return torch.concatenate(outs, axis=1)

    def _B_ref(x, w1, b1, w2, b2):
        y = _layernorm(x, axis=-1)
        h = _gelu(torch.einsum('bsd,df->bsf', y, w1) + b1)
        return torch.einsum('bsf,fd->bsd', h, w2) + b2
    x = A_x
    xn = _layernorm(x, axis=-1)
    s = _A_ref(xn, A_mem0, A_Wq, A_Wk, A_Wv, A_Wo, A_seg_len)
    g = _silu(_B_ref(xn, B_w1, B_b1, B_w2, B_b2))
    return x + s * g
```

```asm
; @launch kernel=main_kernel grid=(256,1,1) block=(512,1,1) lds=163840
.amdgcn_target "amdgcn-amd-amdhsa--gfx950"
.text
.globl main_kernel
.p2align 8
.type main_kernel,@function
main_kernel:

    s_cmp_ge_u32 s2, 256
    s_cbranch_scc1 MAIN_end
    s_load_dwordx2 s[4:5], s[0:1], 112
    s_load_dwordx2 s[68:69], s[0:1], 104
    s_mov_b32 s70, 256
    s_mov_b32 s71, 0x00020000
    s_getreg_b32 s18, hwreg(HW_REG_XCC_ID)
    s_and_b32 s18, s18, 7
    v_lshrrev_b32 v1, 6, v0
    v_and_b32 v255, 63, v0
    s_nop 0
    v_readfirstlane_b32 s17, v1
    s_waitcnt lgkmcnt(0)
    s_mov_b32 s12, s4
    s_mov_b32 s13, s5
    s_mov_b32 s14, 268435456
    s_mov_b32 s15, 0x00020000
    s_lshl_b32 s16, s18, 5
    v_mov_b32 v3, 1
    v_mov_b32 v4, s16
    v_mov_b32 v5, 0
    s_cmp_lg_u32 s17, 0
    s_cbranch_scc1 MAIN_tk1
    s_mov_b64 exec, 1
    buffer_atomic_add v3, v4, s[68:71], 0 offen sc0
    s_waitcnt vmcnt(0)
    ds_write_b32 v5, v3
    s_waitcnt lgkmcnt(0)
    s_mov_b64 exec, -1
MAIN_tk1:
    s_barrier
    ds_read_b32 v3, v5
    s_waitcnt lgkmcnt(0)
    v_readfirstlane_b32 s16, v3
    s_barrier
    s_mov_b32 s96, 0
    s_mov_b32 s88, 0
    s_mov_b32 s75, 0
    s_mov_b32 s92, s16
    s_cmp_lt_u32 s16, 32
    s_cbranch_scc1 MAIN_role
    v_and_b32 v9, 7, v255
    v_lshlrev_b32 v9, 5, v9
    s_mov_b32 s73, 3000000
CEN_1:
    buffer_load_dword v8, v9, s[68:71], 0 offen sc1
    s_mov_b32 s39, 1
    s_sub_u32 s73, s73, 1
    s_cbranch_scc1 CEN_1_ok
    s_waitcnt vmcnt(0)
    v_cmp_ne_u32 vcc, 32, v8
    s_cbranch_vccz CEN_1_ok
    s_mov_b32 s72, 0
    v_readlane_b32 s75, v8, 0
    s_add_u32 s72, s72, s75
    s_cmp_lt_u32 s75, 32
    s_cselect_b32 s39, 0, s39
    v_readlane_b32 s75, v8, 1
    s_add_u32 s72, s72, s75
    s_cmp_lt_u32 s75, 32
    s_cselect_b32 s39, 0, s39
    v_readlane_b32 s75, v8, 2
    s_add_u32 s72, s72, s75
    s_cmp_lt_u32 s75, 32
    s_cselect_b32 s39, 0, s39
    v_readlane_b32 s75, v8, 3
    s_add_u32 s72, s72, s75
    s_cmp_lt_u32 s75, 32
    s_cselect_b32 s39, 0, s39
    v_readlane_b32 s75, v8, 4
    s_add_u32 s72, s72, s75
    v_readlane_b32 s75, v8, 5
    s_add_u32 s72, s72, s75
    v_readlane_b32 s75, v8, 6
    s_add_u32 s72, s72, s75
    v_readlane_b32 s75, v8, 7
    s_add_u32 s72, s72, s75
    s_cmp_ge_u32 s72, 256
    s_cbranch_scc1 CEN_1_ok
    s_sleep 4
    s_branch CEN_1
CEN_1_ok:
    s_waitcnt vmcnt(0)
    s_mov_b32 s16, 16
    v_mov_b32 v3, 1
    v_mov_b32 v4, s16
    v_mov_b32 v5, 0
    s_cmp_lg_u32 s17, 0
    s_cbranch_scc1 MAIN_tk3
    s_mov_b64 exec, 1
    buffer_atomic_add v3, v4, s[68:71], 0 offen sc0
    s_waitcnt vmcnt(0)
    ds_write_b32 v5, v3
    s_waitcnt lgkmcnt(0)
    s_mov_b64 exec, -1
MAIN_tk3:
    s_barrier
    ds_read_b32 v3, v5
    s_waitcnt lgkmcnt(0)
    v_readfirstlane_b32 s16, v3
    s_barrier
    v_readlane_b32 s40, v8, 0
    s_min_u32 s40, s40, 32
    s_sub_u32 s41, 32, s40
    s_mov_b32 s18, 0
    s_cmp_lt_u32 s16, s41
    s_cbranch_scc1 MAIN_ovf
    s_sub_u32 s16, s16, s41
    v_readlane_b32 s40, v8, 1
    s_min_u32 s40, s40, 32
    s_sub_u32 s41, 32, s40
    s_mov_b32 s18, 1
    s_cmp_lt_u32 s16, s41
    s_cbranch_scc1 MAIN_ovf
    s_sub_u32 s16, s16, s41
    v_readlane_b32 s40, v8, 2
    s_min_u32 s40, s40, 32
    s_sub_u32 s41, 32, s40
    s_mov_b32 s18, 2
    s_cmp_lt_u32 s16, s41
    s_cbranch_scc1 MAIN_ovf
    s_sub_u32 s16, s16, s41
    v_readlane_b32 s40, v8, 3
    s_min_u32 s40, s40, 32
    s_sub_u32 s41, 32, s40
    s_mov_b32 s18, 3
    s_cmp_lt_u32 s16, s41
    s_cbranch_scc1 MAIN_ovf
    s_sub_u32 s16, s16, s41
    v_readlane_b32 s40, v8, 4
    s_min_u32 s40, s40, 32
    s_sub_u32 s41, 32, s40
    s_mov_b32 s18, 4
    s_cmp_lt_u32 s16, s41
    s_cbranch_scc1 MAIN_ovf
    s_sub_u32 s16, s16, s41
    v_readlane_b32 s40, v8, 5
    s_min_u32 s40, s40, 32
    s_sub_u32 s41, 32, s40
    s_mov_b32 s18, 5
    s_cmp_lt_u32 s16, s41
    s_cbranch_scc1 MAIN_ovf
    s_sub_u32 s16, s16, s41
    v_readlane_b32 s40, v8, 6
    s_min_u32 s40, s40, 32
    s_sub_u32 s41, 32, s40
    s_mov_b32 s18, 6
    s_cmp_lt_u32 s16, s41
    s_cbranch_scc1 MAIN_ovf
    s_sub_u32 s16, s16, s41
    v_readlane_b32 s40, v8, 7
    s_min_u32 s40, s40, 32
    s_sub_u32 s41, 32, s40
    s_mov_b32 s18, 7
    s_cmp_lt_u32 s16, s41
    s_cbranch_scc1 MAIN_ovf
    s_sub_u32 s16, s16, s41
    s_branch MAIN_wpost
MAIN_ovf:
    s_add_u32 s16, s16, s40
MAIN_role:
    s_mov_b32 s92, s16
    s_mov_b32 s74, 64
    s_cmp_ge_u32 s18, 4
    s_cbranch_scc1 MAIN_gi0
    s_cmp_lt_u32 s16, 24
    s_cbranch_scc1 MAIN_rec
    s_cmp_lt_u32 s16, 28
    s_cbranch_scc1 MAIN_ini
    s_lshl_b32 s74, s18, 2
    s_add_u32 s74, s74, s16
    s_add_u32 s74, s74, 20
    s_branch MAIN_ini
MAIN_gi0:
    s_lshl_b32 s16, s16, 2
    s_add_u32 s16, s16, s18
    s_sub_u32 s16, s16, 4
    s_cmp_lt_u32 s16, 24
    s_cselect_b32 s74, s16, s74
    s_sub_u32 s40, s16, 72
    s_cmp_lt_u32 s40, 12
    s_cbranch_scc0 MAIN_gi1
    s_add_u32 s74, s40, 24
MAIN_gi1:
    s_cmp_lt_u32 s16, 116
    s_cbranch_scc1 MAIN_ini
    s_sub_u32 s74, s16, 80
MAIN_ini:
    s_cmp_ge_u32 s74, 64
    s_cbranch_scc1 MAIN_inid
    s_sub_u32 s24, 0, s4
    s_and_b32 s24, s24, 0x1fffff
    s_lshl_b32 s3, s74, 9
    v_add_u32 v1, s3, v0
    v_lshlrev_b32 v2, 4, v1
    v_mov_b32 v8, -1
    v_mov_b32 v9, -1
    v_mov_b32 v10, -1
    v_mov_b32 v11, -1
    v_mov_b32 v12, 0
    v_mov_b32 v13, 0
    v_mov_b32 v14, 0
    v_mov_b32 v15, 0
    s_mov_b32 s25, 3604480
    v_cmp_gt_u32 vcc, 3072, v1
    s_and_saveexec_b64 s[26:27], vcc
    s_cbranch_execz INI_sk_2
    buffer_store_dwordx4 v[12:15], v2, s[12:15], s25 offen sc1
INI_sk_2:
    s_mov_b64 exec, s[26:27]
    s_load_dwordx2 s[8:9], s[0:1], 0
    s_mov_b32 s10, 2621440
    s_mov_b32 s11, 0x00020000
    s_mov_b32 s20, 0x3acccccd
    s_mov_b32 s21, 0x3727c5ac
    v_lshrrev_b32 v1, 4, v0
    v_and_b32 v2, 15, v0
    s_lshl_b32 s3, s74, 5
    v_add_u32 v1, s3, v1
    v_mul_u32_u24 v3, 1280, v1
    v_lshl_add_u32 v3, v2, 4, v3
    s_waitcnt lgkmcnt(0)
    buffer_load_dwordx4 v[12:15], v3, s[8:11], 0 offen offset:0
    buffer_load_dwordx4 v[16:19], v3, s[8:11], 0 offen offset:256
    buffer_load_dwordx4 v[20:23], v3, s[8:11], 0 offen offset:512
    buffer_load_dwordx4 v[24:27], v3, s[8:11], 0 offen offset:768
    buffer_load_dwordx4 v[28:31], v3, s[8:11], 0 offen offset:1024
    v_and_b32 v5, 31, v1
    v_lshlrev_b32 v4, 4, v5
    v_lshlrev_b32 v6, 4, v0
    s_mul_i32 s3, s74, 40960
    v_lshrrev_b32 v5, 1, v2
    v_lshl_add_u32 v4, v5, 10, v4
    v_and_b32 v5, 1, v2
    v_lshl_add_u32 v4, v5, 9, v4
    s_add_u32 s22, s3, 4194304
    s_mov_b32 s23, 0
    s_waitcnt vmcnt(0)
    v_lshlrev_b32 v32, 16, v12
    v_and_b32 v33, 0xffff0000, v12
    v_lshlrev_b32 v34, 16, v13
    v_and_b32 v35, 0xffff0000, v13
    v_lshlrev_b32 v36, 16, v14
    v_and_b32 v37, 0xffff0000, v14
    v_lshlrev_b32 v38, 16, v15
    v_and_b32 v39, 0xffff0000, v15
    v_lshlrev_b32 v40, 16, v16
    v_and_b32 v41, 0xffff0000, v16
    v_lshlrev_b32 v42, 16, v17
    v_and_b32 v43, 0xffff0000, v17
    v_lshlrev_b32 v44, 16, v18
    v_and_b32 v45, 0xffff0000, v18
    v_lshlrev_b32 v46, 16, v19
    v_and_b32 v47, 0xffff0000, v19
    v_lshlrev_b32 v48, 16, v20
    v_and_b32 v49, 0xffff0000, v20
    v_lshlrev_b32 v50, 16, v21
    v_and_b32 v51, 0xffff0000, v21
    v_lshlrev_b32 v52, 16, v22
    v_and_b32 v53, 0xffff0000, v22
    v_lshlrev_b32 v54, 16, v23
    v_and_b32 v55, 0xffff0000, v23
    v_lshlrev_b32 v56, 16, v24
    v_and_b32 v57, 0xffff0000, v24
    v_lshlrev_b32 v58, 16, v25
    v_and_b32 v59, 0xffff0000, v25
    v_lshlrev_b32 v60, 16, v26
    v_and_b32 v61, 0xffff0000, v26
    v_lshlrev_b32 v62, 16, v27
    v_and_b32 v63, 0xffff0000, v27
    v_lshlrev_b32 v64, 16, v28
    v_and_b32 v65, 0xffff0000, v28
    v_lshlrev_b32 v66, 16, v29
    v_and_b32 v67, 0xffff0000, v29
    v_lshlrev_b32 v68, 16, v30
    v_and_b32 v69, 0xffff0000, v30
    v_lshlrev_b32 v70, 16, v31
    v_and_b32 v71, 0xffff0000, v31
INI_ln_3:
    v_add_f32 v92, v32, v33
    v_add_f32 v92, v92, v34
    v_add_f32 v92, v92, v35
    v_add_f32 v92, v92, v36
    v_add_f32 v92, v92, v37
    v_add_f32 v92, v92, v38
    v_add_f32 v92, v92, v39
    v_add_f32 v92, v92, v40
    v_add_f32 v92, v92, v41
    v_add_f32 v92, v92, v42
    v_add_f32 v92, v92, v43
    v_add_f32 v92, v92, v44
    v_add_f32 v92, v92, v45
    v_add_f32 v92, v92, v46
    v_add_f32 v92, v92, v47
    v_add_f32 v92, v92, v48
    v_add_f32 v92, v92, v49
    v_add_f32 v92, v92, v50
    v_add_f32 v92, v92, v51
    v_add_f32 v92, v92, v52
    v_add_f32 v92, v92, v53
    v_add_f32 v92, v92, v54
    v_add_f32 v92, v92, v55
    v_add_f32 v92, v92, v56
    v_add_f32 v92, v92, v57
    v_add_f32 v92, v92, v58
    v_add_f32 v92, v92, v59
    v_add_f32 v92, v92, v60
    v_add_f32 v92, v92, v61
    v_add_f32 v92, v92, v62
    v_add_f32 v92, v92, v63
    v_add_f32 v92, v92, v64
    v_add_f32 v92, v92, v65
    v_add_f32 v92, v92, v66
    v_add_f32 v92, v92, v67
    v_add_f32 v92, v92, v68
    v_add_f32 v92, v92, v69
    v_add_f32 v92, v92, v70
    v_add_f32 v92, v92, v71
    s_nop 1
    v_add_f32_dpp v93, v92, v92 row_ror:8 row_mask:0xf bank_mask:0xf
    v_mov_b32 v92, v93
    s_nop 1
    v_add_f32_dpp v93, v92, v92 row_ror:4 row_mask:0xf bank_mask:0xf
    v_mov_b32 v92, v93
    s_nop 1
    v_add_f32_dpp v93, v92, v92 row_ror:2 row_mask:0xf bank_mask:0xf
    v_mov_b32 v92, v93
    s_nop 1
    v_add_f32_dpp v93, v92, v92 row_ror:1 row_mask:0xf bank_mask:0xf
    v_mov_b32 v92, v93
    v_mul_f32 v94, s20, v92
    v_sub_f32 v93, v32, v94
    v_mul_f32 v92, v93, v93
    v_sub_f32 v93, v33, v94
    v_fmac_f32 v92, v93, v93
    v_sub_f32 v93, v34, v94
    v_fmac_f32 v92, v93, v93
    v_sub_f32 v93, v35, v94
    v_fmac_f32 v92, v93, v93
    v_sub_f32 v93, v36, v94
    v_fmac_f32 v92, v93, v93
    v_sub_f32 v93, v37, v94
    v_fmac_f32 v92, v93, v93
    v_sub_f32 v93, v38, v94
    v_fmac_f32 v92, v93, v93
    v_sub_f32 v93, v39, v94
    v_fmac_f32 v92, v93, v93
    v_sub_f32 v93, v40, v94
    v_fmac_f32 v92, v93, v93
    v_sub_f32 v93, v41, v94
    v_fmac_f32 v92, v93, v93
    v_sub_f32 v93, v42, v94
    v_fmac_f32 v92, v93, v93
    v_sub_f32 v93, v43, v94
    v_fmac_f32 v92, v93, v93
    v_sub_f32 v93, v44, v94
    v_fmac_f32 v92, v93, v93
    v_sub_f32 v93, v45, v94
    v_fmac_f32 v92, v93, v93
    v_sub_f32 v93, v46, v94
    v_fmac_f32 v92, v93, v93
    v_sub_f32 v93, v47, v94
    v_fmac_f32 v92, v93, v93
    v_sub_f32 v93, v48, v94
    v_fmac_f32 v92, v93, v93
    v_sub_f32 v93, v49, v94
    v_fmac_f32 v92, v93, v93
    v_sub_f32 v93, v50, v94
    v_fmac_f32 v92, v93, v93
    v_sub_f32 v93, v51, v94
    v_fmac_f32 v92, v93, v93
    v_sub_f32 v93, v52, v94
    v_fmac_f32 v92, v93, v93
    v_sub_f32 v93, v53, v94
    v_fmac_f32 v92, v93, v93
    v_sub_f32 v93, v54, v94
    v_fmac_f32 v92, v93, v93
    v_sub_f32 v93, v55, v94
    v_fmac_f32 v92, v93, v93
    v_sub_f32 v93, v56, v94
    v_fmac_f32 v92, v93, v93
    v_sub_f32 v93, v57, v94
    v_fmac_f32 v92, v93, v93
    v_sub_f32 v93, v58, v94
    v_fmac_f32 v92, v93, v93
    v_sub_f32 v93, v59, v94
    v_fmac_f32 v92, v93, v93
    v_sub_f32 v93, v60, v94
    v_fmac_f32 v92, v93, v93
    v_sub_f32 v93, v61, v94
    v_fmac_f32 v92, v93, v93
    v_sub_f32 v93, v62, v94
    v_fmac_f32 v92, v93, v93
    v_sub_f32 v93, v63, v94
    v_fmac_f32 v92, v93, v93
    v_sub_f32 v93, v64, v94
    v_fmac_f32 v92, v93, v93
    v_sub_f32 v93, v65, v94
    v_fmac_f32 v92, v93, v93
    v_sub_f32 v93, v66, v94
    v_fmac_f32 v92, v93, v93
    v_sub_f32 v93, v67, v94
    v_fmac_f32 v92, v93, v93
    v_sub_f32 v93, v68, v94
    v_fmac_f32 v92, v93, v93
    v_sub_f32 v93, v69, v94
    v_fmac_f32 v92, v93, v93
    v_sub_f32 v93, v70, v94
    v_fmac_f32 v92, v93, v93
    v_sub_f32 v93, v71, v94
    v_fmac_f32 v92, v93, v93
    s_nop 1
    v_add_f32_dpp v93, v92, v92 row_ror:8 row_mask:0xf bank_mask:0xf
    v_mov_b32 v92, v93
    s_nop 1
    v_add_f32_dpp v93, v92, v92 row_ror:4 row_mask:0xf bank_mask:0xf
    v_mov_b32 v92, v93
    s_nop 1
    v_add_f32_dpp v93, v92, v92 row_ror:2 row_mask:0xf bank_mask:0xf
    v_mov_b32 v92, v93
    s_nop 1
    v_add_f32_dpp v93, v92, v92 row_ror:1 row_mask:0xf bank_mask:0xf
    v_mov_b32 v92, v93
    v_mul_f32 v92, s20, v92
    v_cvt_pk_bf16_f32 v92, v92, v92
    v_lshlrev_b32 v92, 16, v92
    v_add_f32 v92, s21, v92
    v_cvt_pk_bf16_f32 v92, v92, v92
    v_lshlrev_b32 v92, 16, v92
    v_sqrt_f32 v92, v92
    s_nop 0
    v_cvt_pk_bf16_f32 v92, v92, v92
    v_lshlrev_b32 v92, 16, v92
    v_rcp_f32 v96, v92
    v_cvt_pk_bf16_f32 v95, v94, v94
    v_lshlrev_b32 v95, 16, v95
    v_sub_f32 v32, v32, v95
    v_sub_f32 v33, v33, v95
    v_cvt_pk_bf16_f32 v93, v32, v33
    v_lshlrev_b32 v32, 16, v93
    v_and_b32 v33, 0xffff0000, v93
    v_mul_f32 v93, v32, v96
    v_fma_f32 v32, -v93, v92, v32
    v_fma_f32 v32, v32, v96, v93
    v_mul_f32 v93, v33, v96
    v_fma_f32 v33, -v93, v92, v33
    v_fma_f32 v33, v33, v96, v93
    v_cvt_pk_bf16_f32 v12, v32, v33
    v_lshlrev_b32 v32, 16, v12
    v_and_b32 v33, 0xffff0000, v12
    v_sub_f32 v34, v34, v95
    v_sub_f32 v35, v35, v95
    v_cvt_pk_bf16_f32 v93, v34, v35
    v_lshlrev_b32 v34, 16, v93
    v_and_b32 v35, 0xffff0000, v93
    v_mul_f32 v93, v34, v96
    v_fma_f32 v34, -v93, v92, v34
    v_fma_f32 v34, v34, v96, v93
    v_mul_f32 v93, v35, v96
    v_fma_f32 v35, -v93, v92, v35
    v_fma_f32 v35, v35, v96, v93
    v_cvt_pk_bf16_f32 v13, v34, v35
    v_lshlrev_b32 v34, 16, v13
    v_and_b32 v35, 0xffff0000, v13
    v_sub_f32 v36, v36, v95
    v_sub_f32 v37, v37, v95
    v_cvt_pk_bf16_f32 v93, v36, v37
    v_lshlrev_b32 v36, 16, v93
    v_and_b32 v37, 0xffff0000, v93
    v_mul_f32 v93, v36, v96
    v_fma_f32 v36, -v93, v92, v36
    v_fma_f32 v36, v36, v96, v93
    v_mul_f32 v93, v37, v96
    v_fma_f32 v37, -v93, v92, v37
    v_fma_f32 v37, v37, v96, v93
    v_cvt_pk_bf16_f32 v14, v36, v37
    v_lshlrev_b32 v36, 16, v14
    v_and_b32 v37, 0xffff0000, v14
    v_sub_f32 v38, v38, v95
    v_sub_f32 v39, v39, v95
    v_cvt_pk_bf16_f32 v93, v38, v39
    v_lshlrev_b32 v38, 16, v93
    v_and_b32 v39, 0xffff0000, v93
    v_mul_f32 v93, v38, v96
    v_fma_f32 v38, -v93, v92, v38
    v_fma_f32 v38, v38, v96, v93
    v_mul_f32 v93, v39, v96
    v_fma_f32 v39, -v93, v92, v39
    v_fma_f32 v39, v39, v96, v93
    v_cvt_pk_bf16_f32 v15, v38, v39
    v_lshlrev_b32 v38, 16, v15
    v_and_b32 v39, 0xffff0000, v15
    v_sub_f32 v40, v40, v95
    v_sub_f32 v41, v41, v95
    v_cvt_pk_bf16_f32 v93, v40, v41
    v_lshlrev_b32 v40, 16, v93
    v_and_b32 v41, 0xffff0000, v93
    v_mul_f32 v93, v40, v96
    v_fma_f32 v40, -v93, v92, v40
    v_fma_f32 v40, v40, v96, v93
    v_mul_f32 v93, v41, v96
    v_fma_f32 v41, -v93, v92, v41
    v_fma_f32 v41, v41, v96, v93
    v_cvt_pk_bf16_f32 v16, v40, v41
    v_lshlrev_b32 v40, 16, v16
    v_and_b32 v41, 0xffff0000, v16
    v_sub_f32 v42, v42, v95
    v_sub_f32 v43, v43, v95
    v_cvt_pk_bf16_f32 v93, v42, v43
    v_lshlrev_b32 v42, 16, v93
    v_and_b32 v43, 0xffff0000, v93
    v_mul_f32 v93, v42, v96
    v_fma_f32 v42, -v93, v92, v42
    v_fma_f32 v42, v42, v96, v93
    v_mul_f32 v93, v43, v96
    v_fma_f32 v43, -v93, v92, v43
    v_fma_f32 v43, v43, v96, v93
    v_cvt_pk_bf16_f32 v17, v42, v43
    v_lshlrev_b32 v42, 16, v17
    v_and_b32 v43, 0xffff0000, v17
    v_sub_f32 v44, v44, v95
    v_sub_f32 v45, v45, v95
    v_cvt_pk_bf16_f32 v93, v44, v45
    v_lshlrev_b32 v44, 16, v93
    v_and_b32 v45, 0xffff0000, v93
    v_mul_f32 v93, v44, v96
    v_fma_f32 v44, -v93, v92, v44
    v_fma_f32 v44, v44, v96, v93
    v_mul_f32 v93, v45, v96
    v_fma_f32 v45, -v93, v92, v45
    v_fma_f32 v45, v45, v96, v93
    v_cvt_pk_bf16_f32 v18, v44, v45
    v_lshlrev_b32 v44, 16, v18
    v_and_b32 v45, 0xffff0000, v18
    v_sub_f32 v46, v46, v95
    v_sub_f32 v47, v47, v95
    v_cvt_pk_bf16_f32 v93, v46, v47
    v_lshlrev_b32 v46, 16, v93
    v_and_b32 v47, 0xffff0000, v93
    v_mul_f32 v93, v46, v96
    v_fma_f32 v46, -v93, v92, v46
    v_fma_f32 v46, v46, v96, v93
    v_mul_f32 v93, v47, v96
    v_fma_f32 v47, -v93, v92, v47
    v_fma_f32 v47, v47, v96, v93
    v_cvt_pk_bf16_f32 v19, v46, v47
    v_lshlrev_b32 v46, 16, v19
    v_and_b32 v47, 0xffff0000, v19
    v_sub_f32 v48, v48, v95
    v_sub_f32 v49, v49, v95
    v_cvt_pk_bf16_f32 v93, v48, v49
    v_lshlrev_b32 v48, 16, v93
    v_and_b32 v49, 0xffff0000, v93
    v_mul_f32 v93, v48, v96
    v_fma_f32 v48, -v93, v92, v48
    v_fma_f32 v48, v48, v96, v93
    v_mul_f32 v93, v49, v96
    v_fma_f32 v49, -v93, v92, v49
    v_fma_f32 v49, v49, v96, v93
    v_cvt_pk_bf16_f32 v20, v48, v49
    v_lshlrev_b32 v48, 16, v20
    v_and_b32 v49, 0xffff0000, v20
    v_sub_f32 v50, v50, v95
    v_sub_f32 v51, v51, v95
    v_cvt_pk_bf16_f32 v93, v50, v51
    v_lshlrev_b32 v50, 16, v93
    v_and_b32 v51, 0xffff0000, v93
    v_mul_f32 v93, v50, v96
    v_fma_f32 v50, -v93, v92, v50
    v_fma_f32 v50, v50, v96, v93
    v_mul_f32 v93, v51, v96
    v_fma_f32 v51, -v93, v92, v51
    v_fma_f32 v51, v51, v96, v93
    v_cvt_pk_bf16_f32 v21, v50, v51
    v_lshlrev_b32 v50, 16, v21
    v_and_b32 v51, 0xffff0000, v21
    v_sub_f32 v52, v52, v95
    v_sub_f32 v53, v53, v95
    v_cvt_pk_bf16_f32 v93, v52, v53
    v_lshlrev_b32 v52, 16, v93
    v_and_b32 v53, 0xffff0000, v93
    v_mul_f32 v93, v52, v96
    v_fma_f32 v52, -v93, v92, v52
    v_fma_f32 v52, v52, v96, v93
    v_mul_f32 v93, v53, v96
    v_fma_f32 v53, -v93, v92, v53
    v_fma_f32 v53, v53, v96, v93
    v_cvt_pk_bf16_f32 v22, v52, v53
    v_lshlrev_b32 v52, 16, v22
    v_and_b32 v53, 0xffff0000, v22
    v_sub_f32 v54, v54, v95
    v_sub_f32 v55, v55, v95
    v_cvt_pk_bf16_f32 v93, v54, v55
    v_lshlrev_b32 v54, 16, v93
    v_and_b32 v55, 0xffff0000, v93
    v_mul_f32 v93, v54, v96
    v_fma_f32 v54, -v93, v92, v54
    v_fma_f32 v54, v54, v96, v93
    v_mul_f32 v93, v55, v96
    v_fma_f32 v55, -v93, v92, v55
    v_fma_f32 v55, v55, v96, v93
    v_cvt_pk_bf16_f32 v23, v54, v55
    v_lshlrev_b32 v54, 16, v23
    v_and_b32 v55, 0xffff0000, v23
    v_sub_f32 v56, v56, v95
    v_sub_f32 v57, v57, v95
    v_cvt_pk_bf16_f32 v93, v56, v57
    v_lshlrev_b32 v56, 16, v93
    v_and_b32 v57, 0xffff0000, v93
    v_mul_f32 v93, v56, v96
    v_fma_f32 v56, -v93, v92, v56
    v_fma_f32 v56, v56, v96, v93
    v_mul_f32 v93, v57, v96
    v_fma_f32 v57, -v93, v92, v57
    v_fma_f32 v57, v57, v96, v93
    v_cvt_pk_bf16_f32 v24, v56, v57
    v_lshlrev_b32 v56, 16, v24
    v_and_b32 v57, 0xffff0000, v24
    v_sub_f32 v58, v58, v95
    v_sub_f32 v59, v59, v95
    v_cvt_pk_bf16_f32 v93, v58, v59
    v_lshlrev_b32 v58, 16, v93
    v_and_b32 v59, 0xffff0000, v93
    v_mul_f32 v93, v58, v96
    v_fma_f32 v58, -v93, v92, v58
    v_fma_f32 v58, v58, v96, v93
    v_mul_f32 v93, v59, v96
    v_fma_f32 v59, -v93, v92, v59
    v_fma_f32 v59, v59, v96, v93
    v_cvt_pk_bf16_f32 v25, v58, v59
    v_lshlrev_b32 v58, 16, v25
    v_and_b32 v59, 0xffff0000, v25
    v_sub_f32 v60, v60, v95
    v_sub_f32 v61, v61, v95
    v_cvt_pk_bf16_f32 v93, v60, v61
    v_lshlrev_b32 v60, 16, v93
    v_and_b32 v61, 0xffff0000, v93
    v_mul_f32 v93, v60, v96
    v_fma_f32 v60, -v93, v92, v60
    v_fma_f32 v60, v60, v96, v93
    v_mul_f32 v93, v61, v96
    v_fma_f32 v61, -v93, v92, v61
    v_fma_f32 v61, v61, v96, v93
    v_cvt_pk_bf16_f32 v26, v60, v61
    v_lshlrev_b32 v60, 16, v26
    v_and_b32 v61, 0xffff0000, v26
    v_sub_f32 v62, v62, v95
    v_sub_f32 v63, v63, v95
    v_cvt_pk_bf16_f32 v93, v62, v63
    v_lshlrev_b32 v62, 16, v93
    v_and_b32 v63, 0xffff0000, v93
    v_mul_f32 v93, v62, v96
    v_fma_f32 v62, -v93, v92, v62
    v_fma_f32 v62, v62, v96, v93
    v_mul_f32 v93, v63, v96
    v_fma_f32 v63, -v93, v92, v63
    v_fma_f32 v63, v63, v96, v93
    v_cvt_pk_bf16_f32 v27, v62, v63
    v_lshlrev_b32 v62, 16, v27
    v_and_b32 v63, 0xffff0000, v27
    v_sub_f32 v64, v64, v95
    v_sub_f32 v65, v65, v95
    v_cvt_pk_bf16_f32 v93, v64, v65
    v_lshlrev_b32 v64, 16, v93
    v_and_b32 v65, 0xffff0000, v93
    v_mul_f32 v93, v64, v96
    v_fma_f32 v64, -v93, v92, v64
    v_fma_f32 v64, v64, v96, v93
    v_mul_f32 v93, v65, v96
    v_fma_f32 v65, -v93, v92, v65
    v_fma_f32 v65, v65, v96, v93
    v_cvt_pk_bf16_f32 v28, v64, v65
    v_lshlrev_b32 v64, 16, v28
    v_and_b32 v65, 0xffff0000, v28
    v_sub_f32 v66, v66, v95
    v_sub_f32 v67, v67, v95
    v_cvt_pk_bf16_f32 v93, v66, v67
    v_lshlrev_b32 v66, 16, v93
    v_and_b32 v67, 0xffff0000, v93
    v_mul_f32 v93, v66, v96
    v_fma_f32 v66, -v93, v92, v66
    v_fma_f32 v66, v66, v96, v93
    v_mul_f32 v93, v67, v96
    v_fma_f32 v67, -v93, v92, v67
    v_fma_f32 v67, v67, v96, v93
    v_cvt_pk_bf16_f32 v29, v66, v67
    v_lshlrev_b32 v66, 16, v29
    v_and_b32 v67, 0xffff0000, v29
    v_sub_f32 v68, v68, v95
    v_sub_f32 v69, v69, v95
    v_cvt_pk_bf16_f32 v93, v68, v69
    v_lshlrev_b32 v68, 16, v93
    v_and_b32 v69, 0xffff0000, v93
    v_mul_f32 v93, v68, v96
    v_fma_f32 v68, -v93, v92, v68
    v_fma_f32 v68, v68, v96, v93
    v_mul_f32 v93, v69, v96
    v_fma_f32 v69, -v93, v92, v69
    v_fma_f32 v69, v69, v96, v93
    v_cvt_pk_bf16_f32 v30, v68, v69
    v_lshlrev_b32 v68, 16, v30
    v_and_b32 v69, 0xffff0000, v30
    v_sub_f32 v70, v70, v95
    v_sub_f32 v71, v71, v95
    v_cvt_pk_bf16_f32 v93, v70, v71
    v_lshlrev_b32 v70, 16, v93
    v_and_b32 v71, 0xffff0000, v93
    v_mul_f32 v93, v70, v96
    v_fma_f32 v70, -v93, v92, v70
    v_fma_f32 v70, v70, v96, v93
    v_mul_f32 v93, v71, v96
    v_fma_f32 v71, -v93, v92, v71
    v_fma_f32 v71, v71, v96, v93
    v_cvt_pk_bf16_f32 v31, v70, v71
    v_lshlrev_b32 v70, 16, v31
    v_and_b32 v71, 0xffff0000, v31
    ds_write_b128 v4, v[12:15] offset:0
    ds_write_b128 v4, v[16:19] offset:8192
    ds_write_b128 v4, v[20:23] offset:16384
    ds_write_b128 v4, v[24:27] offset:24576
    ds_write_b128 v4, v[28:31] offset:32768
    s_waitcnt lgkmcnt(0)
    s_barrier
    ds_read_b128 v[100:103], v6 offset:0
    ds_read_b128 v[104:107], v6 offset:8192
    ds_read_b128 v[108:111], v6 offset:16384
    ds_read_b128 v[112:115], v6 offset:24576
    ds_read_b128 v[116:119], v6 offset:32768
    s_waitcnt lgkmcnt(4)
    s_add_u32 s25, s22, 0
    buffer_store_dwordx4 v[100:103], v6, s[12:15], s25 offen sc1
    s_waitcnt lgkmcnt(3)
    s_add_u32 s25, s22, 8192
    buffer_store_dwordx4 v[104:107], v6, s[12:15], s25 offen sc1
    s_waitcnt lgkmcnt(2)
    s_add_u32 s25, s22, 16384
    buffer_store_dwordx4 v[108:111], v6, s[12:15], s25 offen sc1
    s_waitcnt lgkmcnt(1)
    s_add_u32 s25, s22, 24576
    buffer_store_dwordx4 v[112:115], v6, s[12:15], s25 offen sc1
    s_waitcnt lgkmcnt(0)
    s_add_u32 s25, s22, 32768
    buffer_store_dwordx4 v[116:119], v6, s[12:15], s25 offen sc1
    s_cmp_lg_u32 s23, 0
    s_cbranch_scc1 INI_s_4
    s_waitcnt vmcnt(0)
INI_s_4:
    s_barrier
    s_cmp_lg_u32 s23, 0
    s_cbranch_scc1 INI_s_4_b
    s_cmp_lg_u32 s17, 0
    s_cbranch_scc1 INI_s_4_b
    v_mov_b32 v7, 1
    v_mov_b32 v8, 8
    s_mov_b64 exec, 1
    buffer_atomic_add v7, v8, s[68:71], 0 offen
    s_mov_b64 exec, -1
INI_s_4_b:
    s_add_u32 s22, s3, 6815744
    s_add_u32 s23, s23, 1
    s_cmp_lt_u32 s23, 2
    s_cbranch_scc1 INI_ln_3
    s_sub_u32 s24, 0, s4
    s_and_b32 s24, s24, 0x1fffff
    s_lshl_b32 s3, s74, 9
    v_add_u32 v1, s3, v0
    v_lshlrev_b32 v2, 4, v1
    v_mov_b32 v8, -1
    v_mov_b32 v9, -1
    v_mov_b32 v10, -1
    v_mov_b32 v11, -1
    v_mov_b32 v12, 0
    v_mov_b32 v13, 0
    v_mov_b32 v14, 0
    v_mov_b32 v15, 0
    s_add_u32 s25, s24, 0
    buffer_store_dwordx4 v[8:11], v2, s[12:15], s25 offen sc1
    s_add_u32 s25, s24, 524288
    v_cmp_gt_u32 vcc, 8192, v1
    s_and_saveexec_b64 s[26:27], vcc
    s_cbranch_execz INI_sk_5
    buffer_store_dwordx4 v[8:11], v2, s[12:15], s25 offen sc1
INI_sk_5:
    s_mov_b64 exec, s[26:27]
    s_mov_b32 s25, 3145728
    v_cmp_gt_u32 vcc, 16384, v1
    s_and_saveexec_b64 s[26:27], vcc
    s_cbranch_execz INI_sk_6
    buffer_store_dwordx4 v[8:11], v2, s[12:15], s25 offen sc1
INI_sk_6:
    s_mov_b64 exec, s[26:27]
    s_mov_b32 s25, 3448832
    v_cmp_gt_u32 vcc, 7680, v1
    s_and_saveexec_b64 s[26:27], vcc
    s_cbranch_execz INI_sk_7
    buffer_store_dwordx4 v[8:11], v2, s[12:15], s25 offen sc1
INI_sk_7:
    s_mov_b64 exec, s[26:27]
    s_cmp_ge_u32 s74, 5
    s_cbranch_scc1 INI_nod0_8
    s_load_dwordx2 s[28:29], s[0:1], 8
    v_mul_u32_u24 v3, 52429, v1
    v_lshrrev_b32 v3, 25, v3
    v_mul_u32_u24 v3, 640, v3
    v_sub_u32 v3, v1, v3
    v_and_b32 v4, 7, v3
    v_mul_u32_u24 v4, 1280, v4
    v_lshrrev_b32 v5, 5, v3
    v_lshl_add_u32 v4, v5, 6, v4
    v_bfe_u32 v5, v3, 3, 2
    v_lshl_add_u32 v4, v5, 3, v4
    s_waitcnt lgkmcnt(0)
    s_mov_b32 s30, 10240
    s_mov_b32 s31, 0x00020000
    buffer_load_dwordx2 v[16:17], v4, s[28:31], 0 offen
    buffer_load_dwordx2 v[18:19], v4, s[28:31], 0 offen offset:32
    s_mov_b32 s25, 3407872
    s_mov_b32 s33, 0xfffffffe
    s_waitcnt vmcnt(0)
    v_min_u32 v16, s33, v16
    v_min_u32 v17, s33, v17
    v_min_u32 v18, s33, v18
    v_min_u32 v19, s33, v19
    buffer_store_dwordx4 v[16:19], v2, s[12:15], s25 offen sc1
INI_nod0_8:
    s_waitcnt vmcnt(0)
    s_barrier
    s_cmp_lg_u32 s17, 0
    s_cbranch_scc1 INI_d_9
    v_mov_b32 v3, 1
    v_mov_b32 v4, 4
    s_mov_b64 exec, 1
    buffer_atomic_add v3, v4, s[68:71], 0 offen
    s_mov_b64 exec, -1
INI_d_9:
MAIN_inid:
    s_cmp_ge_u32 s18, 4
    s_cbranch_scc1 MAIN_gemm
    s_sub_u32 s19, s16, 24
    s_lshl_b32 s19, s19, 3
    s_add_u32 s19, s19, s17
    s_mul_i32 s20, s19, 12288
    s_mul_i32 s40, s18, 3072
    s_add_u32 s20, s20, s40
    v_lshlrev_b32 v1, 4, v255
    s_mov_b32 s10, 7864320
    s_mov_b32 s11, 0x00020000
    s_cmp_ge_u32 s16, 28
    s_cbranch_scc1 WPF_qk_12
    s_load_dwordx2 s[8:9], s[0:1], 32
    s_mov_b32 s21, s20
    s_mov_b32 s22, 0
    s_waitcnt lgkmcnt(0)
WPF_sw_13:
    buffer_load_dwordx4 v[8:11], v1, s[8:11], s21 offen offset:0
    buffer_load_dwordx4 v[12:15], v1, s[8:11], s21 offen offset:1024
    buffer_load_dwordx4 v[16:19], v1, s[8:11], s21 offen offset:2048
    s_add_u32 s21, s21, 393216
    buffer_load_dwordx4 v[20:23], v1, s[8:11], s21 offen offset:0
    buffer_load_dwordx4 v[24:27], v1, s[8:11], s21 offen offset:1024
    buffer_load_dwordx4 v[28:31], v1, s[8:11], s21 offen offset:2048
    s_add_u32 s21, s21, 393216
    buffer_load_dwordx4 v[32:35], v1, s[8:11], s21 offen offset:0
    buffer_load_dwordx4 v[36:39], v1, s[8:11], s21 offen offset:1024
    buffer_load_dwordx4 v[40:43], v1, s[8:11], s21 offen offset:2048
    s_add_u32 s21, s21, 393216
    buffer_load_dwordx4 v[44:47], v1, s[8:11], s21 offen offset:0
    buffer_load_dwordx4 v[48:51], v1, s[8:11], s21 offen offset:1024
    buffer_load_dwordx4 v[52:55], v1, s[8:11], s21 offen offset:2048
    s_add_u32 s21, s21, 393216
    buffer_load_dwordx4 v[56:59], v1, s[8:11], s21 offen offset:0
    buffer_load_dwordx4 v[60:63], v1, s[8:11], s21 offen offset:1024
    buffer_load_dwordx4 v[64:67], v1, s[8:11], s21 offen offset:2048
    s_add_u32 s21, s21, 393216
    buffer_load_dwordx4 v[68:71], v1, s[8:11], s21 offen offset:0
    buffer_load_dwordx4 v[72:75], v1, s[8:11], s21 offen offset:1024
    buffer_load_dwordx4 v[76:79], v1, s[8:11], s21 offen offset:2048
    s_add_u32 s21, s21, 393216
    buffer_load_dwordx4 v[80:83], v1, s[8:11], s21 offen offset:0
    buffer_load_dwordx4 v[84:87], v1, s[8:11], s21 offen offset:1024
    buffer_load_dwordx4 v[88:91], v1, s[8:11], s21 offen offset:2048
    s_add_u32 s21, s21, 393216
    buffer_load_dwordx4 v[92:95], v1, s[8:11], s21 offen offset:0
    buffer_load_dwordx4 v[96:99], v1, s[8:11], s21 offen offset:1024
    buffer_load_dwordx4 v[100:103], v1, s[8:11], s21 offen offset:2048
    s_add_u32 s21, s21, 393216
    buffer_load_dwordx4 v[104:107], v1, s[8:11], s21 offen offset:0
    buffer_load_dwordx4 v[108:111], v1, s[8:11], s21 offen offset:1024
    buffer_load_dwordx4 v[112:115], v1, s[8:11], s21 offen offset:2048
    s_add_u32 s21, s21, 393216
    buffer_load_dwordx4 v[116:119], v1, s[8:11], s21 offen offset:0
    buffer_load_dwordx4 v[120:123], v1, s[8:11], s21 offen offset:1024
    buffer_load_dwordx4 v[124:127], v1, s[8:11], s21 offen offset:2048
    s_add_u32 s21, s21, 393216
    s_waitcnt vmcnt(0)
    s_add_u32 s22, s22, 10
    s_cmp_lt_u32 s22, 20
    s_cbranch_scc1 WPF_sw_13
    v_mov_b32 v12, 0
    s_mov_b32 s73, 3000000
    s_mov_b32 s93, 0
WINI_14:
    buffer_load_dwordx4 v[8:11], v12, s[68:71], 0 offen sc1
    s_sub_u32 s73, s73, 1
    s_cbranch_scc1 WINI_14_ok
    s_waitcnt vmcnt(0)
    v_readfirstlane_b32 s72, v10
    s_cmp_lt_u32 s72, 64
    s_cbranch_scc1 WINI_14_sl
    v_readfirstlane_b32 s93, v11
    s_cmp_lg_u32 s93, 0
    s_cbranch_scc1 WINI_14_ok
WINI_14_sl:
    s_sleep 8
    s_branch WINI_14
WINI_14_ok:
    s_waitcnt vmcnt(0)
    s_and_b32 s93, s93, 8192
    s_branch WPF_dn_10
WPF_qk_12:
    v_mov_b32 v12, 0
    s_mov_b32 s73, 3000000
    s_mov_b32 s93, 0
WINI_15:
    buffer_load_dwordx4 v[8:11], v12, s[68:71], 0 offen sc1
    s_sub_u32 s73, s73, 1
    s_cbranch_scc1 WINI_15_ok
    s_waitcnt vmcnt(0)
    v_readfirstlane_b32 s72, v10
    s_cmp_lt_u32 s72, 64
    s_cbranch_scc1 WINI_15_sl
    v_readfirstlane_b32 s93, v11
    s_cmp_lg_u32 s93, 0
    s_cbranch_scc1 WINI_15_ok
WINI_15_sl:
    s_sleep 8
    s_branch WINI_15
WINI_15_ok:
    s_waitcnt vmcnt(0)
    s_and_b32 s93, s93, 8192
    s_sub_u32 s20, s20, 393216
    s_mov_b32 s46, 2000000
    v_mov_b32 v2, 3640320
WPF_wt_11:
    buffer_load_dword v3, v2, s[12:15], s93 offen sc1
    s_sub_u32 s46, s46, 1
    s_cbranch_scc1 WPF_wt_11_go
    s_waitcnt vmcnt(0)
    v_cmp_eq_u32 vcc, 0, v3
    s_cbranch_vccz WPF_wt_11_go
    s_sleep 32
    s_branch WPF_wt_11
WPF_wt_11_go:
    s_load_dwordx2 s[8:9], s[0:1], 16
    s_mov_b32 s21, s20
    s_mov_b32 s22, 0
    s_waitcnt lgkmcnt(0)
WPF_sw_16:
    buffer_load_dwordx4 v[8:11], v1, s[8:11], s21 offen offset:0
    buffer_load_dwordx4 v[12:15], v1, s[8:11], s21 offen offset:1024
    buffer_load_dwordx4 v[16:19], v1, s[8:11], s21 offen offset:2048
    s_add_u32 s21, s21, 393216
    buffer_load_dwordx4 v[20:23], v1, s[8:11], s21 offen offset:0
    buffer_load_dwordx4 v[24:27], v1, s[8:11], s21 offen offset:1024
    buffer_load_dwordx4 v[28:31], v1, s[8:11], s21 offen offset:2048
    s_add_u32 s21, s21, 393216
    buffer_load_dwordx4 v[32:35], v1, s[8:11], s21 offen offset:0
    buffer_load_dwordx4 v[36:39], v1, s[8:11], s21 offen offset:1024
    buffer_load_dwordx4 v[40:43], v1, s[8:11], s21 offen offset:2048
    s_add_u32 s21, s21, 393216
    buffer_load_dwordx4 v[44:47], v1, s[8:11], s21 offen offset:0
    buffer_load_dwordx4 v[48:51], v1, s[8:11], s21 offen offset:1024
    buffer_load_dwordx4 v[52:55], v1, s[8:11], s21 offen offset:2048
    s_add_u32 s21, s21, 393216
    buffer_load_dwordx4 v[56:59], v1, s[8:11], s21 offen offset:0
    buffer_load_dwordx4 v[60:63], v1, s[8:11], s21 offen offset:1024
    buffer_load_dwordx4 v[64:67], v1, s[8:11], s21 offen offset:2048
    s_add_u32 s21, s21, 393216
    buffer_load_dwordx4 v[68:71], v1, s[8:11], s21 offen offset:0
    buffer_load_dwordx4 v[72:75], v1, s[8:11], s21 offen offset:1024
    buffer_load_dwordx4 v[76:79], v1, s[8:11], s21 offen offset:2048
    s_add_u32 s21, s21, 393216
    buffer_load_dwordx4 v[80:83], v1, s[8:11], s21 offen offset:0
    buffer_load_dwordx4 v[84:87], v1, s[8:11], s21 offen offset:1024
    buffer_load_dwordx4 v[88:91], v1, s[8:11], s21 offen offset:2048
    s_add_u32 s21, s21, 393216
    buffer_load_dwordx4 v[92:95], v1, s[8:11], s21 offen offset:0
    buffer_load_dwordx4 v[96:99], v1, s[8:11], s21 offen offset:1024
    buffer_load_dwordx4 v[100:103], v1, s[8:11], s21 offen offset:2048
    s_add_u32 s21, s21, 393216
    buffer_load_dwordx4 v[104:107], v1, s[8:11], s21 offen offset:0
    buffer_load_dwordx4 v[108:111], v1, s[8:11], s21 offen offset:1024
    buffer_load_dwordx4 v[112:115], v1, s[8:11], s21 offen offset:2048
    s_add_u32 s21, s21, 393216
    buffer_load_dwordx4 v[116:119], v1, s[8:11], s21 offen offset:0
    buffer_load_dwordx4 v[120:123], v1, s[8:11], s21 offen offset:1024
    buffer_load_dwordx4 v[124:127], v1, s[8:11], s21 offen offset:2048
    s_add_u32 s21, s21, 393216
    s_waitcnt vmcnt(0)
    s_add_u32 s22, s22, 10
    s_cmp_lt_u32 s22, 20
    s_cbranch_scc1 WPF_sw_16
    s_load_dwordx2 s[8:9], s[0:1], 24
    s_mov_b32 s21, s20
    s_mov_b32 s22, 0
    s_waitcnt lgkmcnt(0)
WPF_sw_17:
    buffer_load_dwordx4 v[8:11], v1, s[8:11], s21 offen offset:0
    buffer_load_dwordx4 v[12:15], v1, s[8:11], s21 offen offset:1024
    buffer_load_dwordx4 v[16:19], v1, s[8:11], s21 offen offset:2048
    s_add_u32 s21, s21, 393216
    buffer_load_dwordx4 v[20:23], v1, s[8:11], s21 offen offset:0
    buffer_load_dwordx4 v[24:27], v1, s[8:11], s21 offen offset:1024
    buffer_load_dwordx4 v[28:31], v1, s[8:11], s21 offen offset:2048
    s_add_u32 s21, s21, 393216
    buffer_load_dwordx4 v[32:35], v1, s[8:11], s21 offen offset:0
    buffer_load_dwordx4 v[36:39], v1, s[8:11], s21 offen offset:1024
    buffer_load_dwordx4 v[40:43], v1, s[8:11], s21 offen offset:2048
    s_add_u32 s21, s21, 393216
    buffer_load_dwordx4 v[44:47], v1, s[8:11], s21 offen offset:0
    buffer_load_dwordx4 v[48:51], v1, s[8:11], s21 offen offset:1024
    buffer_load_dwordx4 v[52:55], v1, s[8:11], s21 offen offset:2048
    s_add_u32 s21, s21, 393216
    buffer_load_dwordx4 v[56:59], v1, s[8:11], s21 offen offset:0
    buffer_load_dwordx4 v[60:63], v1, s[8:11], s21 offen offset:1024
    buffer_load_dwordx4 v[64:67], v1, s[8:11], s21 offen offset:2048
    s_add_u32 s21, s21, 393216
    buffer_load_dwordx4 v[68:71], v1, s[8:11], s21 offen offset:0
    buffer_load_dwordx4 v[72:75], v1, s[8:11], s21 offen offset:1024
    buffer_load_dwordx4 v[76:79], v1, s[8:11], s21 offen offset:2048
    s_add_u32 s21, s21, 393216
    buffer_load_dwordx4 v[80:83], v1, s[8:11], s21 offen offset:0
    buffer_load_dwordx4 v[84:87], v1, s[8:11], s21 offen offset:1024
    buffer_load_dwordx4 v[88:91], v1, s[8:11], s21 offen offset:2048
    s_add_u32 s21, s21, 393216
    buffer_load_dwordx4 v[92:95], v1, s[8:11], s21 offen offset:0
    buffer_load_dwordx4 v[96:99], v1, s[8:11], s21 offen offset:1024
    buffer_load_dwordx4 v[100:103], v1, s[8:11], s21 offen offset:2048
    s_add_u32 s21, s21, 393216
    buffer_load_dwordx4 v[104:107], v1, s[8:11], s21 offen offset:0
    buffer_load_dwordx4 v[108:111], v1, s[8:11], s21 offen offset:1024
    buffer_load_dwordx4 v[112:115], v1, s[8:11], s21 offen offset:2048
    s_add_u32 s21, s21, 393216
    buffer_load_dwordx4 v[116:119], v1, s[8:11], s21 offen offset:0
    buffer_load_dwordx4 v[120:123], v1, s[8:11], s21 offen offset:1024
    buffer_load_dwordx4 v[124:127], v1, s[8:11], s21 offen offset:2048
    s_add_u32 s21, s21, 393216
    s_waitcnt vmcnt(0)
    s_add_u32 s22, s22, 10
    s_cmp_lt_u32 s22, 20
    s_cbranch_scc1 WPF_sw_17
WPF_dn_10:
    s_cmp_ge_u32 s16, 28
    s_cbranch_scc1 MAIN_end
    v_and_b32 v9, 7, v255
    v_lshlrev_b32 v9, 5, v9
    s_mov_b32 s73, 3000000
CEN_18:
    buffer_load_dword v8, v9, s[68:71], 0 offen sc1
    s_mov_b32 s39, 1
    s_sub_u32 s73, s73, 1
    s_cbranch_scc1 CEN_18_ok
    s_waitcnt vmcnt(0)
    v_cmp_ne_u32 vcc, 32, v8
    s_cbranch_vccz CEN_18_ok
    s_mov_b32 s72, 0
    v_readlane_b32 s75, v8, 0
    s_add_u32 s72, s72, s75
    s_cmp_lt_u32 s75, 32
    s_cselect_b32 s39, 0, s39
    v_readlane_b32 s75, v8, 1
    s_add_u32 s72, s72, s75
    s_cmp_lt_u32 s75, 32
    s_cselect_b32 s39, 0, s39
    v_readlane_b32 s75, v8, 2
    s_add_u32 s72, s72, s75
    s_cmp_lt_u32 s75, 32
    s_cselect_b32 s39, 0, s39
    v_readlane_b32 s75, v8, 3
    s_add_u32 s72, s72, s75
    s_cmp_lt_u32 s75, 32
    s_cselect_b32 s39, 0, s39
    v_readlane_b32 s75, v8, 4
    s_add_u32 s72, s72, s75
    v_readlane_b32 s75, v8, 5
    s_add_u32 s72, s72, s75
    v_readlane_b32 s75, v8, 6
    s_add_u32 s72, s72, s75
    v_readlane_b32 s75, v8, 7
    s_add_u32 s72, s72, s75
    s_cmp_ge_u32 s72, 256
    s_cbranch_scc1 CEN_18_ok
    s_sleep 4
    s_branch CEN_18
CEN_18_ok:
    s_waitcnt vmcnt(0)
    s_sub_u32 s19, s16, 24
    s_lshl_b32 s19, s19, 3
    s_add_u32 s19, s19, s17
    s_lshl_b32 s20, s18, 3
    s_mul_i32 s21, s20, 40960
    s_mul_i32 s40, s19, 10240
    s_add_u32 s21, s21, s40
    s_add_u32 s21, s21, 91226112
    s_mul_i32 s22, s20, 12288
    s_mul_i32 s40, s19, 3072
    s_add_u32 s22, s22, s40
    s_add_u32 s22, s22, 34603008
    v_lshlrev_b32 v1, 4, v255
    v_add_u32 v2, 4096, v1
    v_add_u32 v3, 8192, v1
    s_lshl_b32 s40, s18, 7
    s_add_u32 s40, s40, 3609600
    v_mov_b32 v4, s40
    s_mov_b32 s27, 0
    s_mov_b32 s46, 4000000
    s_lshr_b32 s23, s19, 2
    s_add_u32 s23, s23, s20
    s_lshl_b32 s40, s23, 6
    s_add_u32 s40, s40, 3604480
    v_and_b32 v6, 7, v255
    v_lshlrev_b32 v6, 2, v6
    v_add_u32 v6, s40, v6
    s_mul_i32 s40, s23, 6
    s_sub_u32 s40, s40, 8
    v_add_u32 v7, s40, v255
    v_lshrrev_b32 v7, 3, v7
    v_lshlrev_b32 v7, 6, v7
    v_add_u32 v7, 3638784, v7
    v_cmp_gt_u32 vcc, 8, v255
    v_cmp_lt_u32 s[42:43], 13, v255
    s_or_b64 vcc, vcc, s[42:43]
    s_nop 1
    v_cndmask_b32 v6, v7, v6, vcc
    s_lshl_b32 s40, s18, 7
    s_lshl_b32 s41, s19, 2
    s_add_u32 s40, s40, s41
    s_add_u32 s40, s40, 3610624
    v_mov_b32 v7, s40
HLP_hloop:
    s_cmp_lt_u32 s27, 4
    s_cbranch_scc1 HLP_hgo
HLP_hwait:
    buffer_load_dword v5, v4, s[12:15], s93 offen sc1
    s_sub_u32 s46, s46, 1
    s_cbranch_scc1 HLP_hdone
    s_waitcnt vmcnt(0)
    v_readfirstlane_b32 s40, v5
    s_add_u32 s40, s40, 4
    s_cmp_gt_u32 s40, s27
    s_cbranch_scc1 HLP_hgo
    s_sleep 8
    s_branch HLP_hwait
HLP_hgo:
    buffer_load_dword v5, v6, s[12:15], s93 offen sc1
    s_sub_u32 s46, s46, 1
    s_cbranch_scc1 HLP_hdone
    s_waitcnt vmcnt(0)
    v_cmp_ge_u32 vcc, s27, v5
    s_cbranch_vccz HLP_hgo2
    s_sleep 8
    s_branch HLP_hgo
HLP_hgo2:
    buffer_load_dwordx4 v[8:11], v1, s[12:15], s22 offen offset:0
    buffer_load_dwordx4 v[12:15], v1, s[12:15], s22 offen offset:1024
    buffer_load_dwordx4 v[16:19], v1, s[12:15], s22 offen offset:2048
    buffer_load_dwordx4 v[20:23], v1, s[12:15], s21 offen offset:0
    buffer_load_dwordx4 v[24:27], v1, s[12:15], s21 offen offset:1024
    buffer_load_dwordx4 v[28:31], v1, s[12:15], s21 offen offset:2048
    buffer_load_dwordx4 v[32:35], v1, s[12:15], s21 offen offset:3072
    buffer_load_dwordx4 v[36:39], v2, s[12:15], s21 offen offset:0
    buffer_load_dwordx4 v[40:43], v2, s[12:15], s21 offen offset:1024
    buffer_load_dwordx4 v[44:47], v2, s[12:15], s21 offen offset:2048
    buffer_load_dwordx4 v[48:51], v2, s[12:15], s21 offen offset:3072
    buffer_load_dwordx4 v[52:55], v3, s[12:15], s21 offen offset:0
    buffer_load_dwordx4 v[56:59], v3, s[12:15], s21 offen offset:1024
    s_add_u32 s21, s21, 1310720
    s_add_u32 s22, s22, 393216
    s_add_u32 s27, s27, 1
    v_mov_b32 v5, s27
    s_waitcnt vmcnt(0)
    s_cmp_eq_u32 s39, 0
    s_cbranch_scc1 HLP_himp
    buffer_store_dword v5, v7, s[12:15], s93 offen
    s_branch HLP_hnx
HLP_himp:
    buffer_store_dword v5, v7, s[12:15], s93 offen sc1
HLP_hnx:
    s_cmp_lt_u32 s27, 64
    s_cbranch_scc1 HLP_hloop
HLP_hdone:
    s_branch MAIN_end
MAIN_rec:
    v_and_b32 v250, 15, v255
    v_lshrrev_b32 v251, 4, v255
    v_and_b32 v252, 7, v255
    v_bfe_u32 v253, v255, 3, 1
    s_sub_u32 s24, 0, s4
    s_and_b32 s24, s24, 0x1fffff
    s_cmp_ge_u32 s16, 12
    s_cselect_b32 s19, 1, 0
    s_mul_i32 s40, s19, 12
    s_sub_u32 s20, s16, s40
    s_mul_i32 s55, s19, 10
    s_add_u32 s55, s55, s20
    s_lshl_b32 s40, s18, 1
    s_add_u32 s19, s19, s40
    s_mul_i32 s21, s20, 11
    s_lshr_b32 s21, s21, 5
    s_mul_i32 s40, s21, 3
    s_sub_u32 s22, s20, s40
    s_and_b32 s23, s17, 3
    s_lshl_b32 s25, s19, 2
    s_add_u32 s26, s25, s23
    s_add_u32 s25, s25, s21
    s_mul_i32 s47, s19, 8192
    s_add_u32 s47, s47, 3145728
    s_mul_i32 s48, s18, 10240
    s_add_u32 s48, s48, 3407872
    s_mov_b32 s49, 0xfffffffe
    s_mov_b32 s46, 4000000
    s_lshl_b32 s56, s22, 2
    s_add_u32 s56, s56, s23
    s_mul_i32 s50, s25, 384
    s_lshl_b32 s40, s56, 5
    s_add_u32 s50, s50, s40
    s_mul_i32 s51, s17, 20480
    v_lshlrev_b32 v249, 4, v255
    v_add_u32 v248, s51, v249
    v_bfe_u32 v247, v255, 2, 2
    v_and_b32 v245, 3, v255
    v_lshl_add_u32 v246, v251, 2, v247
    v_lshlrev_b32 v246, 5, v246
    v_lshl_add_u32 v246, v245, 3, v246
    v_add_u32 v246, s51, v246
    v_lshl_add_u32 v244, v251, 3, v247
    v_lshlrev_b32 v244, 7, v244
    v_lshl_add_u32 v244, v245, 3, v244
    v_add_u32 v244, s51, v244
    v_lshlrev_b32 v243, 7, v251
    v_lshl_add_u32 v243, v252, 4, v243
    v_mov_b32 v242, 2130706432
    s_mov_b32 s27, 0
    s_mul_i32 s58, s23, 32768
    s_add_u32 s58, s58, 32768
    s_lshl_b32 s51, s23, 13
    s_mov_b32 s76, s51
    s_add_u32 s77, s58, 20480
    s_add_u32 s78, s58, 26624
    s_mov_b32 s44, 0x00ff00ff
    s_mov_b32 s45, 0x00ff00ff
    s_cmp_ge_u32 s17, 4
    s_cbranch_scc1 REC_yw
    s_cmp_ge_u32 s20, 10
    s_cbranch_scc1 REC_qkw
    s_load_dwordx2 s[8:9], s[0:1], 40
    s_mov_b32 s10, 7864320
    s_mov_b32 s11, 0x00020000
    s_mul_i32 s54, s26, 245760
    s_lshl_b32 s40, s20, 7
    s_add_u32 s54, s54, s40
    v_lshrrev_b32 v236, 3, v255
    v_mul_u32_u24 v236, 1280, v236
    v_lshl_add_u32 v236, v252, 4, v236
    s_waitcnt lgkmcnt(0)
    buffer_load_dwordx4 v[0:3], v236, s[8:11], s54 offen
    s_add_u32 s54, s54, 10240
    buffer_load_dwordx4 v[4:7], v236, s[8:11], s54 offen
    s_add_u32 s54, s54, 10240
    buffer_load_dwordx4 v[8:11], v236, s[8:11], s54 offen
    s_add_u32 s54, s54, 10240
    buffer_load_dwordx4 v[12:15], v236, s[8:11], s54 offen
    s_add_u32 s54, s54, 10240
    buffer_load_dwordx4 v[16:19], v236, s[8:11], s54 offen
    s_add_u32 s54, s54, 10240
    buffer_load_dwordx4 v[20:23], v236, s[8:11], s54 offen
    s_add_u32 s54, s54, 10240
    buffer_load_dwordx4 v[24:27], v236, s[8:11], s54 offen
    s_add_u32 s54, s54, 10240
    buffer_load_dwordx4 v[28:31], v236, s[8:11], s54 offen
    s_add_u32 s54, s54, 10240
    buffer_load_dwordx4 v[32:35], v236, s[8:11], s54 offen
    s_add_u32 s54, s54, 10240
    buffer_load_dwordx4 v[36:39], v236, s[8:11], s54 offen
    s_add_u32 s54, s54, 10240
    buffer_load_dwordx4 v[40:43], v236, s[8:11], s54 offen
    s_add_u32 s54, s54, 10240
    buffer_load_dwordx4 v[44:47], v236, s[8:11], s54 offen
    s_add_u32 s54, s54, 10240
    buffer_load_dwordx4 v[48:51], v236, s[8:11], s54 offen
    s_add_u32 s54, s54, 10240
    buffer_load_dwordx4 v[52:55], v236, s[8:11], s54 offen
    s_add_u32 s54, s54, 10240
    buffer_load_dwordx4 v[56:59], v236, s[8:11], s54 offen
    s_add_u32 s54, s54, 10240
    buffer_load_dwordx4 v[60:63], v236, s[8:11], s54 offen
    s_add_u32 s54, s54, 10240
    buffer_load_dwordx4 v[64:67], v236, s[8:11], s54 offen
    s_add_u32 s54, s54, 10240
    buffer_load_dwordx4 v[68:71], v236, s[8:11], s54 offen
    s_add_u32 s54, s54, 10240
    buffer_load_dwordx4 v[72:75], v236, s[8:11], s54 offen
    s_add_u32 s54, s54, 10240
    buffer_load_dwordx4 v[76:79], v236, s[8:11], s54 offen
    s_add_u32 s54, s54, 10240
    buffer_load_dwordx4 v[80:83], v236, s[8:11], s54 offen
    s_add_u32 s54, s54, 10240
    buffer_load_dwordx4 v[84:87], v236, s[8:11], s54 offen
    s_add_u32 s54, s54, 10240
    buffer_load_dwordx4 v[88:91], v236, s[8:11], s54 offen
    s_add_u32 s54, s54, 10240
    buffer_load_dwordx4 v[92:95], v236, s[8:11], s54 offen
    s_add_u32 s54, s54, 10240
    v_mul_u32_u24 v237, 384, v250
    v_xor_b32 v238, v251, v252
    v_lshl_add_u32 v240, v238, 4, v237
    v_or_b32 v238, 4, v251
    v_xor_b32 v238, v238, v252
    v_lshl_add_u32 v241, v238, 4, v237
    v_add_u32 v248, s58, v249
    v_lshl_add_u32 v244, v251, 3, v247
    v_lshlrev_b32 v244, 7, v244
    v_lshl_add_u32 v244, v245, 3, v244
    v_add_u32 v244, s58, v244
    s_waitcnt vmcnt(0)
    ds_write_b128 v248, v[0:3] offset:0
    ds_write_b128 v248, v[4:7] offset:1024
    ds_write_b128 v248, v[8:11] offset:2048
    ds_write_b128 v248, v[12:15] offset:3072
    ds_write_b128 v248, v[16:19] offset:4096
    ds_write_b128 v248, v[20:23] offset:5120
    ds_write_b128 v248, v[24:27] offset:6144
    ds_write_b128 v248, v[28:31] offset:7168
    ds_write_b128 v248, v[32:35] offset:8192
    ds_write_b128 v248, v[36:39] offset:9216
    ds_write_b128 v248, v[40:43] offset:10240
    ds_write_b128 v248, v[44:47] offset:11264
    s_waitcnt lgkmcnt(0)
    ds_read_b64_tr_b16 v[0:1], v244 offset:0
    ds_read_b64_tr_b16 v[2:3], v244 offset:512
    ds_read_b64_tr_b16 v[4:5], v244 offset:32
    ds_read_b64_tr_b16 v[6:7], v244 offset:544
    ds_read_b64_tr_b16 v[8:9], v244 offset:64
    ds_read_b64_tr_b16 v[10:11], v244 offset:576
    ds_read_b64_tr_b16 v[12:13], v244 offset:96
    ds_read_b64_tr_b16 v[14:15], v244 offset:608
    ds_read_b64_tr_b16 v[16:17], v244 offset:4096
    ds_read_b64_tr_b16 v[18:19], v244 offset:4608
    ds_read_b64_tr_b16 v[20:21], v244 offset:4128
    ds_read_b64_tr_b16 v[22:23], v244 offset:4640
    ds_read_b64_tr_b16 v[24:25], v244 offset:4160
    ds_read_b64_tr_b16 v[26:27], v244 offset:4672
    ds_read_b64_tr_b16 v[28:29], v244 offset:4192
    ds_read_b64_tr_b16 v[30:31], v244 offset:4704
    ds_read_b64_tr_b16 v[32:33], v244 offset:8192
    ds_read_b64_tr_b16 v[34:35], v244 offset:8704
    ds_read_b64_tr_b16 v[36:37], v244 offset:8224
    ds_read_b64_tr_b16 v[38:39], v244 offset:8736
    ds_read_b64_tr_b16 v[40:41], v244 offset:8256
    ds_read_b64_tr_b16 v[42:43], v244 offset:8768
    ds_read_b64_tr_b16 v[44:45], v244 offset:8288
    ds_read_b64_tr_b16 v[46:47], v244 offset:8800
    s_waitcnt lgkmcnt(0)
    ds_write_b128 v248, v[48:51] offset:0
    ds_write_b128 v248, v[52:55] offset:1024
    ds_write_b128 v248, v[56:59] offset:2048
    ds_write_b128 v248, v[60:63] offset:3072
    ds_write_b128 v248, v[64:67] offset:4096
    ds_write_b128 v248, v[68:71] offset:5120
    ds_write_b128 v248, v[72:75] offset:6144
    ds_write_b128 v248, v[76:79] offset:7168
    ds_write_b128 v248, v[80:83] offset:8192
    ds_write_b128 v248, v[84:87] offset:9216
    ds_write_b128 v248, v[88:91] offset:10240
    ds_write_b128 v248, v[92:95] offset:11264
    s_waitcnt lgkmcnt(0)
    ds_read_b64_tr_b16 v[48:49], v244 offset:0
    ds_read_b64_tr_b16 v[50:51], v244 offset:512
    ds_read_b64_tr_b16 v[52:53], v244 offset:32
    ds_read_b64_tr_b16 v[54:55], v244 offset:544
    ds_read_b64_tr_b16 v[56:57], v244 offset:64
    ds_read_b64_tr_b16 v[58:59], v244 offset:576
    ds_read_b64_tr_b16 v[60:61], v244 offset:96
    ds_read_b64_tr_b16 v[62:63], v244 offset:608
    ds_read_b64_tr_b16 v[64:65], v244 offset:4096
    ds_read_b64_tr_b16 v[66:67], v244 offset:4608
    ds_read_b64_tr_b16 v[68:69], v244 offset:4128
    ds_read_b64_tr_b16 v[70:71], v244 offset:4640
    ds_read_b64_tr_b16 v[72:73], v244 offset:4160
    ds_read_b64_tr_b16 v[74:75], v244 offset:4672
    ds_read_b64_tr_b16 v[76:77], v244 offset:4192
    ds_read_b64_tr_b16 v[78:79], v244 offset:4704
    ds_read_b64_tr_b16 v[80:81], v244 offset:8192
    ds_read_b64_tr_b16 v[82:83], v244 offset:8704
    ds_read_b64_tr_b16 v[84:85], v244 offset:8224
    ds_read_b64_tr_b16 v[86:87], v244 offset:8736
    ds_read_b64_tr_b16 v[88:89], v244 offset:8256
    ds_read_b64_tr_b16 v[90:91], v244 offset:8768
    ds_read_b64_tr_b16 v[92:93], v244 offset:8288
    ds_read_b64_tr_b16 v[94:95], v244 offset:8800
    s_waitcnt lgkmcnt(0)
    s_barrier
    v_add_u32 v246, s76, v240
    v_add_u32 v244, s76, v241
    s_mov_b32 s40, s76
    s_mov_b32 s76, s77
    s_mov_b32 s77, s78
    s_mov_b32 s78, s40
    ds_read_b128 v[96:99], v246 offset:0
    ds_read_b128 v[100:103], v244 offset:0
    ds_read_b128 v[104:107], v246 offset:128
    ds_read_b128 v[108:111], v244 offset:128
    ds_read_b128 v[112:115], v246 offset:256
    ds_read_b128 v[116:119], v244 offset:256
    s_waitcnt lgkmcnt(0)
    s_mov_b32 s53, 0
REC_bloop:
    s_barrier
    v_add_u32 v246, s76, v240
    v_add_u32 v244, s76, v241
    s_mov_b32 s40, s76
    s_mov_b32 s76, s77
    s_mov_b32 s77, s78
    s_mov_b32 s78, s40
    ds_read_b128 v[120:123], v246 offset:0
    ds_read_b128 v[124:127], v244 offset:0
    ds_read_b128 v[128:131], v246 offset:128
    ds_read_b128 v[132:135], v244 offset:128
    ds_read_b128 v[136:139], v246 offset:256
    ds_read_b128 v[140:143], v244 offset:256
    v_mfma_f32_16x16x32_bf16 v[144:147], v[96:99], v[0:3], 0
    v_mfma_f32_16x16x32_bf16 v[148:151], v[96:99], v[4:7], 0
    v_mfma_f32_16x16x32_bf16 v[152:155], v[96:99], v[8:11], 0
    v_mfma_f32_16x16x32_bf16 v[156:159], v[96:99], v[12:15], 0
    v_mfma_f32_16x16x32_bf16 v[144:147], v[100:103], v[16:19], v[144:147]
    v_mfma_f32_16x16x32_bf16 v[148:151], v[100:103], v[20:23], v[148:151]
    v_mfma_f32_16x16x32_bf16 v[152:155], v[100:103], v[24:27], v[152:155]
    v_mfma_f32_16x16x32_bf16 v[156:159], v[100:103], v[28:31], v[156:159]
    v_mfma_f32_16x16x32_bf16 v[144:147], v[104:107], v[32:35], v[144:147]
    v_mfma_f32_16x16x32_bf16 v[148:151], v[104:107], v[36:39], v[148:151]
    v_mfma_f32_16x16x32_bf16 v[152:155], v[104:107], v[40:43], v[152:155]
    v_mfma_f32_16x16x32_bf16 v[156:159], v[104:107], v[44:47], v[156:159]
    v_mfma_f32_16x16x32_bf16 v[144:147], v[108:111], v[48:51], v[144:147]
    v_mfma_f32_16x16x32_bf16 v[148:151], v[108:111], v[52:55], v[148:151]
    v_mfma_f32_16x16x32_bf16 v[152:155], v[108:111], v[56:59], v[152:155]
    v_mfma_f32_16x16x32_bf16 v[156:159], v[108:111], v[60:63], v[156:159]
    v_mfma_f32_16x16x32_bf16 v[144:147], v[112:115], v[64:67], v[144:147]
    v_mfma_f32_16x16x32_bf16 v[148:151], v[112:115], v[68:71], v[148:151]
    v_mfma_f32_16x16x32_bf16 v[152:155], v[112:115], v[72:75], v[152:155]
    v_mfma_f32_16x16x32_bf16 v[156:159], v[112:115], v[76:79], v[156:159]
    v_mfma_f32_16x16x32_bf16 v[144:147], v[116:119], v[80:83], v[144:147]
    v_mfma_f32_16x16x32_bf16 v[148:151], v[116:119], v[84:87], v[148:151]
    v_mfma_f32_16x16x32_bf16 v[152:155], v[116:119], v[88:91], v[152:155]
    v_mfma_f32_16x16x32_bf16 v[156:159], v[116:119], v[92:95], v[156:159]
    s_waitcnt lgkmcnt(0)
    s_cmp_eq_u32 s53, 19
    s_cbranch_scc1 REC_blast
    s_barrier
    v_add_u32 v246, s76, v240
    v_add_u32 v244, s76, v241
    s_mov_b32 s40, s76
    s_mov_b32 s76, s77
    s_mov_b32 s77, s78
    s_mov_b32 s78, s40
    ds_read_b128 v[96:99], v246 offset:0
    ds_read_b128 v[100:103], v244 offset:0
    ds_read_b128 v[104:107], v246 offset:128
    ds_read_b128 v[108:111], v244 offset:128
    ds_read_b128 v[112:115], v246 offset:256
    ds_read_b128 v[116:119], v244 offset:256
REC_blast:
    v_mfma_f32_16x16x32_bf16 v[160:163], v[120:123], v[0:3], 0
    v_mfma_f32_16x16x32_bf16 v[164:167], v[120:123], v[4:7], 0
    v_mfma_f32_16x16x32_bf16 v[168:171], v[120:123], v[8:11], 0
    v_mfma_f32_16x16x32_bf16 v[172:175], v[120:123], v[12:15], 0
    v_mfma_f32_16x16x32_bf16 v[160:163], v[124:127], v[16:19], v[160:163]
    v_mfma_f32_16x16x32_bf16 v[164:167], v[124:127], v[20:23], v[164:167]
    v_mfma_f32_16x16x32_bf16 v[168:171], v[124:127], v[24:27], v[168:171]
    v_mfma_f32_16x16x32_bf16 v[172:175], v[124:127], v[28:31], v[172:175]
    v_mfma_f32_16x16x32_bf16 v[160:163], v[128:131], v[32:35], v[160:163]
    v_mfma_f32_16x16x32_bf16 v[164:167], v[128:131], v[36:39], v[164:167]
    v_mfma_f32_16x16x32_bf16 v[168:171], v[128:131], v[40:43], v[168:171]
    v_mfma_f32_16x16x32_bf16 v[172:175], v[128:131], v[44:47], v[172:175]
    v_mfma_f32_16x16x32_bf16 v[160:163], v[132:135], v[48:51], v[160:163]
    v_mfma_f32_16x16x32_bf16 v[164:167], v[132:135], v[52:55], v[164:167]
    v_mfma_f32_16x16x32_bf16 v[168:171], v[132:135], v[56:59], v[168:171]
    v_mfma_f32_16x16x32_bf16 v[172:175], v[132:135], v[60:63], v[172:175]
    v_mfma_f32_16x16x32_bf16 v[160:163], v[136:139], v[64:67], v[160:163]
    v_mfma_f32_16x16x32_bf16 v[164:167], v[136:139], v[68:71], v[164:167]
    v_mfma_f32_16x16x32_bf16 v[168:171], v[136:139], v[72:75], v[168:171]
    v_mfma_f32_16x16x32_bf16 v[172:175], v[136:139], v[76:79], v[172:175]
    v_mfma_f32_16x16x32_bf16 v[160:163], v[140:143], v[80:83], v[160:163]
    v_mfma_f32_16x16x32_bf16 v[164:167], v[140:143], v[84:87], v[164:167]
    v_mfma_f32_16x16x32_bf16 v[168:171], v[140:143], v[88:91], v[168:171]
    v_mfma_f32_16x16x32_bf16 v[172:175], v[140:143], v[92:95], v[172:175]
    s_and_b32 s40, s53, 1
    s_lshl_b32 s40, s40, 12
    s_add_u32 s40, s40, 8192
    s_sub_u32 s41, s53, 12
    s_lshl_b32 s41, s41, 12
    s_cmp_lt_u32 s53, 12
    s_cselect_b32 s40, s40, s41
    v_add_u32 v242, s40, v248
    s_nop 3
    v_cvt_pk_bf16_f32 v224, v144, v145
    v_cvt_pk_bf16_f32 v225, v146, v147
    v_cvt_pk_bf16_f32 v226, v160, v161
    v_cvt_pk_bf16_f32 v227, v162, v163
    v_cvt_pk_bf16_f32 v228, v148, v149
    v_cvt_pk_bf16_f32 v229, v150, v151
    v_cvt_pk_bf16_f32 v230, v164, v165
    v_cvt_pk_bf16_f32 v231, v166, v167
    v_cvt_pk_bf16_f32 v232, v152, v153
    v_cvt_pk_bf16_f32 v233, v154, v155
    v_cvt_pk_bf16_f32 v234, v168, v169
    v_cvt_pk_bf16_f32 v235, v170, v171
    v_cvt_pk_bf16_f32 v236, v156, v157
    v_cvt_pk_bf16_f32 v237, v158, v159
    v_cvt_pk_bf16_f32 v238, v172, v173
    v_cvt_pk_bf16_f32 v239, v174, v175
    s_cmp_ge_u32 s53, 17
    s_cbranch_scc1 REC_bhold
    ds_write_b128 v242, v[224:227] offset:0
    ds_write_b128 v242, v[228:231] offset:1024
    ds_write_b128 v242, v[232:235] offset:2048
    ds_write_b128 v242, v[236:239] offset:3072
    s_branch REC_bnext
REC_bhold:
    s_cmp_lg_u32 s53, 17
    s_cbranch_scc1 REC_bh0
    v_mov_b32 v176, v224
    v_mov_b32 v177, v225
    v_mov_b32 v178, v226
    v_mov_b32 v179, v227
    v_mov_b32 v180, v228
    v_mov_b32 v181, v229
    v_mov_b32 v182, v230
    v_mov_b32 v183, v231
    v_mov_b32 v184, v232
    v_mov_b32 v185, v233
    v_mov_b32 v186, v234
    v_mov_b32 v187, v235
    v_mov_b32 v188, v236
    v_mov_b32 v189, v237
    v_mov_b32 v190, v238
    v_mov_b32 v191, v239
REC_bh0:
    s_cmp_lg_u32 s53, 18
    s_cbranch_scc1 REC_bh1
    v_mov_b32 v192, v224
    v_mov_b32 v193, v225
    v_mov_b32 v194, v226
    v_mov_b32 v195, v227
    v_mov_b32 v196, v228
    v_mov_b32 v197, v229
    v_mov_b32 v198, v230
    v_mov_b32 v199, v231
    v_mov_b32 v200, v232
    v_mov_b32 v201, v233
    v_mov_b32 v202, v234
    v_mov_b32 v203, v235
    v_mov_b32 v204, v236
    v_mov_b32 v205, v237
    v_mov_b32 v206, v238
    v_mov_b32 v207, v239
REC_bh1:
    s_cmp_lg_u32 s53, 19
    s_cbranch_scc1 REC_bh2
    v_mov_b32 v208, v224
    v_mov_b32 v209, v225
    v_mov_b32 v210, v226
    v_mov_b32 v211, v227
    v_mov_b32 v212, v228
    v_mov_b32 v213, v229
    v_mov_b32 v214, v230
    v_mov_b32 v215, v231
    v_mov_b32 v216, v232
    v_mov_b32 v217, v233
    v_mov_b32 v218, v234
    v_mov_b32 v219, v235
    v_mov_b32 v220, v236
    v_mov_b32 v221, v237
    v_mov_b32 v222, v238
    v_mov_b32 v223, v239
REC_bh2:
REC_bnext:
    s_waitcnt lgkmcnt(0)
    s_add_u32 s53, s53, 1
    s_cmp_lt_u32 s53, 20
    s_cbranch_scc1 REC_bloop
    v_mov_b32 v242, 2130706432
    ds_write_b128 v248, v[176:179] offset:20480
    ds_write_b128 v248, v[180:183] offset:21504
    ds_write_b128 v248, v[184:187] offset:22528
    ds_write_b128 v248, v[188:191] offset:23552
    ds_write_b128 v248, v[192:195] offset:24576
    ds_write_b128 v248, v[196:199] offset:25600
    ds_write_b128 v248, v[200:203] offset:26624
    ds_write_b128 v248, v[204:207] offset:27648
    ds_write_b128 v248, v[208:211] offset:28672
    ds_write_b128 v248, v[212:215] offset:29696
    ds_write_b128 v248, v[216:219] offset:30720
    ds_write_b128 v248, v[220:223] offset:31744
    s_waitcnt lgkmcnt(0)
REC_qkw:
    v_lshl_add_u32 v246, v251, 2, v247
    v_bfe_u32 v244, v246, 1, 2
    v_xor_b32 v244, s23, v244
    v_lshlrev_b32 v246, 7, v246
    v_lshl_add_u32 v246, v244, 5, v246
    v_lshl_add_u32 v246, v245, 3, v246
    s_barrier
    s_cmp_lg_u32 s23, 0
    s_cbranch_scc1 REC_qk1
    s_barrier
    ds_read_b64_tr_b16 v[0:1], v246 offset:0
    ds_read_b64_tr_b16 v[2:3], v246 offset:2048
    ds_read_b64_tr_b16 v[4:5], v246 offset:4096
    ds_read_b64_tr_b16 v[6:7], v246 offset:6144
    s_waitcnt lgkmcnt(0)
    s_barrier
    ds_read_b64_tr_b16 v[8:9], v246 offset:8192
    ds_read_b64_tr_b16 v[10:11], v246 offset:10240
    ds_read_b64_tr_b16 v[12:13], v246 offset:12288
    ds_read_b64_tr_b16 v[14:15], v246 offset:14336
    s_waitcnt lgkmcnt(0)
    s_barrier
    ds_read_b64_tr_b16 v[16:17], v246 offset:16384
    ds_read_b64_tr_b16 v[18:19], v246 offset:18432
    ds_read_b64_tr_b16 v[20:21], v246 offset:20480
    ds_read_b64_tr_b16 v[22:23], v246 offset:22528
    s_waitcnt lgkmcnt(0)
    s_barrier
    ds_read_b64_tr_b16 v[24:25], v246 offset:24576
    ds_read_b64_tr_b16 v[26:27], v246 offset:26624
    ds_read_b64_tr_b16 v[28:29], v246 offset:28672
    ds_read_b64_tr_b16 v[30:31], v246 offset:30720
    s_waitcnt lgkmcnt(0)
    s_barrier
    ds_read_b64_tr_b16 v[32:33], v246 offset:0
    ds_read_b64_tr_b16 v[34:35], v246 offset:2048
    ds_read_b64_tr_b16 v[36:37], v246 offset:4096
    ds_read_b64_tr_b16 v[38:39], v246 offset:6144
    s_waitcnt lgkmcnt(0)
    s_barrier
    ds_read_b64_tr_b16 v[40:41], v246 offset:8192
    ds_read_b64_tr_b16 v[42:43], v246 offset:10240
    ds_read_b64_tr_b16 v[44:45], v246 offset:12288
    ds_read_b64_tr_b16 v[46:47], v246 offset:14336
    s_waitcnt lgkmcnt(0)
    s_barrier
    ds_read_b64_tr_b16 v[48:49], v246 offset:16384
    ds_read_b64_tr_b16 v[50:51], v246 offset:18432
    ds_read_b64_tr_b16 v[52:53], v246 offset:20480
    ds_read_b64_tr_b16 v[54:55], v246 offset:22528
    s_waitcnt lgkmcnt(0)
    s_barrier
    ds_read_b64_tr_b16 v[56:57], v246 offset:24576
    ds_read_b64_tr_b16 v[58:59], v246 offset:26624
    ds_read_b64_tr_b16 v[60:61], v246 offset:28672
    ds_read_b64_tr_b16 v[62:63], v246 offset:30720
    s_waitcnt lgkmcnt(0)
    s_barrier
    ds_read_b64_tr_b16 v[64:65], v246 offset:0
    ds_read_b64_tr_b16 v[66:67], v246 offset:2048
    ds_read_b64_tr_b16 v[68:69], v246 offset:4096
    ds_read_b64_tr_b16 v[70:71], v246 offset:6144
    s_waitcnt lgkmcnt(0)
    s_barrier
    ds_read_b64_tr_b16 v[72:73], v246 offset:8192
    ds_read_b64_tr_b16 v[74:75], v246 offset:10240
    ds_read_b64_tr_b16 v[76:77], v246 offset:12288
    ds_read_b64_tr_b16 v[78:79], v246 offset:14336
    s_waitcnt lgkmcnt(0)
    s_barrier
    ds_read_b64_tr_b16 v[80:81], v246 offset:16384
    ds_read_b64_tr_b16 v[82:83], v246 offset:18432
    ds_read_b64_tr_b16 v[84:85], v246 offset:20480
    ds_read_b64_tr_b16 v[86:87], v246 offset:22528
    s_waitcnt lgkmcnt(0)
    s_barrier
    ds_read_b64_tr_b16 v[88:89], v246 offset:24576
    ds_read_b64_tr_b16 v[90:91], v246 offset:26624
    ds_read_b64_tr_b16 v[92:93], v246 offset:28672
    ds_read_b64_tr_b16 v[94:95], v246 offset:30720
    s_waitcnt lgkmcnt(0)
    s_barrier
    ds_read_b64_tr_b16 v[96:97], v246 offset:0
    ds_read_b64_tr_b16 v[98:99], v246 offset:2048
    ds_read_b64_tr_b16 v[100:101], v246 offset:4096
    ds_read_b64_tr_b16 v[102:103], v246 offset:6144
    s_waitcnt lgkmcnt(0)
    s_barrier
    ds_read_b64_tr_b16 v[104:105], v246 offset:8192
    ds_read_b64_tr_b16 v[106:107], v246 offset:10240
    ds_read_b64_tr_b16 v[108:109], v246 offset:12288
    ds_read_b64_tr_b16 v[110:111], v246 offset:14336
    s_waitcnt lgkmcnt(0)
    s_barrier
    ds_read_b64_tr_b16 v[112:113], v246 offset:16384
    ds_read_b64_tr_b16 v[114:115], v246 offset:18432
    ds_read_b64_tr_b16 v[116:117], v246 offset:20480
    ds_read_b64_tr_b16 v[118:119], v246 offset:22528
    s_waitcnt lgkmcnt(0)
    s_barrier
    ds_read_b64_tr_b16 v[120:121], v246 offset:24576
    ds_read_b64_tr_b16 v[122:123], v246 offset:26624
    ds_read_b64_tr_b16 v[124:125], v246 offset:28672
    ds_read_b64_tr_b16 v[126:127], v246 offset:30720
    s_waitcnt lgkmcnt(0)
    s_barrier
    ds_read_b64_tr_b16 v[128:129], v246 offset:0
    ds_read_b64_tr_b16 v[130:131], v246 offset:2048
    ds_read_b64_tr_b16 v[132:133], v246 offset:4096
    ds_read_b64_tr_b16 v[134:135], v246 offset:6144
    s_waitcnt lgkmcnt(0)
    s_barrier
    ds_read_b64_tr_b16 v[136:137], v246 offset:8192
    ds_read_b64_tr_b16 v[138:139], v246 offset:10240
    ds_read_b64_tr_b16 v[140:141], v246 offset:12288
    ds_read_b64_tr_b16 v[142:143], v246 offset:14336
    s_waitcnt lgkmcnt(0)
    s_barrier
    ds_read_b64_tr_b16 v[144:145], v246 offset:16384
    ds_read_b64_tr_b16 v[146:147], v246 offset:18432
    ds_read_b64_tr_b16 v[148:149], v246 offset:20480
    ds_read_b64_tr_b16 v[150:151], v246 offset:22528
    s_waitcnt lgkmcnt(0)
    s_barrier
    ds_read_b64_tr_b16 v[152:153], v246 offset:24576
    ds_read_b64_tr_b16 v[154:155], v246 offset:26624
    ds_read_b64_tr_b16 v[156:157], v246 offset:28672
    ds_read_b64_tr_b16 v[158:159], v246 offset:30720
    s_waitcnt lgkmcnt(0)
    s_branch REC_qkd
REC_qk1:
    s_cmp_lg_u32 s23, 1
    s_cbranch_scc1 REC_qk2
    s_barrier
    ds_read_b64_tr_b16 v[60:61], v246 offset:0
    ds_read_b64_tr_b16 v[62:63], v246 offset:2048
    ds_read_b64_tr_b16 v[64:65], v246 offset:4096
    ds_read_b64_tr_b16 v[66:67], v246 offset:6144
    s_waitcnt lgkmcnt(0)
    s_barrier
    ds_read_b64_tr_b16 v[68:69], v246 offset:8192
    ds_read_b64_tr_b16 v[70:71], v246 offset:10240
    ds_read_b64_tr_b16 v[72:73], v246 offset:12288
    ds_read_b64_tr_b16 v[74:75], v246 offset:14336
    s_waitcnt lgkmcnt(0)
    s_barrier
    ds_read_b64_tr_b16 v[76:77], v246 offset:16384
    ds_read_b64_tr_b16 v[78:79], v246 offset:18432
    ds_read_b64_tr_b16 v[0:1], v246 offset:20480
    ds_read_b64_tr_b16 v[2:3], v246 offset:22528
    s_waitcnt lgkmcnt(0)
    s_barrier
    ds_read_b64_tr_b16 v[4:5], v246 offset:24576
    ds_read_b64_tr_b16 v[6:7], v246 offset:26624
    ds_read_b64_tr_b16 v[8:9], v246 offset:28672
    ds_read_b64_tr_b16 v[10:11], v246 offset:30720
    s_waitcnt lgkmcnt(0)
    s_barrier
    ds_read_b64_tr_b16 v[12:13], v246 offset:0
    ds_read_b64_tr_b16 v[14:15], v246 offset:2048
    ds_read_b64_tr_b16 v[16:17], v246 offset:4096
    ds_read_b64_tr_b16 v[18:19], v246 offset:6144
    s_waitcnt lgkmcnt(0)
    s_barrier
    ds_read_b64_tr_b16 v[20:21], v246 offset:8192
    ds_read_b64_tr_b16 v[22:23], v246 offset:10240
    ds_read_b64_tr_b16 v[24:25], v246 offset:12288
    ds_read_b64_tr_b16 v[26:27], v246 offset:14336
    s_waitcnt lgkmcnt(0)
    s_barrier
    ds_read_b64_tr_b16 v[28:29], v246 offset:16384
    ds_read_b64_tr_b16 v[30:31], v246 offset:18432
    ds_read_b64_tr_b16 v[32:33], v246 offset:20480
    ds_read_b64_tr_b16 v[34:35], v246 offset:22528
    s_waitcnt lgkmcnt(0)
    s_barrier
    ds_read_b64_tr_b16 v[36:37], v246 offset:24576
    ds_read_b64_tr_b16 v[38:39], v246 offset:26624
    ds_read_b64_tr_b16 v[40:41], v246 offset:28672
    ds_read_b64_tr_b16 v[42:43], v246 offset:30720
    s_waitcnt lgkmcnt(0)
    s_barrier
    ds_read_b64_tr_b16 v[44:45], v246 offset:0
    ds_read_b64_tr_b16 v[46:47], v246 offset:2048
    ds_read_b64_tr_b16 v[48:49], v246 offset:4096
    ds_read_b64_tr_b16 v[50:51], v246 offset:6144
    s_waitcnt lgkmcnt(0)
    s_barrier
    ds_read_b64_tr_b16 v[52:53], v246 offset:8192
    ds_read_b64_tr_b16 v[54:55], v246 offset:10240
    ds_read_b64_tr_b16 v[56:57], v246 offset:12288
    ds_read_b64_tr_b16 v[58:59], v246 offset:14336
    s_waitcnt lgkmcnt(0)
    s_barrier
    ds_read_b64_tr_b16 v[140:141], v246 offset:16384
    ds_read_b64_tr_b16 v[142:143], v246 offset:18432
    ds_read_b64_tr_b16 v[144:145], v246 offset:20480
    ds_read_b64_tr_b16 v[146:147], v246 offset:22528
    s_waitcnt lgkmcnt(0)
    s_barrier
    ds_read_b64_tr_b16 v[148:149], v246 offset:24576
    ds_read_b64_tr_b16 v[150:151], v246 offset:26624
    ds_read_b64_tr_b16 v[152:153], v246 offset:28672
    ds_read_b64_tr_b16 v[154:155], v246 offset:30720
    s_waitcnt lgkmcnt(0)
    s_barrier
    ds_read_b64_tr_b16 v[156:157], v246 offset:0
    ds_read_b64_tr_b16 v[158:159], v246 offset:2048
    ds_read_b64_tr_b16 v[80:81], v246 offset:4096
    ds_read_b64_tr_b16 v[82:83], v246 offset:6144
    s_waitcnt lgkmcnt(0)
    s_barrier
    ds_read_b64_tr_b16 v[84:85], v246 offset:8192
    ds_read_b64_tr_b16 v[86:87], v246 offset:10240
    ds_read_b64_tr_b16 v[88:89], v246 offset:12288
    ds_read_b64_tr_b16 v[90:91], v246 offset:14336
    s_waitcnt lgkmcnt(0)
    s_barrier
    ds_read_b64_tr_b16 v[92:93], v246 offset:16384
    ds_read_b64_tr_b16 v[94:95], v246 offset:18432
    ds_read_b64_tr_b16 v[96:97], v246 offset:20480
    ds_read_b64_tr_b16 v[98:99], v246 offset:22528
    s_waitcnt lgkmcnt(0)
    s_barrier
    ds_read_b64_tr_b16 v[100:101], v246 offset:24576
    ds_read_b64_tr_b16 v[102:103], v246 offset:26624
    ds_read_b64_tr_b16 v[104:105], v246 offset:28672
    ds_read_b64_tr_b16 v[106:107], v246 offset:30720
    s_waitcnt lgkmcnt(0)
    s_barrier
    ds_read_b64_tr_b16 v[108:109], v246 offset:0
    ds_read_b64_tr_b16 v[110:111], v246 offset:2048
    ds_read_b64_tr_b16 v[112:113], v246 offset:4096
    ds_read_b64_tr_b16 v[114:115], v246 offset:6144
    s_waitcnt lgkmcnt(0)
    s_barrier
    ds_read_b64_tr_b16 v[116:117], v246 offset:8192
    ds_read_b64_tr_b16 v[118:119], v246 offset:10240
    ds_read_b64_tr_b16 v[120:121], v246 offset:12288
    ds_read_b64_tr_b16 v[122:123], v246 offset:14336
    s_waitcnt lgkmcnt(0)
    s_barrier
    ds_read_b64_tr_b16 v[124:125], v246 offset:16384
    ds_read_b64_tr_b16 v[126:127], v246 offset:18432
    ds_read_b64_tr_b16 v[128:129], v246 offset:20480
    ds_read_b64_tr_b16 v[130:131], v246 offset:22528
    s_waitcnt lgkmcnt(0)
    s_barrier
    ds_read_b64_tr_b16 v[132:133], v246 offset:24576
    ds_read_b64_tr_b16 v[134:135], v246 offset:26624
    ds_read_b64_tr_b16 v[136:137], v246 offset:28672
    ds_read_b64_tr_b16 v[138:139], v246 offset:30720
    s_waitcnt lgkmcnt(0)
    s_branch REC_qkd
REC_qk2:
    s_cmp_lg_u32 s23, 2
    s_cbranch_scc1 REC_qk3
    s_barrier
    ds_read_b64_tr_b16 v[40:41], v246 offset:0
    ds_read_b64_tr_b16 v[42:43], v246 offset:2048
    ds_read_b64_tr_b16 v[44:45], v246 offset:4096
    ds_read_b64_tr_b16 v[46:47], v246 offset:6144
    s_waitcnt lgkmcnt(0)
    s_barrier
    ds_read_b64_tr_b16 v[48:49], v246 offset:8192
    ds_read_b64_tr_b16 v[50:51], v246 offset:10240
    ds_read_b64_tr_b16 v[52:53], v246 offset:12288
    ds_read_b64_tr_b16 v[54:55], v246 offset:14336
    s_waitcnt lgkmcnt(0)
    s_barrier
    ds_read_b64_tr_b16 v[56:57], v246 offset:16384
    ds_read_b64_tr_b16 v[58:59], v246 offset:18432
    ds_read_b64_tr_b16 v[60:61], v246 offset:20480
    ds_read_b64_tr_b16 v[62:63], v246 offset:22528
    s_waitcnt lgkmcnt(0)
    s_barrier
    ds_read_b64_tr_b16 v[64:65], v246 offset:24576
    ds_read_b64_tr_b16 v[66:67], v246 offset:26624
    ds_read_b64_tr_b16 v[68:69], v246 offset:28672
    ds_read_b64_tr_b16 v[70:71], v246 offset:30720
    s_waitcnt lgkmcnt(0)
    s_barrier
    ds_read_b64_tr_b16 v[72:73], v246 offset:0
    ds_read_b64_tr_b16 v[74:75], v246 offset:2048
    ds_read_b64_tr_b16 v[76:77], v246 offset:4096
    ds_read_b64_tr_b16 v[78:79], v246 offset:6144
    s_waitcnt lgkmcnt(0)
    s_barrier
    ds_read_b64_tr_b16 v[0:1], v246 offset:8192
    ds_read_b64_tr_b16 v[2:3], v246 offset:10240
    ds_read_b64_tr_b16 v[4:5], v246 offset:12288
    ds_read_b64_tr_b16 v[6:7], v246 offset:14336
    s_waitcnt lgkmcnt(0)
    s_barrier
    ds_read_b64_tr_b16 v[8:9], v246 offset:16384
    ds_read_b64_tr_b16 v[10:11], v246 offset:18432
    ds_read_b64_tr_b16 v[12:13], v246 offset:20480
    ds_read_b64_tr_b16 v[14:15], v246 offset:22528
    s_waitcnt lgkmcnt(0)
    s_barrier
    ds_read_b64_tr_b16 v[16:17], v246 offset:24576
    ds_read_b64_tr_b16 v[18:19], v246 offset:26624
    ds_read_b64_tr_b16 v[20:21], v246 offset:28672
    ds_read_b64_tr_b16 v[22:23], v246 offset:30720
    s_waitcnt lgkmcnt(0)
    s_barrier
    ds_read_b64_tr_b16 v[24:25], v246 offset:0
    ds_read_b64_tr_b16 v[26:27], v246 offset:2048
    ds_read_b64_tr_b16 v[28:29], v246 offset:4096
    ds_read_b64_tr_b16 v[30:31], v246 offset:6144
    s_waitcnt lgkmcnt(0)
    s_barrier
    ds_read_b64_tr_b16 v[32:33], v246 offset:8192
    ds_read_b64_tr_b16 v[34:35], v246 offset:10240
    ds_read_b64_tr_b16 v[36:37], v246 offset:12288
    ds_read_b64_tr_b16 v[38:39], v246 offset:14336
    s_waitcnt lgkmcnt(0)
    s_barrier
    ds_read_b64_tr_b16 v[120:121], v246 offset:16384
    ds_read_b64_tr_b16 v[122:123], v246 offset:18432
    ds_read_b64_tr_b16 v[124:125], v246 offset:20480
    ds_read_b64_tr_b16 v[126:127], v246 offset:22528
    s_waitcnt lgkmcnt(0)
    s_barrier
    ds_read_b64_tr_b16 v[128:129], v246 offset:24576
    ds_read_b64_tr_b16 v[130:131], v246 offset:26624
    ds_read_b64_tr_b16 v[132:133], v246 offset:28672
    ds_read_b64_tr_b16 v[134:135], v246 offset:30720
    s_waitcnt lgkmcnt(0)
    s_barrier
    ds_read_b64_tr_b16 v[136:137], v246 offset:0
    ds_read_b64_tr_b16 v[138:139], v246 offset:2048
    ds_read_b64_tr_b16 v[140:141], v246 offset:4096
    ds_read_b64_tr_b16 v[142:143], v246 offset:6144
    s_waitcnt lgkmcnt(0)
    s_barrier
    ds_read_b64_tr_b16 v[144:145], v246 offset:8192
    ds_read_b64_tr_b16 v[146:147], v246 offset:10240
    ds_read_b64_tr_b16 v[148:149], v246 offset:12288
    ds_read_b64_tr_b16 v[150:151], v246 offset:14336
    s_waitcnt lgkmcnt(0)
    s_barrier
    ds_read_b64_tr_b16 v[152:153], v246 offset:16384
    ds_read_b64_tr_b16 v[154:155], v246 offset:18432
    ds_read_b64_tr_b16 v[156:157], v246 offset:20480
    ds_read_b64_tr_b16 v[158:159], v246 offset:22528
    s_waitcnt lgkmcnt(0)
    s_barrier
    ds_read_b64_tr_b16 v[80:81], v246 offset:24576
    ds_read_b64_tr_b16 v[82:83], v246 offset:26624
    ds_read_b64_tr_b16 v[84:85], v246 offset:28672
    ds_read_b64_tr_b16 v[86:87], v246 offset:30720
    s_waitcnt lgkmcnt(0)
    s_barrier
    ds_read_b64_tr_b16 v[88:89], v246 offset:0
    ds_read_b64_tr_b16 v[90:91], v246 offset:2048
    ds_read_b64_tr_b16 v[92:93], v246 offset:4096
    ds_read_b64_tr_b16 v[94:95], v246 offset:6144
    s_waitcnt lgkmcnt(0)
    s_barrier
    ds_read_b64_tr_b16 v[96:97], v246 offset:8192
    ds_read_b64_tr_b16 v[98:99], v246 offset:10240
    ds_read_b64_tr_b16 v[100:101], v246 offset:12288
    ds_read_b64_tr_b16 v[102:103], v246 offset:14336
    s_waitcnt lgkmcnt(0)
    s_barrier
    ds_read_b64_tr_b16 v[104:105], v246 offset:16384
    ds_read_b64_tr_b16 v[106:107], v246 offset:18432
    ds_read_b64_tr_b16 v[108:109], v246 offset:20480
    ds_read_b64_tr_b16 v[110:111], v246 offset:22528
    s_waitcnt lgkmcnt(0)
    s_barrier
    ds_read_b64_tr_b16 v[112:113], v246 offset:24576
    ds_read_b64_tr_b16 v[114:115], v246 offset:26624
    ds_read_b64_tr_b16 v[116:117], v246 offset:28672
    ds_read_b64_tr_b16 v[118:119], v246 offset:30720
    s_waitcnt lgkmcnt(0)
    s_branch REC_qkd
REC_qk3:
    s_barrier
    ds_read_b64_tr_b16 v[20:21], v246 offset:0
    ds_read_b64_tr_b16 v[22:23], v246 offset:2048
    ds_read_b64_tr_b16 v[24:25], v246 offset:4096
    ds_read_b64_tr_b16 v[26:27], v246 offset:6144
    s_waitcnt lgkmcnt(0)
    s_barrier
    ds_read_b64_tr_b16 v[28:29], v246 offset:8192
    ds_read_b64_tr_b16 v[30:31], v246 offset:10240
    ds_read_b64_tr_b16 v[32:33], v246 offset:12288
    ds_read_b64_tr_b16 v[34:35], v246 offset:14336
    s_waitcnt lgkmcnt(0)
    s_barrier
    ds_read_b64_tr_b16 v[36:37], v246 offset:16384
    ds_read_b64_tr_b16 v[38:39], v246 offset:18432
    ds_read_b64_tr_b16 v[40:41], v246 offset:20480
    ds_read_b64_tr_b16 v[42:43], v246 offset:22528
    s_waitcnt lgkmcnt(0)
    s_barrier
    ds_read_b64_tr_b16 v[44:45], v246 offset:24576
    ds_read_b64_tr_b16 v[46:47], v246 offset:26624
    ds_read_b64_tr_b16 v[48:49], v246 offset:28672
    ds_read_b64_tr_b16 v[50:51], v246 offset:30720
    s_waitcnt lgkmcnt(0)
    s_barrier
    ds_read_b64_tr_b16 v[52:53], v246 offset:0
    ds_read_b64_tr_b16 v[54:55], v246 offset:2048
    ds_read_b64_tr_b16 v[56:57], v246 offset:4096
    ds_read_b64_tr_b16 v[58:59], v246 offset:6144
    s_waitcnt lgkmcnt(0)
    s_barrier
    ds_read_b64_tr_b16 v[60:61], v246 offset:8192
    ds_read_b64_tr_b16 v[62:63], v246 offset:10240
    ds_read_b64_tr_b16 v[64:65], v246 offset:12288
    ds_read_b64_tr_b16 v[66:67], v246 offset:14336
    s_waitcnt lgkmcnt(0)
    s_barrier
    ds_read_b64_tr_b16 v[68:69], v246 offset:16384
    ds_read_b64_tr_b16 v[70:71], v246 offset:18432
    ds_read_b64_tr_b16 v[72:73], v246 offset:20480
    ds_read_b64_tr_b16 v[74:75], v246 offset:22528
    s_waitcnt lgkmcnt(0)
    s_barrier
    ds_read_b64_tr_b16 v[76:77], v246 offset:24576
    ds_read_b64_tr_b16 v[78:79], v246 offset:26624
    ds_read_b64_tr_b16 v[0:1], v246 offset:28672
    ds_read_b64_tr_b16 v[2:3], v246 offset:30720
    s_waitcnt lgkmcnt(0)
    s_barrier
    ds_read_b64_tr_b16 v[4:5], v246 offset:0
    ds_read_b64_tr_b16 v[6:7], v246 offset:2048
    ds_read_b64_tr_b16 v[8:9], v246 offset:4096
    ds_read_b64_tr_b16 v[10:11], v246 offset:6144
    s_waitcnt lgkmcnt(0)
    s_barrier
    ds_read_b64_tr_b16 v[12:13], v246 offset:8192
    ds_read_b64_tr_b16 v[14:15], v246 offset:10240
    ds_read_b64_tr_b16 v[16:17], v246 offset:12288
    ds_read_b64_tr_b16 v[18:19], v246 offset:14336
    s_waitcnt lgkmcnt(0)
    s_barrier
    ds_read_b64_tr_b16 v[100:101], v246 offset:16384
    ds_read_b64_tr_b16 v[102:103], v246 offset:18432
    ds_read_b64_tr_b16 v[104:105], v246 offset:20480
    ds_read_b64_tr_b16 v[106:107], v246 offset:22528
    s_waitcnt lgkmcnt(0)
    s_barrier
    ds_read_b64_tr_b16 v[108:109], v246 offset:24576
    ds_read_b64_tr_b16 v[110:111], v246 offset:26624
    ds_read_b64_tr_b16 v[112:113], v246 offset:28672
    ds_read_b64_tr_b16 v[114:115], v246 offset:30720
    s_waitcnt lgkmcnt(0)
    s_barrier
    ds_read_b64_tr_b16 v[116:117], v246 offset:0
    ds_read_b64_tr_b16 v[118:119], v246 offset:2048
    ds_read_b64_tr_b16 v[120:121], v246 offset:4096
    ds_read_b64_tr_b16 v[122:123], v246 offset:6144
    s_waitcnt lgkmcnt(0)
    s_barrier
    ds_read_b64_tr_b16 v[124:125], v246 offset:8192
    ds_read_b64_tr_b16 v[126:127], v246 offset:10240
    ds_read_b64_tr_b16 v[128:129], v246 offset:12288
    ds_read_b64_tr_b16 v[130:131], v246 offset:14336
    s_waitcnt lgkmcnt(0)
    s_barrier
    ds_read_b64_tr_b16 v[132:133], v246 offset:16384
    ds_read_b64_tr_b16 v[134:135], v246 offset:18432
    ds_read_b64_tr_b16 v[136:137], v246 offset:20480
    ds_read_b64_tr_b16 v[138:139], v246 offset:22528
    s_waitcnt lgkmcnt(0)
    s_barrier
    ds_read_b64_tr_b16 v[140:141], v246 offset:24576
    ds_read_b64_tr_b16 v[142:143], v246 offset:26624
    ds_read_b64_tr_b16 v[144:145], v246 offset:28672
    ds_read_b64_tr_b16 v[146:147], v246 offset:30720
    s_waitcnt lgkmcnt(0)
    s_barrier
    ds_read_b64_tr_b16 v[148:149], v246 offset:0
    ds_read_b64_tr_b16 v[150:151], v246 offset:2048
    ds_read_b64_tr_b16 v[152:153], v246 offset:4096
    ds_read_b64_tr_b16 v[154:155], v246 offset:6144
    s_waitcnt lgkmcnt(0)
    s_barrier
    ds_read_b64_tr_b16 v[156:157], v246 offset:8192
    ds_read_b64_tr_b16 v[158:159], v246 offset:10240
    ds_read_b64_tr_b16 v[80:81], v246 offset:12288
    ds_read_b64_tr_b16 v[82:83], v246 offset:14336
    s_waitcnt lgkmcnt(0)
    s_barrier
    ds_read_b64_tr_b16 v[84:85], v246 offset:16384
    ds_read_b64_tr_b16 v[86:87], v246 offset:18432
    ds_read_b64_tr_b16 v[88:89], v246 offset:20480
    ds_read_b64_tr_b16 v[90:91], v246 offset:22528
    s_waitcnt lgkmcnt(0)
    s_barrier
    ds_read_b64_tr_b16 v[92:93], v246 offset:24576
    ds_read_b64_tr_b16 v[94:95], v246 offset:26624
    ds_read_b64_tr_b16 v[96:97], v246 offset:28672
    ds_read_b64_tr_b16 v[98:99], v246 offset:30720
    s_waitcnt lgkmcnt(0)
REC_qkd:
    s_mul_i32 s40, s23, 2560
    v_add_u32 v225, s40, v243
    v_lshl_add_u32 v224, v253, 9, v225
    s_lshl_b32 s41, s56, 10
    v_lshl_add_u32 v160, v253, 4, v252
    v_lshlrev_b32 v228, 4, v160
    v_and_b32 v161, 1, v251
    v_lshrrev_b32 v162, 1, v251
    v_lshl_add_u32 v228, v161, 9, v228
    v_lshl_add_u32 v228, v162, 3, v228
    v_add_u32 v228, s41, v228
    s_lshl_b32 s41, s23, 8
    s_add_u32 s41, s41, 30720
    v_lshlrev_b32 v231, 7, v161
    v_lshl_add_u32 v231, v252, 4, v231
    v_lshl_add_u32 v231, v162, 3, v231
    v_add_u32 v231, s41, v231
    v_cmp_eq_u32 vcc, 0, v253
    s_lshl_b32 s40, s17, 10
    v_add_u32 v229, s40, v249
    s_mul_i32 s40, s17, 3072
    v_add_u32 v248, s40, v249
    s_lshl_b32 s40, s17, 2
    v_add_u32 v240, s40, v249
    s_mul_i32 s40, s21, 2048
    s_cmp_ge_u32 s17, 2
    s_cbranch_scc1 REC_sst2
    v_lshl_add_u32 v230, v251, 4, v252
    s_lshl_b32 s41, s17, 3
    v_add_u32 v230, s41, v230
    s_cmp_eq_u32 s22, 2
    s_cbranch_scc1 REC_sstc2
    s_lshl_b32 s41, s22, 3
    s_add_u32 s40, s40, s41
    v_lshlrev_b32 v230, 4, v230
    s_branch REC_sstc
REC_sstc2:
    s_add_u32 s40, s40, 1024
    v_lshlrev_b32 v230, 3, v230
REC_sstc:
    v_add_u32 v230, s40, v230
    v_cndmask_b32 v230, v242, v230, vcc
    s_branch REC_sstd
REC_sst2:
    s_lshl_b32 s41, s22, 2
    s_add_u32 s40, s40, s41
    s_add_u32 s40, s40, 1536
    v_lshlrev_b32 v230, 4, v252
    v_lshl_add_u32 v230, v251, 8, v230
    v_add_u32 v230, s40, v230
    v_cndmask_b32 v230, v242, v230, vcc
    v_cmp_gt_u32 vcc, 2, v251
    s_nop 1
    v_cndmask_b32 v230, v242, v230, vcc
REC_sstd:
    s_add_u32 s40, s23, 1
    s_and_b32 s40, s40, 3
    s_mul_i32 s40, s40, 2560
    s_add_u32 s40, s40, 0
    v_add_u32 v232, s40, v243
    s_add_u32 s40, s23, 2
    s_and_b32 s40, s40, 3
    s_mul_i32 s40, s40, 2560
    s_add_u32 s40, s40, 0
    v_add_u32 v233, s40, v243
    s_add_u32 s40, s23, 3
    s_and_b32 s40, s40, 3
    s_mul_i32 s40, s40, 2560
    s_add_u32 s40, s40, 0
    v_add_u32 v234, s40, v243
    s_mul_i32 s40, s23, 2048
    v_add_u32 v235, s40, v249
    v_lshlrev_b32 v236, 3, v255
    v_add_u32 v236, s40, v236
    v_add_u32 v237, s40, v243
    v_lshlrev_b32 v238, 9, v251
    v_lshl_add_u32 v238, v250, 4, v238
    s_lshl_b32 s36, s19, 2
    s_mul_i32 s36, s36, 40960
    s_add_u32 s36, s36, 91226112
    s_min_u32 s40, s20, 9
    s_lshl_b32 s40, s40, 12
    s_add_u32 s36, s36, s40
    s_lshr_b32 s40, s23, 1
    s_lshl_b32 s40, s40, 11
    s_add_u32 s36, s36, s40
    s_and_b32 s40, s23, 1
    s_lshl_b32 s40, s40, 8
    s_add_u32 s36, s36, s40
    s_mul_i32 s40, s19, 10240
    s_lshl_b32 s41, s20, 10
    s_add_u32 s40, s40, s41
    s_lshl_b32 s41, s23, 8
    s_add_u32 s40, s40, s41
    v_lshlrev_b32 v239, 6, v251
    v_lshl_add_u32 v239, v252, 3, v239
    v_add_u32 v239, s40, v239
    v_lshrrev_b32 v160, 13, v239
    v_lshlrev_b32 v160, 13, v160
    v_add_u32 v239, v239, v160
    v_cmp_eq_u32 vcc, 0, v253
    s_nop 1
    v_cndmask_b32 v239, v242, v239, vcc
    s_mov_b32 s53, 0x3dd53b95
    v_lshrrev_b32 v160, 3, v255
    v_mul_u32_u24 v226, 10240, v160
    s_lshl_b32 s40, s55, 9
    s_lshl_b32 s41, s23, 7
    s_add_u32 s41, s41, s40
    v_add_u32 v226, s41, v226
    v_lshl_add_u32 v226, v252, 4, v226
    v_lshrrev_b32 v161, 13, v226
    v_lshlrev_b32 v161, 13, v161
    v_add_u32 v226, v226, v161
    v_lshrrev_b32 v160, 2, v252
    s_lshl_b32 s41, s23, 1
    v_add_u32 v160, s41, v160
    v_and_b32 v161, 3, v160
    v_lshlrev_b32 v227, 7, v161
    v_lshrrev_b32 v161, 2, v160
    v_lshl_add_u32 v227, v161, 3, v227
    v_and_b32 v161, 3, v255
    v_lshl_add_u32 v227, v161, 5, v227
    v_lshrrev_b32 v161, 5, v255
    v_lshl_add_u32 v227, v161, 4, v227
    v_bfe_u32 v161, v255, 4, 1
    v_lshl_add_u32 v227, v161, 2, v227
    v_add_u32 v227, s40, v227
    v_cmp_eq_u32 vcc, 0, v253
    s_nop 1
    v_cndmask_b32 v227, v242, v227, vcc
    v_and_b32 v161, 7, v255
    v_lshlrev_b32 v161, 5, v161
    s_mov_b32 s73, 3000000
CEN_19:
    buffer_load_dword v160, v161, s[68:71], 0 offen sc1
    s_mov_b32 s39, 1
    s_sub_u32 s73, s73, 1
    s_cbranch_scc1 CEN_19_ok
    s_waitcnt vmcnt(0)
    v_cmp_ne_u32 vcc, 32, v160
    s_cbranch_vccz CEN_19_ok
    s_mov_b32 s72, 0
    v_readlane_b32 s75, v160, 0
    s_add_u32 s72, s72, s75
    s_cmp_lt_u32 s75, 32
    s_cselect_b32 s39, 0, s39
    v_readlane_b32 s75, v160, 1
    s_add_u32 s72, s72, s75
    s_cmp_lt_u32 s75, 32
    s_cselect_b32 s39, 0, s39
    v_readlane_b32 s75, v160, 2
    s_add_u32 s72, s72, s75
    s_cmp_lt_u32 s75, 32
    s_cselect_b32 s39, 0, s39
    v_readlane_b32 s75, v160, 3
    s_add_u32 s72, s72, s75
    s_cmp_lt_u32 s75, 32
    s_cselect_b32 s39, 0, s39
    v_readlane_b32 s75, v160, 4
    s_add_u32 s72, s72, s75
    v_readlane_b32 s75, v160, 5
    s_add_u32 s72, s72, s75
    v_readlane_b32 s75, v160, 6
    s_add_u32 s72, s72, s75
    v_readlane_b32 s75, v160, 7
    s_add_u32 s72, s72, s75
    s_cmp_ge_u32 s72, 256
    s_cbranch_scc1 CEN_19_ok
    s_sleep 4
    s_branch CEN_19
CEN_19_ok:
    s_waitcnt vmcnt(0)
    v_mov_b32 v164, 0
    s_mov_b32 s73, 3000000
    s_mov_b32 s93, 0
WINI_20:
    buffer_load_dwordx4 v[160:163], v164, s[68:71], 0 offen sc1
    s_sub_u32 s73, s73, 1
    s_cbranch_scc1 WINI_20_ok
    s_waitcnt vmcnt(0)
    v_readfirstlane_b32 s72, v161
    s_cmp_lt_u32 s72, 64
    s_cbranch_scc1 WINI_20_sl
    v_readfirstlane_b32 s93, v163
    s_cmp_lg_u32 s93, 0
    s_cbranch_scc1 WINI_20_ok
WINI_20_sl:
    s_sleep 24
    s_branch WINI_20
WINI_20_ok:
    s_waitcnt vmcnt(0)
    s_and_b32 s93, s93, 8192
    s_mov_b32 s41, s93
    s_and_b32 s41, s41, 8192
    s_add_u32 s24, s24, s41
    s_mul_i32 s35, s25, 12288
    s_add_u32 s35, s35, 34603008
    s_barrier
    s_waitcnt lgkmcnt(0)
    s_cmp_eq_u32 s17, 1
    s_waitcnt lgkmcnt(0)
    s_setprio 3
    s_cmp_eq_u32 s39, 0
    s_cbranch_scc1 RECB_loopA
REC_loopA:
    s_and_b32 s40, s27, 3
    s_add_u32 s41, s27, 2
    s_and_b32 s41, s41, 3
    s_mul_i32 s28, s40, 65536
    s_add_u32 s28, s28, s47
    s_mul_i32 s29, s41, 65536
    s_add_u32 s29, s29, s47
    s_mul_i32 s30, s40, 163840
    s_add_u32 s30, s30, s24
    s_mul_i32 s31, s41, 163840
    s_add_u32 s31, s31, s24
    s_mul_i32 s32, s40, 40960
    s_add_u32 s32, s32, s48
    s_add_u32 s41, s27, 1
    s_and_b32 s41, s41, 3
    s_mul_i32 s33, s41, 40960
    s_add_u32 s33, s33, s48
    s_add_u32 s41, s27, 3
    s_and_b32 s41, s41, 3
    s_mul_i32 s34, s41, 40960
    s_add_u32 s34, s34, s48
REC_poll_21:
    buffer_load_dwordx4 v[160:163], v224, s[12:15], s32 offen sc1
    buffer_load_dwordx4 v[164:167], v224, s[12:15], s32 offen offset:1024 sc1
    buffer_load_dwordx4 v[168:171], v225, s[12:15], s32 offen offset:2048 sc1
    s_sub_u32 s46, s46, 1
    s_cbranch_scc1 REC_pdone_22_x
    s_waitcnt vmcnt(0)
    v_max3_u32 v198, v160, v161, v162
    v_max3_u32 v198, v198, v163, v164
    v_max3_u32 v198, v198, v165, v166
    v_max3_u32 v198, v198, v167, v168
    v_max3_u32 v198, v198, v169, v170
    v_max_u32 v198, v198, v171
    v_cmp_eq_u32 vcc, -1, v198
    s_cbranch_vccnz REC_poll_21
    s_branch REC_pdone_22
REC_pdone_22_x:
    s_mov_b32 s46, 0
    s_waitcnt vmcnt(0)
REC_pdone_22:
    ds_write_b128 v224, v[160:163] offset:0
    ds_write_b128 v224, v[164:167] offset:1024
    ds_write_b128 v225, v[168:171] offset:2048
    v_mfma_f32_16x16x32_bf16 v[200:203], v[0:3], v[160:163], 0
    v_mfma_f32_16x16x32_bf16 v[204:207], v[80:83], v[160:163], 0
    v_mov_b32_dpp v172, v160 row_ror:8 row_mask:0xf bank_mask:0xf
    v_mov_b32_dpp v173, v161 row_ror:8 row_mask:0xf bank_mask:0xf
    v_mov_b32_dpp v174, v162 row_ror:8 row_mask:0xf bank_mask:0xf
    v_mov_b32_dpp v175, v163 row_ror:8 row_mask:0xf bank_mask:0xf
    v_mfma_f32_16x16x32_bf16 v[200:203], v[8:11], v[164:167], v[200:203]
    v_mfma_f32_16x16x32_bf16 v[204:207], v[88:91], v[164:167], v[204:207]
    v_mov_b32_dpp v176, v164 row_ror:8 row_mask:0xf bank_mask:0xf
    v_mov_b32_dpp v177, v165 row_ror:8 row_mask:0xf bank_mask:0xf
    v_mov_b32_dpp v178, v166 row_ror:8 row_mask:0xf bank_mask:0xf
    v_mov_b32_dpp v179, v167 row_ror:8 row_mask:0xf bank_mask:0xf
    s_waitcnt lgkmcnt(0)
    s_barrier
    ds_read_b128 v[180:183], v232 offset:0
    ds_read_b128 v[184:187], v232 offset:512
    ds_read_b128 v[188:191], v232 offset:1024
    ds_read_b128 v[192:195], v232 offset:1536
    v_mfma_f32_16x16x32_bf16 v[200:203], v[16:19], v[168:171], v[200:203]
    v_mfma_f32_16x16x32_bf16 v[204:207], v[96:99], v[168:171], v[204:207]
    v_mfma_f32_16x16x32_bf16 v[200:203], v[4:7], v[172:175], v[200:203]
    v_mfma_f32_16x16x32_bf16 v[204:207], v[84:87], v[172:175], v[204:207]
    v_mfma_f32_16x16x32_bf16 v[200:203], v[12:15], v[176:179], v[200:203]
    v_mfma_f32_16x16x32_bf16 v[204:207], v[92:95], v[176:179], v[204:207]
    s_waitcnt lgkmcnt(3)
    v_mfma_f32_16x16x32_bf16 v[200:203], v[20:23], v[180:183], v[200:203]
    v_mfma_f32_16x16x32_bf16 v[204:207], v[100:103], v[180:183], v[204:207]
    ds_read_b128 v[196:199], v232 offset:2048
    buffer_load_dwordx2 v[244:245], v228, s[12:15], s35 offen
    s_waitcnt lgkmcnt(3)
    v_mfma_f32_16x16x32_bf16 v[200:203], v[24:27], v[184:187], v[200:203]
    v_mfma_f32_16x16x32_bf16 v[204:207], v[104:107], v[184:187], v[204:207]
    ds_read_b128 v[180:183], v233 offset:0
    buffer_load_dwordx2 v[246:247], v228, s[12:15], s35 offen offset:128
    s_waitcnt lgkmcnt(3)
    v_mfma_f32_16x16x32_bf16 v[200:203], v[28:31], v[188:191], v[200:203]
    v_mfma_f32_16x16x32_bf16 v[204:207], v[108:111], v[188:191], v[204:207]
    ds_read_b128 v[184:187], v233 offset:512
    s_add_u32 s35, s35, 393216
    s_waitcnt lgkmcnt(3)
    v_mfma_f32_16x16x32_bf16 v[200:203], v[32:35], v[192:195], v[200:203]
    v_mfma_f32_16x16x32_bf16 v[204:207], v[112:115], v[192:195], v[204:207]
    ds_read_b128 v[188:191], v233 offset:1024
    s_add_u32 s40, s36, 0
    buffer_load_dwordx4 v[208:211], v238, s[12:15], s40 offen
    s_waitcnt lgkmcnt(3)
    v_mfma_f32_16x16x32_bf16 v[200:203], v[36:39], v[196:199], v[200:203]
    v_mfma_f32_16x16x32_bf16 v[204:207], v[116:119], v[196:199], v[204:207]
    ds_read_b128 v[192:195], v233 offset:1536
    s_add_u32 s40, s36, 40960
    buffer_load_dwordx4 v[212:215], v238, s[12:15], s40 offen
    s_waitcnt lgkmcnt(3)
    v_mfma_f32_16x16x32_bf16 v[200:203], v[40:43], v[180:183], v[200:203]
    v_mfma_f32_16x16x32_bf16 v[204:207], v[120:123], v[180:183], v[204:207]
    ds_read_b128 v[196:199], v233 offset:2048
    s_add_u32 s40, s36, 81920
    buffer_load_dwordx4 v[216:219], v238, s[12:15], s40 offen
    s_waitcnt lgkmcnt(3)
    v_mfma_f32_16x16x32_bf16 v[200:203], v[44:47], v[184:187], v[200:203]
    v_mfma_f32_16x16x32_bf16 v[204:207], v[124:127], v[184:187], v[204:207]
    ds_read_b128 v[180:183], v234 offset:0
    s_add_u32 s40, s36, 122880
    buffer_load_dwordx4 v[220:223], v238, s[12:15], s40 offen
    s_waitcnt lgkmcnt(3)
    v_mfma_f32_16x16x32_bf16 v[200:203], v[48:51], v[188:191], v[200:203]
    v_mfma_f32_16x16x32_bf16 v[204:207], v[128:131], v[188:191], v[204:207]
    ds_read_b128 v[184:187], v234 offset:512
    s_add_u32 s36, s36, 1310720
    s_waitcnt lgkmcnt(3)
    v_mfma_f32_16x16x32_bf16 v[200:203], v[52:55], v[192:195], v[200:203]
    v_mfma_f32_16x16x32_bf16 v[204:207], v[132:135], v[192:195], v[204:207]
    ds_read_b128 v[188:191], v234 offset:1024
    s_waitcnt lgkmcnt(3)
    v_mfma_f32_16x16x32_bf16 v[200:203], v[56:59], v[196:199], v[200:203]
    v_mfma_f32_16x16x32_bf16 v[204:207], v[136:139], v[196:199], v[204:207]
    ds_read_b128 v[192:195], v234 offset:1536
    s_waitcnt lgkmcnt(3)
    v_mfma_f32_16x16x32_bf16 v[200:203], v[60:63], v[180:183], v[200:203]
    v_mfma_f32_16x16x32_bf16 v[204:207], v[140:143], v[180:183], v[204:207]
    ds_read_b128 v[196:199], v234 offset:2048
    s_waitcnt lgkmcnt(3)
    v_mfma_f32_16x16x32_bf16 v[200:203], v[64:67], v[184:187], v[200:203]
    v_mfma_f32_16x16x32_bf16 v[204:207], v[144:147], v[184:187], v[204:207]
    s_waitcnt lgkmcnt(2)
    v_mfma_f32_16x16x32_bf16 v[200:203], v[68:71], v[188:191], v[200:203]
    v_mfma_f32_16x16x32_bf16 v[204:207], v[148:151], v[188:191], v[204:207]
    s_waitcnt lgkmcnt(1)
    v_mfma_f32_16x16x32_bf16 v[200:203], v[72:75], v[192:195], v[200:203]
    v_mfma_f32_16x16x32_bf16 v[204:207], v[152:155], v[192:195], v[204:207]
    s_waitcnt lgkmcnt(0)
    v_mfma_f32_16x16x32_bf16 v[200:203], v[76:79], v[196:199], v[200:203]
    v_mfma_f32_16x16x32_bf16 v[204:207], v[156:159], v[196:199], v[204:207]
    s_nop 6
    v_cvt_pk_bf16_f32 v192, v200, v201
    v_cvt_pk_bf16_f32 v193, v202, v203
    v_cvt_pk_bf16_f32 v194, v204, v205
    v_cvt_pk_bf16_f32 v195, v206, v207
    s_waitcnt vmcnt(4)
    v_mfma_f32_16x16x16_bf16 v[160:163], v[244:245], v[192:193], 0
    v_mfma_f32_16x16x16_bf16 v[164:167], v[246:247], v[192:193], 0
    v_mfma_f32_16x16x16_bf16 v[168:171], v[194:195], v[192:193], 0
    s_nop 5
    ds_write_b128 v248, v[160:163] offset:10240
    ds_write_b128 v248, v[164:167] offset:11264
    ds_write_b128 v248, v[168:171] offset:12288
    s_waitcnt lgkmcnt(0)
    s_barrier
    s_cmp_eq_u32 s17, 3
    s_cbranch_scc1 REC_std
    ds_read_b128 v[160:163], v229 offset:10240
    ds_read_b128 v[164:167], v229 offset:13312
    ds_read_b128 v[172:175], v229 offset:16384
    ds_read_b128 v[176:179], v229 offset:19456
    s_waitcnt lgkmcnt(2)
    v_add_f32 v160, v160, v164
    v_add_f32 v161, v161, v165
    v_add_f32 v162, v162, v166
    v_add_f32 v163, v163, v167
    s_waitcnt lgkmcnt(0)
    v_add_f32 v172, v172, v176
    v_add_f32 v173, v173, v177
    v_add_f32 v174, v174, v178
    v_add_f32 v175, v175, v179
    v_add_f32 v160, v160, v172
    v_add_f32 v161, v161, v173
    v_add_f32 v162, v162, v174
    v_add_f32 v163, v163, v175
    v_cvt_pk_bf16_f32 v172, v160, v161
    v_cvt_pk_bf16_f32 v173, v162, v163
    v_min_u32 v172, s49, v172
    v_min_u32 v173, s49, v173
    s_cmp_eq_u32 s17, 2
    s_cbranch_scc1 REC_st2
    buffer_store_dwordx2 v[172:173], v230, s[12:15], s28 offen
    s_branch REC_std
REC_st2:
    buffer_store_dword v172, v230, s[12:15], s28 offen
    buffer_store_dword v173, v230, s[12:15], s28 offen offset:128
REC_std:
    s_mov_b64 exec, s[44:45]
    ds_write_b64 v231, v[194:195]
    s_mov_b64 exec, -1
    s_cmp_ge_u32 s20, 10
    s_cbranch_scc1 REC_endA
    s_sleep 3
REC_poll_23:
    buffer_load_dwordx4 v[160:163], v235, s[12:15], s28 offen sc1
    buffer_load_dwordx2 v[164:165], v236, s[12:15], s28 offen offset:1024 sc1
    buffer_load_dwordx3 v[166:168], v237, s[12:15], s28 offen offset:1536 sc1
    s_sub_u32 s46, s46, 1
    s_cbranch_scc1 REC_pdone_24_x
    s_waitcnt vmcnt(0)
    v_max3_u32 v198, v160, v161, v162
    v_max3_u32 v198, v198, v163, v164
    v_max3_u32 v198, v198, v165, v166
    v_max3_u32 v198, v198, v167, v168
    v_cmp_eq_u32 vcc, -1, v198
    s_cbranch_vccnz REC_poll_23
    s_branch REC_pdone_24
REC_pdone_24_x:
    s_mov_b32 s46, 0
    s_waitcnt vmcnt(0)
REC_pdone_24:
    v_lshlrev_b32 v172, 16, v160
    v_and_b32 v173, 0xffff0000, v160
    v_lshlrev_b32 v174, 16, v161
    v_and_b32 v175, 0xffff0000, v161
    v_lshlrev_b32 v176, 16, v162
    v_and_b32 v177, 0xffff0000, v162
    v_lshlrev_b32 v178, 16, v163
    v_and_b32 v179, 0xffff0000, v163
    v_lshlrev_b32 v180, 16, v164
    v_and_b32 v181, 0xffff0000, v164
    v_lshlrev_b32 v182, 16, v165
    v_and_b32 v183, 0xffff0000, v165
    v_lshlrev_b32 v184, 16, v166
    v_and_b32 v185, 0xffff0000, v166
    v_lshlrev_b32 v186, 16, v167
    v_and_b32 v187, 0xffff0000, v167
    v_lshlrev_b32 v188, 16, v168
    v_and_b32 v189, 0xffff0000, v168
    v_add_f32 v172, v172, v176
    v_add_f32 v173, v173, v177
    v_add_f32 v174, v174, v178
    v_add_f32 v175, v175, v179
    v_add_f32 v176, v184, v186
    v_add_f32 v177, v185, v187
    v_add_f32 v172, v172, v180
    v_add_f32 v173, v173, v181
    v_add_f32 v174, v174, v182
    v_add_f32 v175, v175, v183
    v_add_f32 v176, v176, v188
    v_add_f32 v177, v177, v189
    v_max3_f32 v198, v172, v173, v174
    v_max3_f32 v199, v175, v176, v177
    v_max_f32 v198, v198, v199
    s_nop 1
    v_max_f32_dpp v198, v198, v198 row_ror:8 row_mask:0xf bank_mask:0xf
    v_mov_b32 v199, v198
    s_nop 1
    v_permlane32_swap_b32 v198, v199
    v_max_f32 v198, v198, v199
    v_mov_b32 v199, v198
    s_nop 1
    v_permlane16_swap_b32 v198, v199
    v_max_f32 v198, v198, v199
    v_mul_f32 v198, s53, v198
    v_fma_f32 v172, v172, s53, -v198
    v_fma_f32 v173, v173, s53, -v198
    v_fma_f32 v174, v174, s53, -v198
    v_fma_f32 v175, v175, s53, -v198
    v_fma_f32 v176, v176, s53, -v198
    v_fma_f32 v177, v177, s53, -v198
    v_exp_f32 v172, v172
    v_exp_f32 v173, v173
    v_exp_f32 v174, v174
    v_exp_f32 v175, v175
    v_exp_f32 v176, v176
    v_exp_f32 v177, v177
    v_add_f32 v200, v172, v174
    v_add_f32 v201, v173, v175
    v_add_f32 v199, v176, v177
    v_add_f32 v200, v200, v201
    v_fmac_f32 v200, 0.5, v199
    s_nop 1
    v_add_f32_dpp v200, v200, v200 row_ror:8 row_mask:0xf bank_mask:0xf
    v_mov_b32 v199, v200
    s_nop 1
    v_permlane32_swap_b32 v200, v199
    v_add_f32 v200, v200, v199
    v_mov_b32 v199, v200
    s_nop 1
    v_permlane16_swap_b32 v200, v199
    v_add_f32 v200, v200, v199
    v_rcp_f32 v200, v200
    s_nop 0
    v_mul_f32 v172, v172, v200
    v_mul_f32 v173, v173, v200
    v_mul_f32 v174, v174, v200
    v_mul_f32 v175, v175, v200
    v_mul_f32 v176, v176, v200
    v_mul_f32 v177, v177, v200
    v_cvt_pk_bf16_f32 v192, v172, v173
    v_cvt_pk_bf16_f32 v193, v174, v175
    v_cvt_pk_bf16_f32 v196, v176, v177
    v_mov_b32_dpp v194, v192 row_ror:8 row_mask:0xf bank_mask:0xf
    v_mov_b32_dpp v195, v193 row_ror:8 row_mask:0xf bank_mask:0xf
    ds_write_b32 v240, v196 offset:14336
    ds_write_b128 v229, v[192:195] offset:10240
    s_waitcnt lgkmcnt(0) vmcnt(0)
    s_barrier
    ds_read_b128 v[160:163], v249 offset:10240
    ds_read_b128 v[164:167], v249 offset:11264
    ds_read_b128 v[168:171], v249 offset:12288
    ds_read_b128 v[172:175], v249 offset:13312
    ds_read_b128 v[180:183], v249 offset:14336
    ds_read_b128 v[176:179], v229 offset:22528
    s_waitcnt lgkmcnt(5)
    v_mfma_f32_16x16x32_bf16 v[184:187], v[208:211], v[160:163], 0
    s_waitcnt lgkmcnt(4)
    v_mfma_f32_16x16x32_bf16 v[184:187], v[212:215], v[164:167], v[184:187]
    s_waitcnt lgkmcnt(3)
    v_mfma_f32_16x16x32_bf16 v[184:187], v[216:219], v[168:171], v[184:187]
    s_waitcnt lgkmcnt(2)
    v_mfma_f32_16x16x32_bf16 v[184:187], v[220:223], v[172:175], v[184:187]
    s_waitcnt lgkmcnt(0)
    v_mfma_f32_16x16x32_bf16 v[184:187], v[176:179], v[180:183], v[184:187]
    s_nop 7
    v_cvt_pk_bf16_f32 v198, v184, v185
    v_cvt_pk_bf16_f32 v199, v186, v187
    v_min_u32 v198, s49, v198
    v_min_u32 v199, s49, v199
    buffer_store_dwordx2 v[198:199], v239, s[12:15], s30 offen sc1
    s_sleep 7
    s_cmp_eq_u32 s27, 63
    s_cbranch_scc1 REC_endA
REC_poll_25:
    buffer_load_dwordx4 v[160:163], v226, s[12:15], s30 offen sc1
    s_sub_u32 s46, s46, 1
    s_cbranch_scc1 REC_pdone_26_x
    s_waitcnt vmcnt(0)
    v_max3_u32 v164, v160, v161, v162
    v_max_u32 v164, v164, v163
    v_cmp_eq_u32 vcc, -1, v164
    s_cbranch_vccnz REC_poll_25
    s_branch REC_pdone_26
REC_pdone_26_x:
    s_mov_b32 s46, 0
    s_waitcnt vmcnt(0)
REC_pdone_26:
    v_lshlrev_b32 v164, 16, v160
    v_and_b32 v165, 0xffff0000, v160
    v_lshlrev_b32 v168, 16, v162
    v_and_b32 v169, 0xffff0000, v162
    v_lshlrev_b32 v166, 16, v161
    v_and_b32 v167, 0xffff0000, v161
    v_lshlrev_b32 v170, 16, v163
    v_and_b32 v171, 0xffff0000, v163
    v_permlane32_swap_b32 v164, v168
    v_permlane32_swap_b32 v165, v169
    v_permlane32_swap_b32 v166, v170
    v_permlane32_swap_b32 v167, v171
    v_pk_add_f32 v[164:165], v[164:165], v[168:169]
    v_pk_add_f32 v[166:167], v[166:167], v[170:171]
    s_nop 1
    v_permlane16_swap_b32 v164, v166
    v_permlane16_swap_b32 v165, v167
    v_pk_add_f32 v[164:165], v[164:165], v[166:167]
    s_nop 1
    v_add_f32_dpp v164, v164, v164 row_ror:8 row_mask:0xf bank_mask:0xf
    v_add_f32_dpp v165, v165, v165 row_ror:8 row_mask:0xf bank_mask:0xf
    v_cvt_pk_bf16_f32 v160, v164, v165
    v_min_u32 v160, s49, v160
    buffer_store_dword v160, v227, s[12:15], s33 offen
REC_endA:
    s_add_u32 s27, s27, 1
    s_cmp_lt_u32 s27, 64
    s_cbranch_scc1 REC_loopA
    s_waitcnt lgkmcnt(0)
    s_barrier
    s_barrier
    s_branch REC_done
REC_yw:
    s_cmp_ge_u32 s20, 10
    s_cbranch_scc1 REC_norecv
    v_add_u32 v248, s58, v249
    s_load_dwordx2 s[8:9], s[0:1], 32
    s_mov_b32 s10, 7864320
    s_mov_b32 s11, 0x00020000
    s_mul_i32 s52, s26, 384
    v_add_u32 v237, 0, v255
    v_mul_u32_u24 v238, 2731, v237
    v_lshrrev_b32 v238, 16, v238
    v_mul_u32_u24 v239, 24, v238
    v_sub_u32 v239, v237, v239
    v_and_b32 v240, 7, v238
    v_xor_b32 v239, v239, v240
    v_mul_u32_u24 v238, 12288, v238
    v_lshl_add_u32 v200, v239, 4, v238
    v_add_u32 v237, 64, v255
    v_mul_u32_u24 v238, 2731, v237
    v_lshrrev_b32 v238, 16, v238
    v_mul_u32_u24 v239, 24, v238
    v_sub_u32 v239, v237, v239
    v_and_b32 v240, 7, v238
    v_xor_b32 v239, v239, v240
    v_mul_u32_u24 v238, 12288, v238
    v_lshl_add_u32 v201, v239, 4, v238
    v_add_u32 v237, 128, v255
    v_mul_u32_u24 v238, 2731, v237
    v_lshrrev_b32 v238, 16, v238
    v_mul_u32_u24 v239, 24, v238
    v_sub_u32 v239, v237, v239
    v_and_b32 v240, 7, v238
    v_xor_b32 v239, v239, v240
    v_mul_u32_u24 v238, 12288, v238
    v_lshl_add_u32 v202, v239, 4, v238
    v_add_u32 v237, 192, v255
    v_mul_u32_u24 v238, 2731, v237
    v_lshrrev_b32 v238, 16, v238
    v_mul_u32_u24 v239, 24, v238
    v_sub_u32 v239, v237, v239
    v_and_b32 v240, 7, v238
    v_xor_b32 v239, v239, v240
    v_mul_u32_u24 v238, 12288, v238
    v_lshl_add_u32 v203, v239, 4, v238
    v_add_u32 v237, 256, v255
    v_mul_u32_u24 v238, 2731, v237
    v_lshrrev_b32 v238, 16, v238
    v_mul_u32_u24 v239, 24, v238
    v_sub_u32 v239, v237, v239
    v_and_b32 v240, 7, v238
    v_xor_b32 v239, v239, v240
    v_mul_u32_u24 v238, 12288, v238
    v_lshl_add_u32 v204, v239, 4, v238
    v_add_u32 v237, 320, v255
    v_mul_u32_u24 v238, 2731, v237
    v_lshrrev_b32 v238, 16, v238
    v_mul_u32_u24 v239, 24, v238
    v_sub_u32 v239, v237, v239
    v_and_b32 v240, 7, v238
    v_xor_b32 v239, v239, v240
    v_mul_u32_u24 v238, 12288, v238
    v_lshl_add_u32 v205, v239, 4, v238
    s_waitcnt lgkmcnt(0)
    s_mov_b32 s43, s76
    s_mov_b32 m0, s43
    s_add_u32 s43, s43, 1024
    buffer_load_dwordx4 v200, s[8:11], s52 offen lds
    s_mov_b32 m0, s43
    s_add_u32 s43, s43, 1024
    buffer_load_dwordx4 v201, s[8:11], s52 offen lds
    s_mov_b32 m0, s43
    s_add_u32 s43, s43, 1024
    buffer_load_dwordx4 v202, s[8:11], s52 offen lds
    s_mov_b32 m0, s43
    s_add_u32 s43, s43, 1024
    buffer_load_dwordx4 v203, s[8:11], s52 offen lds
    s_mov_b32 m0, s43
    s_add_u32 s43, s43, 1024
    buffer_load_dwordx4 v204, s[8:11], s52 offen lds
    s_mov_b32 m0, s43
    s_add_u32 s43, s43, 1024
    buffer_load_dwordx4 v205, s[8:11], s52 offen lds
    s_add_u32 s52, s52, 196608
    s_mov_b32 s43, s77
    s_mov_b32 m0, s43
    s_add_u32 s43, s43, 1024
    buffer_load_dwordx4 v200, s[8:11], s52 offen lds
    s_mov_b32 m0, s43
    s_add_u32 s43, s43, 1024
    buffer_load_dwordx4 v201, s[8:11], s52 offen lds
    s_mov_b32 m0, s43
    s_add_u32 s43, s43, 1024
    buffer_load_dwordx4 v202, s[8:11], s52 offen lds
    s_mov_b32 m0, s43
    s_add_u32 s43, s43, 1024
    buffer_load_dwordx4 v203, s[8:11], s52 offen lds
    s_mov_b32 m0, s43
    s_add_u32 s43, s43, 1024
    buffer_load_dwordx4 v204, s[8:11], s52 offen lds
    s_mov_b32 m0, s43
    s_add_u32 s43, s43, 1024
    buffer_load_dwordx4 v205, s[8:11], s52 offen lds
    s_add_u32 s52, s52, 196608
    s_waitcnt vmcnt(6)
    s_barrier
    s_mov_b32 s43, s78
    s_mov_b32 m0, s43
    s_add_u32 s43, s43, 1024
    buffer_load_dwordx4 v200, s[8:11], s52 offen lds
    s_mov_b32 m0, s43
    s_add_u32 s43, s43, 1024
    buffer_load_dwordx4 v201, s[8:11], s52 offen lds
    s_mov_b32 m0, s43
    s_add_u32 s43, s43, 1024
    buffer_load_dwordx4 v202, s[8:11], s52 offen lds
    s_mov_b32 m0, s43
    s_add_u32 s43, s43, 1024
    buffer_load_dwordx4 v203, s[8:11], s52 offen lds
    s_mov_b32 m0, s43
    s_add_u32 s43, s43, 1024
    buffer_load_dwordx4 v204, s[8:11], s52 offen lds
    s_mov_b32 m0, s43
    s_add_u32 s43, s43, 1024
    buffer_load_dwordx4 v205, s[8:11], s52 offen lds
    s_add_u32 s52, s52, 196608
    s_waitcnt vmcnt(6)
    s_barrier
    s_mov_b32 s43, s76
    s_mov_b32 m0, s43
    s_add_u32 s43, s43, 1024
    buffer_load_dwordx4 v200, s[8:11], s52 offen lds
    s_mov_b32 m0, s43
    s_add_u32 s43, s43, 1024
    buffer_load_dwordx4 v201, s[8:11], s52 offen lds
    s_mov_b32 m0, s43
    s_add_u32 s43, s43, 1024
    buffer_load_dwordx4 v202, s[8:11], s52 offen lds
    s_mov_b32 m0, s43
    s_add_u32 s43, s43, 1024
    buffer_load_dwordx4 v203, s[8:11], s52 offen lds
    s_mov_b32 m0, s43
    s_add_u32 s43, s43, 1024
    buffer_load_dwordx4 v204, s[8:11], s52 offen lds
    s_mov_b32 m0, s43
    s_add_u32 s43, s43, 1024
    buffer_load_dwordx4 v205, s[8:11], s52 offen lds
    s_add_u32 s52, s52, 196608
    s_waitcnt vmcnt(6)
    s_barrier
    s_mov_b32 s43, s77
    s_mov_b32 m0, s43
    s_add_u32 s43, s43, 1024
    buffer_load_dwordx4 v200, s[8:11], s52 offen lds
    s_mov_b32 m0, s43
    s_add_u32 s43, s43, 1024
    buffer_load_dwordx4 v201, s[8:11], s52 offen lds
    s_mov_b32 m0, s43
    s_add_u32 s43, s43, 1024
    buffer_load_dwordx4 v202, s[8:11], s52 offen lds
    s_mov_b32 m0, s43
    s_add_u32 s43, s43, 1024
    buffer_load_dwordx4 v203, s[8:11], s52 offen lds
    s_mov_b32 m0, s43
    s_add_u32 s43, s43, 1024
    buffer_load_dwordx4 v204, s[8:11], s52 offen lds
    s_mov_b32 m0, s43
    s_add_u32 s43, s43, 1024
    buffer_load_dwordx4 v205, s[8:11], s52 offen lds
    s_add_u32 s52, s52, 196608
    s_waitcnt vmcnt(6)
    s_barrier
    s_mov_b32 s43, s78
    s_mov_b32 m0, s43
    s_add_u32 s43, s43, 1024
    buffer_load_dwordx4 v200, s[8:11], s52 offen lds
    s_mov_b32 m0, s43
    s_add_u32 s43, s43, 1024
    buffer_load_dwordx4 v201, s[8:11], s52 offen lds
    s_mov_b32 m0, s43
    s_add_u32 s43, s43, 1024
    buffer_load_dwordx4 v202, s[8:11], s52 offen lds
    s_mov_b32 m0, s43
    s_add_u32 s43, s43, 1024
    buffer_load_dwordx4 v203, s[8:11], s52 offen lds
    s_mov_b32 m0, s43
    s_add_u32 s43, s43, 1024
    buffer_load_dwordx4 v204, s[8:11], s52 offen lds
    s_mov_b32 m0, s43
    s_add_u32 s43, s43, 1024
    buffer_load_dwordx4 v205, s[8:11], s52 offen lds
    s_add_u32 s52, s52, 196608
    ds_read_b128 v[0:3], v248 offset:8192
    ds_read_b128 v[4:7], v248 offset:9216
    ds_read_b128 v[8:11], v248 offset:10240
    ds_read_b128 v[12:15], v248 offset:11264
    s_waitcnt lgkmcnt(0)
    s_waitcnt vmcnt(6)
    s_barrier
    s_mov_b32 s43, s76
    s_mov_b32 m0, s43
    s_add_u32 s43, s43, 1024
    buffer_load_dwordx4 v200, s[8:11], s52 offen lds
    s_mov_b32 m0, s43
    s_add_u32 s43, s43, 1024
    buffer_load_dwordx4 v201, s[8:11], s52 offen lds
    s_mov_b32 m0, s43
    s_add_u32 s43, s43, 1024
    buffer_load_dwordx4 v202, s[8:11], s52 offen lds
    s_mov_b32 m0, s43
    s_add_u32 s43, s43, 1024
    buffer_load_dwordx4 v203, s[8:11], s52 offen lds
    s_mov_b32 m0, s43
    s_add_u32 s43, s43, 1024
    buffer_load_dwordx4 v204, s[8:11], s52 offen lds
    s_mov_b32 m0, s43
    s_add_u32 s43, s43, 1024
    buffer_load_dwordx4 v205, s[8:11], s52 offen lds
    s_add_u32 s52, s52, 196608
    s_waitcnt vmcnt(6)
    s_barrier
    s_mov_b32 s43, s77
    s_mov_b32 m0, s43
    s_add_u32 s43, s43, 1024
    buffer_load_dwordx4 v200, s[8:11], s52 offen lds
    s_mov_b32 m0, s43
    s_add_u32 s43, s43, 1024
    buffer_load_dwordx4 v201, s[8:11], s52 offen lds
    s_mov_b32 m0, s43
    s_add_u32 s43, s43, 1024
    buffer_load_dwordx4 v202, s[8:11], s52 offen lds
    s_mov_b32 m0, s43
    s_add_u32 s43, s43, 1024
    buffer_load_dwordx4 v203, s[8:11], s52 offen lds
    s_mov_b32 m0, s43
    s_add_u32 s43, s43, 1024
    buffer_load_dwordx4 v204, s[8:11], s52 offen lds
    s_mov_b32 m0, s43
    s_add_u32 s43, s43, 1024
    buffer_load_dwordx4 v205, s[8:11], s52 offen lds
    s_add_u32 s52, s52, 196608
    ds_read_b128 v[16:19], v248 offset:12288
    ds_read_b128 v[20:23], v248 offset:13312
    ds_read_b128 v[24:27], v248 offset:14336
    ds_read_b128 v[28:31], v248 offset:15360
    s_waitcnt lgkmcnt(0)
    s_waitcnt vmcnt(6)
    s_barrier
    s_mov_b32 s43, s78
    s_mov_b32 m0, s43
    s_add_u32 s43, s43, 1024
    buffer_load_dwordx4 v200, s[8:11], s52 offen lds
    s_mov_b32 m0, s43
    s_add_u32 s43, s43, 1024
    buffer_load_dwordx4 v201, s[8:11], s52 offen lds
    s_mov_b32 m0, s43
    s_add_u32 s43, s43, 1024
    buffer_load_dwordx4 v202, s[8:11], s52 offen lds
    s_mov_b32 m0, s43
    s_add_u32 s43, s43, 1024
    buffer_load_dwordx4 v203, s[8:11], s52 offen lds
    s_mov_b32 m0, s43
    s_add_u32 s43, s43, 1024
    buffer_load_dwordx4 v204, s[8:11], s52 offen lds
    s_mov_b32 m0, s43
    s_add_u32 s43, s43, 1024
    buffer_load_dwordx4 v205, s[8:11], s52 offen lds
    s_add_u32 s52, s52, 196608
    s_waitcnt vmcnt(6)
    s_barrier
    s_mov_b32 s43, s76
    s_mov_b32 m0, s43
    s_add_u32 s43, s43, 1024
    buffer_load_dwordx4 v200, s[8:11], s52 offen lds
    s_mov_b32 m0, s43
    s_add_u32 s43, s43, 1024
    buffer_load_dwordx4 v201, s[8:11], s52 offen lds
    s_mov_b32 m0, s43
    s_add_u32 s43, s43, 1024
    buffer_load_dwordx4 v202, s[8:11], s52 offen lds
    s_mov_b32 m0, s43
    s_add_u32 s43, s43, 1024
    buffer_load_dwordx4 v203, s[8:11], s52 offen lds
    s_mov_b32 m0, s43
    s_add_u32 s43, s43, 1024
    buffer_load_dwordx4 v204, s[8:11], s52 offen lds
    s_mov_b32 m0, s43
    s_add_u32 s43, s43, 1024
    buffer_load_dwordx4 v205, s[8:11], s52 offen lds
    s_add_u32 s52, s52, 196608
    ds_read_b128 v[32:35], v248 offset:8192
    ds_read_b128 v[36:39], v248 offset:9216
    ds_read_b128 v[40:43], v248 offset:10240
    ds_read_b128 v[44:47], v248 offset:11264
    s_waitcnt lgkmcnt(0)
    s_waitcnt vmcnt(6)
    s_barrier
    s_mov_b32 s43, s77
    s_mov_b32 m0, s43
    s_add_u32 s43, s43, 1024
    buffer_load_dwordx4 v200, s[8:11], s52 offen lds
    s_mov_b32 m0, s43
    s_add_u32 s43, s43, 1024
    buffer_load_dwordx4 v201, s[8:11], s52 offen lds
    s_mov_b32 m0, s43
    s_add_u32 s43, s43, 1024
    buffer_load_dwordx4 v202, s[8:11], s52 offen lds
    s_mov_b32 m0, s43
    s_add_u32 s43, s43, 1024
    buffer_load_dwordx4 v203, s[8:11], s52 offen lds
    s_mov_b32 m0, s43
    s_add_u32 s43, s43, 1024
    buffer_load_dwordx4 v204, s[8:11], s52 offen lds
    s_mov_b32 m0, s43
    s_add_u32 s43, s43, 1024
    buffer_load_dwordx4 v205, s[8:11], s52 offen lds
    s_add_u32 s52, s52, 196608
    s_waitcnt vmcnt(6)
    s_barrier
    s_mov_b32 s43, s78
    s_mov_b32 m0, s43
    s_add_u32 s43, s43, 1024
    buffer_load_dwordx4 v200, s[8:11], s52 offen lds
    s_mov_b32 m0, s43
    s_add_u32 s43, s43, 1024
    buffer_load_dwordx4 v201, s[8:11], s52 offen lds
    s_mov_b32 m0, s43
    s_add_u32 s43, s43, 1024
    buffer_load_dwordx4 v202, s[8:11], s52 offen lds
    s_mov_b32 m0, s43
    s_add_u32 s43, s43, 1024
    buffer_load_dwordx4 v203, s[8:11], s52 offen lds
    s_mov_b32 m0, s43
    s_add_u32 s43, s43, 1024
    buffer_load_dwordx4 v204, s[8:11], s52 offen lds
    s_mov_b32 m0, s43
    s_add_u32 s43, s43, 1024
    buffer_load_dwordx4 v205, s[8:11], s52 offen lds
    s_add_u32 s52, s52, 196608
    ds_read_b128 v[48:51], v248 offset:12288
    ds_read_b128 v[52:55], v248 offset:13312
    ds_read_b128 v[56:59], v248 offset:14336
    ds_read_b128 v[60:63], v248 offset:15360
    s_waitcnt lgkmcnt(0)
    s_waitcnt vmcnt(6)
    s_barrier
    s_mov_b32 s43, s76
    s_mov_b32 m0, s43
    s_add_u32 s43, s43, 1024
    buffer_load_dwordx4 v200, s[8:11], s52 offen lds
    s_mov_b32 m0, s43
    s_add_u32 s43, s43, 1024
    buffer_load_dwordx4 v201, s[8:11], s52 offen lds
    s_mov_b32 m0, s43
    s_add_u32 s43, s43, 1024
    buffer_load_dwordx4 v202, s[8:11], s52 offen lds
    s_mov_b32 m0, s43
    s_add_u32 s43, s43, 1024
    buffer_load_dwordx4 v203, s[8:11], s52 offen lds
    s_mov_b32 m0, s43
    s_add_u32 s43, s43, 1024
    buffer_load_dwordx4 v204, s[8:11], s52 offen lds
    s_mov_b32 m0, s43
    s_add_u32 s43, s43, 1024
    buffer_load_dwordx4 v205, s[8:11], s52 offen lds
    s_add_u32 s52, s52, 196608
    s_waitcnt vmcnt(6)
    s_barrier
    s_mov_b32 s43, s77
    s_mov_b32 m0, s43
    s_add_u32 s43, s43, 1024
    buffer_load_dwordx4 v200, s[8:11], s52 offen lds
    s_mov_b32 m0, s43
    s_add_u32 s43, s43, 1024
    buffer_load_dwordx4 v201, s[8:11], s52 offen lds
    s_mov_b32 m0, s43
    s_add_u32 s43, s43, 1024
    buffer_load_dwordx4 v202, s[8:11], s52 offen lds
    s_mov_b32 m0, s43
    s_add_u32 s43, s43, 1024
    buffer_load_dwordx4 v203, s[8:11], s52 offen lds
    s_mov_b32 m0, s43
    s_add_u32 s43, s43, 1024
    buffer_load_dwordx4 v204, s[8:11], s52 offen lds
    s_mov_b32 m0, s43
    s_add_u32 s43, s43, 1024
    buffer_load_dwordx4 v205, s[8:11], s52 offen lds
    s_add_u32 s52, s52, 196608
    ds_read_b128 v[64:67], v248 offset:8192
    ds_read_b128 v[68:71], v248 offset:9216
    ds_read_b128 v[72:75], v248 offset:10240
    ds_read_b128 v[76:79], v248 offset:11264
    s_waitcnt lgkmcnt(0)
    s_waitcnt vmcnt(6)
    s_barrier
    s_mov_b32 s43, s78
    s_mov_b32 m0, s43
    s_add_u32 s43, s43, 1024
    buffer_load_dwordx4 v200, s[8:11], s52 offen lds
    s_mov_b32 m0, s43
    s_add_u32 s43, s43, 1024
    buffer_load_dwordx4 v201, s[8:11], s52 offen lds
    s_mov_b32 m0, s43
    s_add_u32 s43, s43, 1024
    buffer_load_dwordx4 v202, s[8:11], s52 offen lds
    s_mov_b32 m0, s43
    s_add_u32 s43, s43, 1024
    buffer_load_dwordx4 v203, s[8:11], s52 offen lds
    s_mov_b32 m0, s43
    s_add_u32 s43, s43, 1024
    buffer_load_dwordx4 v204, s[8:11], s52 offen lds
    s_mov_b32 m0, s43
    s_add_u32 s43, s43, 1024
    buffer_load_dwordx4 v205, s[8:11], s52 offen lds
    s_add_u32 s52, s52, 196608
    s_waitcnt vmcnt(6)
    s_barrier
    s_mov_b32 s43, s76
    s_mov_b32 m0, s43
    s_add_u32 s43, s43, 1024
    buffer_load_dwordx4 v200, s[8:11], s52 offen lds
    s_mov_b32 m0, s43
    s_add_u32 s43, s43, 1024
    buffer_load_dwordx4 v201, s[8:11], s52 offen lds
    s_mov_b32 m0, s43
    s_add_u32 s43, s43, 1024
    buffer_load_dwordx4 v202, s[8:11], s52 offen lds
    s_mov_b32 m0, s43
    s_add_u32 s43, s43, 1024
    buffer_load_dwordx4 v203, s[8:11], s52 offen lds
    s_mov_b32 m0, s43
    s_add_u32 s43, s43, 1024
    buffer_load_dwordx4 v204, s[8:11], s52 offen lds
    s_mov_b32 m0, s43
    s_add_u32 s43, s43, 1024
    buffer_load_dwordx4 v205, s[8:11], s52 offen lds
    s_add_u32 s52, s52, 196608
    ds_read_b128 v[80:83], v248 offset:12288
    ds_read_b128 v[84:87], v248 offset:13312
    ds_read_b128 v[88:91], v248 offset:14336
    ds_read_b128 v[92:95], v248 offset:15360
    s_waitcnt lgkmcnt(0)
    s_waitcnt vmcnt(6)
    s_barrier
    s_mov_b32 s43, s77
    s_mov_b32 m0, s43
    s_add_u32 s43, s43, 1024
    buffer_load_dwordx4 v200, s[8:11], s52 offen lds
    s_mov_b32 m0, s43
    s_add_u32 s43, s43, 1024
    buffer_load_dwordx4 v201, s[8:11], s52 offen lds
    s_mov_b32 m0, s43
    s_add_u32 s43, s43, 1024
    buffer_load_dwordx4 v202, s[8:11], s52 offen lds
    s_mov_b32 m0, s43
    s_add_u32 s43, s43, 1024
    buffer_load_dwordx4 v203, s[8:11], s52 offen lds
    s_mov_b32 m0, s43
    s_add_u32 s43, s43, 1024
    buffer_load_dwordx4 v204, s[8:11], s52 offen lds
    s_mov_b32 m0, s43
    s_add_u32 s43, s43, 1024
    buffer_load_dwordx4 v205, s[8:11], s52 offen lds
    s_add_u32 s52, s52, 196608
    s_waitcnt vmcnt(6)
    s_barrier
    s_mov_b32 s43, s78
    s_mov_b32 m0, s43
    s_add_u32 s43, s43, 1024
    buffer_load_dwordx4 v200, s[8:11], s52 offen lds
    s_mov_b32 m0, s43
    s_add_u32 s43, s43, 1024
    buffer_load_dwordx4 v201, s[8:11], s52 offen lds
    s_mov_b32 m0, s43
    s_add_u32 s43, s43, 1024
    buffer_load_dwordx4 v202, s[8:11], s52 offen lds
    s_mov_b32 m0, s43
    s_add_u32 s43, s43, 1024
    buffer_load_dwordx4 v203, s[8:11], s52 offen lds
    s_mov_b32 m0, s43
    s_add_u32 s43, s43, 1024
    buffer_load_dwordx4 v204, s[8:11], s52 offen lds
    s_mov_b32 m0, s43
    s_add_u32 s43, s43, 1024
    buffer_load_dwordx4 v205, s[8:11], s52 offen lds
    s_add_u32 s52, s52, 196608
    ds_read_b128 v[96:99], v248 offset:8192
    ds_read_b128 v[100:103], v248 offset:9216
    ds_read_b128 v[104:107], v248 offset:10240
    ds_read_b128 v[108:111], v248 offset:11264
    s_waitcnt lgkmcnt(0)
    s_waitcnt vmcnt(6)
    s_barrier
    s_mov_b32 s43, s76
    s_mov_b32 m0, s43
    s_add_u32 s43, s43, 1024
    buffer_load_dwordx4 v200, s[8:11], s52 offen lds
    s_mov_b32 m0, s43
    s_add_u32 s43, s43, 1024
    buffer_load_dwordx4 v201, s[8:11], s52 offen lds
    s_mov_b32 m0, s43
    s_add_u32 s43, s43, 1024
    buffer_load_dwordx4 v202, s[8:11], s52 offen lds
    s_mov_b32 m0, s43
    s_add_u32 s43, s43, 1024
    buffer_load_dwordx4 v203, s[8:11], s52 offen lds
    s_mov_b32 m0, s43
    s_add_u32 s43, s43, 1024
    buffer_load_dwordx4 v204, s[8:11], s52 offen lds
    s_mov_b32 m0, s43
    s_add_u32 s43, s43, 1024
    buffer_load_dwordx4 v205, s[8:11], s52 offen lds
    s_add_u32 s52, s52, 196608
    s_waitcnt vmcnt(6)
    s_barrier
    s_mov_b32 s43, s77
    s_mov_b32 m0, s43
    s_add_u32 s43, s43, 1024
    buffer_load_dwordx4 v200, s[8:11], s52 offen lds
    s_mov_b32 m0, s43
    s_add_u32 s43, s43, 1024
    buffer_load_dwordx4 v201, s[8:11], s52 offen lds
    s_mov_b32 m0, s43
    s_add_u32 s43, s43, 1024
    buffer_load_dwordx4 v202, s[8:11], s52 offen lds
    s_mov_b32 m0, s43
    s_add_u32 s43, s43, 1024
    buffer_load_dwordx4 v203, s[8:11], s52 offen lds
    s_mov_b32 m0, s43
    s_add_u32 s43, s43, 1024
    buffer_load_dwordx4 v204, s[8:11], s52 offen lds
    s_mov_b32 m0, s43
    s_add_u32 s43, s43, 1024
    buffer_load_dwordx4 v205, s[8:11], s52 offen lds
    s_add_u32 s52, s52, 196608
    ds_read_b128 v[112:115], v248 offset:12288
    ds_read_b128 v[116:119], v248 offset:13312
    ds_read_b128 v[120:123], v248 offset:14336
    ds_read_b128 v[124:127], v248 offset:15360
    s_waitcnt lgkmcnt(0)
    s_waitcnt vmcnt(6)
    s_barrier
    s_mov_b32 s43, s78
    s_mov_b32 m0, s43
    s_add_u32 s43, s43, 1024
    buffer_load_dwordx4 v200, s[8:11], s52 offen lds
    s_mov_b32 m0, s43
    s_add_u32 s43, s43, 1024
    buffer_load_dwordx4 v201, s[8:11], s52 offen lds
    s_mov_b32 m0, s43
    s_add_u32 s43, s43, 1024
    buffer_load_dwordx4 v202, s[8:11], s52 offen lds
    s_mov_b32 m0, s43
    s_add_u32 s43, s43, 1024
    buffer_load_dwordx4 v203, s[8:11], s52 offen lds
    s_mov_b32 m0, s43
    s_add_u32 s43, s43, 1024
    buffer_load_dwordx4 v204, s[8:11], s52 offen lds
    s_mov_b32 m0, s43
    s_add_u32 s43, s43, 1024
    buffer_load_dwordx4 v205, s[8:11], s52 offen lds
    s_add_u32 s52, s52, 196608
    s_waitcnt vmcnt(6)
    s_barrier
    s_mov_b32 s43, s76
    s_mov_b32 m0, s43
    s_add_u32 s43, s43, 1024
    buffer_load_dwordx4 v200, s[8:11], s52 offen lds
    s_mov_b32 m0, s43
    s_add_u32 s43, s43, 1024
    buffer_load_dwordx4 v201, s[8:11], s52 offen lds
    s_mov_b32 m0, s43
    s_add_u32 s43, s43, 1024
    buffer_load_dwordx4 v202, s[8:11], s52 offen lds
    s_mov_b32 m0, s43
    s_add_u32 s43, s43, 1024
    buffer_load_dwordx4 v203, s[8:11], s52 offen lds
    s_mov_b32 m0, s43
    s_add_u32 s43, s43, 1024
    buffer_load_dwordx4 v204, s[8:11], s52 offen lds
    s_mov_b32 m0, s43
    s_add_u32 s43, s43, 1024
    buffer_load_dwordx4 v205, s[8:11], s52 offen lds
    s_add_u32 s52, s52, 196608
    ds_read_b128 v[128:131], v248 offset:8192
    ds_read_b128 v[132:135], v248 offset:9216
    ds_read_b128 v[136:139], v248 offset:10240
    ds_read_b128 v[140:143], v248 offset:11264
    s_waitcnt lgkmcnt(0)
    s_waitcnt vmcnt(6)
    s_barrier
    s_mov_b32 s43, s77
    s_mov_b32 m0, s43
    s_add_u32 s43, s43, 1024
    buffer_load_dwordx4 v200, s[8:11], s52 offen lds
    s_mov_b32 m0, s43
    s_add_u32 s43, s43, 1024
    buffer_load_dwordx4 v201, s[8:11], s52 offen lds
    s_mov_b32 m0, s43
    s_add_u32 s43, s43, 1024
    buffer_load_dwordx4 v202, s[8:11], s52 offen lds
    s_mov_b32 m0, s43
    s_add_u32 s43, s43, 1024
    buffer_load_dwordx4 v203, s[8:11], s52 offen lds
    s_mov_b32 m0, s43
    s_add_u32 s43, s43, 1024
    buffer_load_dwordx4 v204, s[8:11], s52 offen lds
    s_mov_b32 m0, s43
    s_add_u32 s43, s43, 1024
    buffer_load_dwordx4 v205, s[8:11], s52 offen lds
    s_add_u32 s52, s52, 196608
    s_waitcnt vmcnt(6)
    s_barrier
    s_mov_b32 s43, s78
    s_mov_b32 m0, s43
    s_add_u32 s43, s43, 1024
    buffer_load_dwordx4 v200, s[8:11], s52 offen lds
    s_mov_b32 m0, s43
    s_add_u32 s43, s43, 1024
    buffer_load_dwordx4 v201, s[8:11], s52 offen lds
    s_mov_b32 m0, s43
    s_add_u32 s43, s43, 1024
    buffer_load_dwordx4 v202, s[8:11], s52 offen lds
    s_mov_b32 m0, s43
    s_add_u32 s43, s43, 1024
    buffer_load_dwordx4 v203, s[8:11], s52 offen lds
    s_mov_b32 m0, s43
    s_add_u32 s43, s43, 1024
    buffer_load_dwordx4 v204, s[8:11], s52 offen lds
    s_mov_b32 m0, s43
    s_add_u32 s43, s43, 1024
    buffer_load_dwordx4 v205, s[8:11], s52 offen lds
    s_add_u32 s52, s52, 196608
    ds_read_b128 v[144:147], v248 offset:12288
    ds_read_b128 v[148:151], v248 offset:13312
    ds_read_b128 v[152:155], v248 offset:14336
    ds_read_b128 v[156:159], v248 offset:15360
    s_waitcnt lgkmcnt(0)
    s_waitcnt vmcnt(6)
    s_barrier
    s_mov_b32 s43, s76
    s_mov_b32 m0, s43
    s_add_u32 s43, s43, 1024
    buffer_load_dwordx4 v200, s[8:11], s52 offen lds
    s_mov_b32 m0, s43
    s_add_u32 s43, s43, 1024
    buffer_load_dwordx4 v201, s[8:11], s52 offen lds
    s_mov_b32 m0, s43
    s_add_u32 s43, s43, 1024
    buffer_load_dwordx4 v202, s[8:11], s52 offen lds
    s_mov_b32 m0, s43
    s_add_u32 s43, s43, 1024
    buffer_load_dwordx4 v203, s[8:11], s52 offen lds
    s_mov_b32 m0, s43
    s_add_u32 s43, s43, 1024
    buffer_load_dwordx4 v204, s[8:11], s52 offen lds
    s_mov_b32 m0, s43
    s_add_u32 s43, s43, 1024
    buffer_load_dwordx4 v205, s[8:11], s52 offen lds
    s_add_u32 s52, s52, 196608
    s_waitcnt vmcnt(6)
    s_barrier
    s_mov_b32 s43, s77
    s_mov_b32 m0, s43
    s_add_u32 s43, s43, 1024
    buffer_load_dwordx4 v200, s[8:11], s52 offen lds
    s_mov_b32 m0, s43
    s_add_u32 s43, s43, 1024
    buffer_load_dwordx4 v201, s[8:11], s52 offen lds
    s_mov_b32 m0, s43
    s_add_u32 s43, s43, 1024
    buffer_load_dwordx4 v202, s[8:11], s52 offen lds
    s_mov_b32 m0, s43
    s_add_u32 s43, s43, 1024
    buffer_load_dwordx4 v203, s[8:11], s52 offen lds
    s_mov_b32 m0, s43
    s_add_u32 s43, s43, 1024
    buffer_load_dwordx4 v204, s[8:11], s52 offen lds
    s_mov_b32 m0, s43
    s_add_u32 s43, s43, 1024
    buffer_load_dwordx4 v205, s[8:11], s52 offen lds
    s_add_u32 s52, s52, 196608
    ds_read_b128 v[160:163], v248 offset:8192
    ds_read_b128 v[164:167], v248 offset:9216
    ds_read_b128 v[168:171], v248 offset:10240
    ds_read_b128 v[172:175], v248 offset:11264
    s_waitcnt lgkmcnt(0)
    s_waitcnt vmcnt(6)
    s_barrier
    s_mov_b32 s43, s78
    s_mov_b32 m0, s43
    s_add_u32 s43, s43, 1024
    buffer_load_dwordx4 v200, s[8:11], s52 offen lds
    s_mov_b32 m0, s43
    s_add_u32 s43, s43, 1024
    buffer_load_dwordx4 v201, s[8:11], s52 offen lds
    s_mov_b32 m0, s43
    s_add_u32 s43, s43, 1024
    buffer_load_dwordx4 v202, s[8:11], s52 offen lds
    s_mov_b32 m0, s43
    s_add_u32 s43, s43, 1024
    buffer_load_dwordx4 v203, s[8:11], s52 offen lds
    s_mov_b32 m0, s43
    s_add_u32 s43, s43, 1024
    buffer_load_dwordx4 v204, s[8:11], s52 offen lds
    s_mov_b32 m0, s43
    s_add_u32 s43, s43, 1024
    buffer_load_dwordx4 v205, s[8:11], s52 offen lds
    s_add_u32 s52, s52, 196608
    s_waitcnt vmcnt(6)
    s_barrier
    s_mov_b32 s43, s76
    s_mov_b32 m0, s43
    s_add_u32 s43, s43, 1024
    buffer_load_dwordx4 v200, s[8:11], s52 offen lds
    s_mov_b32 m0, s43
    s_add_u32 s43, s43, 1024
    buffer_load_dwordx4 v201, s[8:11], s52 offen lds
    s_mov_b32 m0, s43
    s_add_u32 s43, s43, 1024
    buffer_load_dwordx4 v202, s[8:11], s52 offen lds
    s_mov_b32 m0, s43
    s_add_u32 s43, s43, 1024
    buffer_load_dwordx4 v203, s[8:11], s52 offen lds
    s_mov_b32 m0, s43
    s_add_u32 s43, s43, 1024
    buffer_load_dwordx4 v204, s[8:11], s52 offen lds
    s_mov_b32 m0, s43
    s_add_u32 s43, s43, 1024
    buffer_load_dwordx4 v205, s[8:11], s52 offen lds
    s_add_u32 s52, s52, 196608
    ds_read_b128 v[176:179], v248 offset:12288
    ds_read_b128 v[180:183], v248 offset:13312
    ds_read_b128 v[184:187], v248 offset:14336
    ds_read_b128 v[188:191], v248 offset:15360
    s_waitcnt lgkmcnt(0)
    s_waitcnt vmcnt(6)
    s_barrier
    s_mov_b32 s43, s77
    s_mov_b32 m0, s43
    s_add_u32 s43, s43, 1024
    buffer_load_dwordx4 v200, s[8:11], s52 offen lds
    s_mov_b32 m0, s43
    s_add_u32 s43, s43, 1024
    buffer_load_dwordx4 v201, s[8:11], s52 offen lds
    s_mov_b32 m0, s43
    s_add_u32 s43, s43, 1024
    buffer_load_dwordx4 v202, s[8:11], s52 offen lds
    s_mov_b32 m0, s43
    s_add_u32 s43, s43, 1024
    buffer_load_dwordx4 v203, s[8:11], s52 offen lds
    s_mov_b32 m0, s43
    s_add_u32 s43, s43, 1024
    buffer_load_dwordx4 v204, s[8:11], s52 offen lds
    s_mov_b32 m0, s43
    s_add_u32 s43, s43, 1024
    buffer_load_dwordx4 v205, s[8:11], s52 offen lds
    s_add_u32 s52, s52, 196608
    s_waitcnt vmcnt(6)
    s_barrier
    s_mov_b32 s43, s78
    s_mov_b32 m0, s43
    s_add_u32 s43, s43, 1024
    buffer_load_dwordx4 v200, s[8:11], s52 offen lds
    s_mov_b32 m0, s43
    s_add_u32 s43, s43, 1024
    buffer_load_dwordx4 v201, s[8:11], s52 offen lds
    s_mov_b32 m0, s43
    s_add_u32 s43, s43, 1024
    buffer_load_dwordx4 v202, s[8:11], s52 offen lds
    s_mov_b32 m0, s43
    s_add_u32 s43, s43, 1024
    buffer_load_dwordx4 v203, s[8:11], s52 offen lds
    s_mov_b32 m0, s43
    s_add_u32 s43, s43, 1024
    buffer_load_dwordx4 v204, s[8:11], s52 offen lds
    s_mov_b32 m0, s43
    s_add_u32 s43, s43, 1024
    buffer_load_dwordx4 v205, s[8:11], s52 offen lds
    s_add_u32 s52, s52, 196608
    s_waitcnt vmcnt(6)
    s_barrier
    s_mov_b32 s43, s76
    s_mov_b32 m0, s43
    s_add_u32 s43, s43, 1024
    buffer_load_dwordx4 v200, s[8:11], s52 offen lds
    s_mov_b32 m0, s43
    s_add_u32 s43, s43, 1024
    buffer_load_dwordx4 v201, s[8:11], s52 offen lds
    s_mov_b32 m0, s43
    s_add_u32 s43, s43, 1024
    buffer_load_dwordx4 v202, s[8:11], s52 offen lds
    s_mov_b32 m0, s43
    s_add_u32 s43, s43, 1024
    buffer_load_dwordx4 v203, s[8:11], s52 offen lds
    s_mov_b32 m0, s43
    s_add_u32 s43, s43, 1024
    buffer_load_dwordx4 v204, s[8:11], s52 offen lds
    s_mov_b32 m0, s43
    s_add_u32 s43, s43, 1024
    buffer_load_dwordx4 v205, s[8:11], s52 offen lds
    s_add_u32 s52, s52, 196608
    s_waitcnt vmcnt(6)
    s_barrier
    s_mov_b32 s43, s77
    s_mov_b32 m0, s43
    s_add_u32 s43, s43, 1024
    buffer_load_dwordx4 v200, s[8:11], s52 offen lds
    s_mov_b32 m0, s43
    s_add_u32 s43, s43, 1024
    buffer_load_dwordx4 v201, s[8:11], s52 offen lds
    s_mov_b32 m0, s43
    s_add_u32 s43, s43, 1024
    buffer_load_dwordx4 v202, s[8:11], s52 offen lds
    s_mov_b32 m0, s43
    s_add_u32 s43, s43, 1024
    buffer_load_dwordx4 v203, s[8:11], s52 offen lds
    s_mov_b32 m0, s43
    s_add_u32 s43, s43, 1024
    buffer_load_dwordx4 v204, s[8:11], s52 offen lds
    s_mov_b32 m0, s43
    s_add_u32 s43, s43, 1024
    buffer_load_dwordx4 v205, s[8:11], s52 offen lds
    s_add_u32 s52, s52, 196608
    s_waitcnt vmcnt(6)
    s_barrier
    s_mov_b32 s43, s78
    s_mov_b32 m0, s43
    s_add_u32 s43, s43, 1024
    buffer_load_dwordx4 v200, s[8:11], s52 offen lds
    s_mov_b32 m0, s43
    s_add_u32 s43, s43, 1024
    buffer_load_dwordx4 v201, s[8:11], s52 offen lds
    s_mov_b32 m0, s43
    s_add_u32 s43, s43, 1024
    buffer_load_dwordx4 v202, s[8:11], s52 offen lds
    s_mov_b32 m0, s43
    s_add_u32 s43, s43, 1024
    buffer_load_dwordx4 v203, s[8:11], s52 offen lds
    s_mov_b32 m0, s43
    s_add_u32 s43, s43, 1024
    buffer_load_dwordx4 v204, s[8:11], s52 offen lds
    s_mov_b32 m0, s43
    s_add_u32 s43, s43, 1024
    buffer_load_dwordx4 v205, s[8:11], s52 offen lds
    s_add_u32 s52, s52, 196608
    s_waitcnt vmcnt(6)
    s_barrier
    s_mov_b32 s43, s76
    s_mov_b32 m0, s43
    s_add_u32 s43, s43, 1024
    buffer_load_dwordx4 v200, s[8:11], s52 offen lds
    s_mov_b32 m0, s43
    s_add_u32 s43, s43, 1024
    buffer_load_dwordx4 v201, s[8:11], s52 offen lds
    s_mov_b32 m0, s43
    s_add_u32 s43, s43, 1024
    buffer_load_dwordx4 v202, s[8:11], s52 offen lds
    s_mov_b32 m0, s43
    s_add_u32 s43, s43, 1024
    buffer_load_dwordx4 v203, s[8:11], s52 offen lds
    s_mov_b32 m0, s43
    s_add_u32 s43, s43, 1024
    buffer_load_dwordx4 v204, s[8:11], s52 offen lds
    s_mov_b32 m0, s43
    s_add_u32 s43, s43, 1024
    buffer_load_dwordx4 v205, s[8:11], s52 offen lds
    s_add_u32 s52, s52, 196608
    s_waitcnt vmcnt(6)
    s_barrier
    s_mov_b32 s43, s77
    s_mov_b32 m0, s43
    s_add_u32 s43, s43, 1024
    buffer_load_dwordx4 v200, s[8:11], s52 offen lds
    s_mov_b32 m0, s43
    s_add_u32 s43, s43, 1024
    buffer_load_dwordx4 v201, s[8:11], s52 offen lds
    s_mov_b32 m0, s43
    s_add_u32 s43, s43, 1024
    buffer_load_dwordx4 v202, s[8:11], s52 offen lds
    s_mov_b32 m0, s43
    s_add_u32 s43, s43, 1024
    buffer_load_dwordx4 v203, s[8:11], s52 offen lds
    s_mov_b32 m0, s43
    s_add_u32 s43, s43, 1024
    buffer_load_dwordx4 v204, s[8:11], s52 offen lds
    s_mov_b32 m0, s43
    s_add_u32 s43, s43, 1024
    buffer_load_dwordx4 v205, s[8:11], s52 offen lds
    s_add_u32 s52, s52, 196608
    s_waitcnt vmcnt(6)
    s_barrier
    s_mov_b32 s43, s78
    s_mov_b32 m0, s43
    s_add_u32 s43, s43, 1024
    buffer_load_dwordx4 v200, s[8:11], s52 offen lds
    s_mov_b32 m0, s43
    s_add_u32 s43, s43, 1024
    buffer_load_dwordx4 v201, s[8:11], s52 offen lds
    s_mov_b32 m0, s43
    s_add_u32 s43, s43, 1024
    buffer_load_dwordx4 v202, s[8:11], s52 offen lds
    s_mov_b32 m0, s43
    s_add_u32 s43, s43, 1024
    buffer_load_dwordx4 v203, s[8:11], s52 offen lds
    s_mov_b32 m0, s43
    s_add_u32 s43, s43, 1024
    buffer_load_dwordx4 v204, s[8:11], s52 offen lds
    s_mov_b32 m0, s43
    s_add_u32 s43, s43, 1024
    buffer_load_dwordx4 v205, s[8:11], s52 offen lds
    s_add_u32 s52, s52, 196608
    s_waitcnt vmcnt(6)
    s_barrier
    s_mov_b32 s43, s76
    s_mov_b32 m0, s43
    s_add_u32 s43, s43, 1024
    buffer_load_dwordx4 v200, s[8:11], s52 offen lds
    s_mov_b32 m0, s43
    s_add_u32 s43, s43, 1024
    buffer_load_dwordx4 v201, s[8:11], s52 offen lds
    s_mov_b32 m0, s43
    s_add_u32 s43, s43, 1024
    buffer_load_dwordx4 v202, s[8:11], s52 offen lds
    s_mov_b32 m0, s43
    s_add_u32 s43, s43, 1024
    buffer_load_dwordx4 v203, s[8:11], s52 offen lds
    s_mov_b32 m0, s43
    s_add_u32 s43, s43, 1024
    buffer_load_dwordx4 v204, s[8:11], s52 offen lds
    s_mov_b32 m0, s43
    s_add_u32 s43, s43, 1024
    buffer_load_dwordx4 v205, s[8:11], s52 offen lds
    s_add_u32 s52, s52, 196608
    s_waitcnt vmcnt(6)
    s_barrier
    s_mov_b32 s43, s77
    s_mov_b32 m0, s43
    s_add_u32 s43, s43, 1024
    buffer_load_dwordx4 v200, s[8:11], s52 offen lds
    s_mov_b32 m0, s43
    s_add_u32 s43, s43, 1024
    buffer_load_dwordx4 v201, s[8:11], s52 offen lds
    s_mov_b32 m0, s43
    s_add_u32 s43, s43, 1024
    buffer_load_dwordx4 v202, s[8:11], s52 offen lds
    s_mov_b32 m0, s43
    s_add_u32 s43, s43, 1024
    buffer_load_dwordx4 v203, s[8:11], s52 offen lds
    s_mov_b32 m0, s43
    s_add_u32 s43, s43, 1024
    buffer_load_dwordx4 v204, s[8:11], s52 offen lds
    s_mov_b32 m0, s43
    s_add_u32 s43, s43, 1024
    buffer_load_dwordx4 v205, s[8:11], s52 offen lds
    s_add_u32 s52, s52, 196608
    s_waitcnt vmcnt(6)
    s_barrier
    s_mov_b32 s43, s78
    s_mov_b32 m0, s43
    s_add_u32 s43, s43, 1024
    buffer_load_dwordx4 v200, s[8:11], s52 offen lds
    s_mov_b32 m0, s43
    s_add_u32 s43, s43, 1024
    buffer_load_dwordx4 v201, s[8:11], s52 offen lds
    s_mov_b32 m0, s43
    s_add_u32 s43, s43, 1024
    buffer_load_dwordx4 v202, s[8:11], s52 offen lds
    s_mov_b32 m0, s43
    s_add_u32 s43, s43, 1024
    buffer_load_dwordx4 v203, s[8:11], s52 offen lds
    s_mov_b32 m0, s43
    s_add_u32 s43, s43, 1024
    buffer_load_dwordx4 v204, s[8:11], s52 offen lds
    s_mov_b32 m0, s43
    s_add_u32 s43, s43, 1024
    buffer_load_dwordx4 v205, s[8:11], s52 offen lds
    s_add_u32 s52, s52, 196608
    s_waitcnt vmcnt(6)
    s_barrier
    s_mov_b32 s43, s76
    s_mov_b32 m0, s43
    s_add_u32 s43, s43, 1024
    buffer_load_dwordx4 v200, s[8:11], s52 offen lds
    s_mov_b32 m0, s43
    s_add_u32 s43, s43, 1024
    buffer_load_dwordx4 v201, s[8:11], s52 offen lds
    s_mov_b32 m0, s43
    s_add_u32 s43, s43, 1024
    buffer_load_dwordx4 v202, s[8:11], s52 offen lds
    s_mov_b32 m0, s43
    s_add_u32 s43, s43, 1024
    buffer_load_dwordx4 v203, s[8:11], s52 offen lds
    s_mov_b32 m0, s43
    s_add_u32 s43, s43, 1024
    buffer_load_dwordx4 v204, s[8:11], s52 offen lds
    s_mov_b32 m0, s43
    s_add_u32 s43, s43, 1024
    buffer_load_dwordx4 v205, s[8:11], s52 offen lds
    s_add_u32 s52, s52, 196608
    s_waitcnt vmcnt(6)
    s_barrier
    s_waitcnt vmcnt(0)
    s_barrier
REC_norecv:
    s_cmp_lg_u32 s16, 11
    s_cbranch_scc1 REC_nopb
    s_cmp_lg_u32 s18, 0
    s_cbranch_scc1 REC_nopb
    s_cmp_lg_u32 s17, 7
    s_cbranch_scc1 REC_nopb
    v_mov_b32 v8, -1
    v_mov_b32 v3, 0
    s_mov_b32 s34, 0x7fffffff
    s_mov_b32 s35, 0x7fffffff
    s_add_u32 s33, s24, 0
    buffer_store_dword v8, v3, s[12:15], s33 offen sc1
    s_waitcnt vmcnt(0)
    s_memtime s[36:37]
    s_waitcnt lgkmcnt(0)
    buffer_load_dword v5, v3, s[12:15], s33 offen sc1
    s_waitcnt vmcnt(0)
    s_memtime s[38:39]
    s_waitcnt lgkmcnt(0)
    s_sub_u32 s38, s38, s36
    s_min_u32 s34, s34, s38
    s_add_u32 s33, s24, 8192
    buffer_store_dword v8, v3, s[12:15], s33 offen sc1
    s_waitcnt vmcnt(0)
    s_memtime s[36:37]
    s_waitcnt lgkmcnt(0)
    buffer_load_dword v5, v3, s[12:15], s33 offen sc1
    s_waitcnt vmcnt(0)
    s_memtime s[38:39]
    s_waitcnt lgkmcnt(0)
    s_sub_u32 s38, s38, s36
    s_min_u32 s35, s35, s38
    s_add_u32 s33, s24, 82944
    buffer_store_dword v8, v3, s[12:15], s33 offen sc1
    s_waitcnt vmcnt(0)
    s_memtime s[36:37]
    s_waitcnt lgkmcnt(0)
    buffer_load_dword v5, v3, s[12:15], s33 offen sc1
    s_waitcnt vmcnt(0)
    s_memtime s[38:39]
    s_waitcnt lgkmcnt(0)
    s_sub_u32 s38, s38, s36
    s_min_u32 s34, s34, s38
    s_add_u32 s33, s24, 91136
    buffer_store_dword v8, v3, s[12:15], s33 offen sc1
    s_waitcnt vmcnt(0)
    s_memtime s[36:37]
    s_waitcnt lgkmcnt(0)
    buffer_load_dword v5, v3, s[12:15], s33 offen sc1
    s_waitcnt vmcnt(0)
    s_memtime s[38:39]
    s_waitcnt lgkmcnt(0)
    s_sub_u32 s38, s38, s36
    s_min_u32 s35, s35, s38
    s_add_u32 s33, s24, 165888
    buffer_store_dword v8, v3, s[12:15], s33 offen sc1
    s_waitcnt vmcnt(0)
    s_memtime s[36:37]
    s_waitcnt lgkmcnt(0)
    buffer_load_dword v5, v3, s[12:15], s33 offen sc1
    s_waitcnt vmcnt(0)
    s_memtime s[38:39]
    s_waitcnt lgkmcnt(0)
    s_sub_u32 s38, s38, s36
    s_min_u32 s34, s34, s38
    s_add_u32 s33, s24, 174080
    buffer_store_dword v8, v3, s[12:15], s33 offen sc1
    s_waitcnt vmcnt(0)
    s_memtime s[36:37]
    s_waitcnt lgkmcnt(0)
    buffer_load_dword v5, v3, s[12:15], s33 offen sc1
    s_waitcnt vmcnt(0)
    s_memtime s[38:39]
    s_waitcnt lgkmcnt(0)
    s_sub_u32 s38, s38, s36
    s_min_u32 s35, s35, s38
    s_add_u32 s33, s24, 248832
    buffer_store_dword v8, v3, s[12:15], s33 offen sc1
    s_waitcnt vmcnt(0)
    s_memtime s[36:37]
    s_waitcnt lgkmcnt(0)
    buffer_load_dword v5, v3, s[12:15], s33 offen sc1
    s_waitcnt vmcnt(0)
    s_memtime s[38:39]
    s_waitcnt lgkmcnt(0)
    s_sub_u32 s38, s38, s36
    s_min_u32 s34, s34, s38
    s_add_u32 s33, s24, 257024
    buffer_store_dword v8, v3, s[12:15], s33 offen sc1
    s_waitcnt vmcnt(0)
    s_memtime s[36:37]
    s_waitcnt lgkmcnt(0)
    buffer_load_dword v5, v3, s[12:15], s33 offen sc1
    s_waitcnt vmcnt(0)
    s_memtime s[38:39]
    s_waitcnt lgkmcnt(0)
    s_sub_u32 s38, s38, s36
    s_min_u32 s35, s35, s38
    s_add_u32 s33, s24, 331776
    buffer_store_dword v8, v3, s[12:15], s33 offen sc1
    s_waitcnt vmcnt(0)
    s_memtime s[36:37]
    s_waitcnt lgkmcnt(0)
    buffer_load_dword v5, v3, s[12:15], s33 offen sc1
    s_waitcnt vmcnt(0)
    s_memtime s[38:39]
    s_waitcnt lgkmcnt(0)
    s_sub_u32 s38, s38, s36
    s_min_u32 s34, s34, s38
    s_add_u32 s33, s24, 339968
    buffer_store_dword v8, v3, s[12:15], s33 offen sc1
    s_waitcnt vmcnt(0)
    s_memtime s[36:37]
    s_waitcnt lgkmcnt(0)
    buffer_load_dword v5, v3, s[12:15], s33 offen sc1
    s_waitcnt vmcnt(0)
    s_memtime s[38:39]
    s_waitcnt lgkmcnt(0)
    s_sub_u32 s38, s38, s36
    s_min_u32 s35, s35, s38
    s_add_u32 s33, s24, 414720
    buffer_store_dword v8, v3, s[12:15], s33 offen sc1
    s_waitcnt vmcnt(0)
    s_memtime s[36:37]
    s_waitcnt lgkmcnt(0)
    buffer_load_dword v5, v3, s[12:15], s33 offen sc1
    s_waitcnt vmcnt(0)
    s_memtime s[38:39]
    s_waitcnt lgkmcnt(0)
    s_sub_u32 s38, s38, s36
    s_min_u32 s34, s34, s38
    s_add_u32 s33, s24, 422912
    buffer_store_dword v8, v3, s[12:15], s33 offen sc1
    s_waitcnt vmcnt(0)
    s_memtime s[36:37]
    s_waitcnt lgkmcnt(0)
    buffer_load_dword v5, v3, s[12:15], s33 offen sc1
    s_waitcnt vmcnt(0)
    s_memtime s[38:39]
    s_waitcnt lgkmcnt(0)
    s_sub_u32 s38, s38, s36
    s_min_u32 s35, s35, s38
    s_add_u32 s33, s24, 497664
    buffer_store_dword v8, v3, s[12:15], s33 offen sc1
    s_waitcnt vmcnt(0)
    s_memtime s[36:37]
    s_waitcnt lgkmcnt(0)
    buffer_load_dword v5, v3, s[12:15], s33 offen sc1
    s_waitcnt vmcnt(0)
    s_memtime s[38:39]
    s_waitcnt lgkmcnt(0)
    s_sub_u32 s38, s38, s36
    s_min_u32 s34, s34, s38
    s_add_u32 s33, s24, 505856
    buffer_store_dword v8, v3, s[12:15], s33 offen sc1
    s_waitcnt vmcnt(0)
    s_memtime s[36:37]
    s_waitcnt lgkmcnt(0)
    buffer_load_dword v5, v3, s[12:15], s33 offen sc1
    s_waitcnt vmcnt(0)
    s_memtime s[38:39]
    s_waitcnt lgkmcnt(0)
    s_sub_u32 s38, s38, s36
    s_min_u32 s35, s35, s38
    s_getreg_b32 s36, hwreg(HW_REG_XCC_ID)
    s_lshr_b32 s36, s36, 2
    s_and_b32 s36, s36, 1
    s_cmp_lt_u32 s35, s34
    s_cselect_b32 s37, 1, 0
    s_xor_b32 s37, s37, s36
    s_lshl_b32 s37, s37, 13
    s_add_u32 s37, s37, 1
    v_mov_b32 v4, s37
    v_mov_b32 v3, 12
    buffer_store_dword v4, v3, s[68:71], 0 offen sc1
REC_nopb:
    s_waitcnt lgkmcnt(0)
    s_load_dwordx2 s[8:9], s[0:1], 16
    s_load_dwordx2 s[60:61], s[0:1], 24
    s_mov_b32 s10, 7864320
    s_mov_b32 s11, 0x00020000
    s_mov_b32 s62, 7864320
    s_mov_b32 s63, 0x00020000
    v_lshrrev_b32 v200, 3, v255
    v_bfe_u32 v201, v200, 1, 2
    v_lshlrev_b32 v201, 1, v201
    v_xor_b32 v201, v201, v252
    v_mul_u32_u24 v200, 12288, v200
    v_lshl_add_u32 v200, v201, 4, v200
    s_mul_i32 s54, s25, 384
    s_lshl_b32 s40, s22, 7
    s_add_u32 s54, s54, s40
    s_mul_i32 s40, s23, 196608
    s_add_u32 s54, s54, s40
    s_lshl_b32 s57, s23, 11
    s_waitcnt lgkmcnt(0)
    s_barrier
    s_add_u32 s52, s54, 0
    s_add_u32 s43, s57, 0
    s_mov_b32 m0, s43
    s_add_u32 s43, s43, 1024
    buffer_load_dwordx4 v200, s[8:11], s52 offen lds
    s_add_u32 s52, s52, 98304
    s_mov_b32 m0, s43
    s_add_u32 s43, s43, 1024
    buffer_load_dwordx4 v200, s[8:11], s52 offen lds
    s_add_u32 s52, s52, 98304
    s_add_u32 s52, s54, 786432
    s_add_u32 s43, s57, 8192
    s_mov_b32 m0, s43
    s_add_u32 s43, s43, 1024
    buffer_load_dwordx4 v200, s[8:11], s52 offen lds
    s_add_u32 s52, s52, 98304
    s_mov_b32 m0, s43
    s_add_u32 s43, s43, 1024
    buffer_load_dwordx4 v200, s[8:11], s52 offen lds
    s_add_u32 s52, s52, 98304
    s_add_u32 s52, s54, 1572864
    s_add_u32 s43, s57, 16384
    s_mov_b32 m0, s43
    s_add_u32 s43, s43, 1024
    buffer_load_dwordx4 v200, s[8:11], s52 offen lds
    s_add_u32 s52, s52, 98304
    s_mov_b32 m0, s43
    s_add_u32 s43, s43, 1024
    buffer_load_dwordx4 v200, s[8:11], s52 offen lds
    s_add_u32 s52, s52, 98304
    s_waitcnt vmcnt(4)
    s_barrier
    s_add_u32 s52, s54, 2359296
    s_add_u32 s43, s57, 24576
    s_mov_b32 m0, s43
    s_add_u32 s43, s43, 1024
    buffer_load_dwordx4 v200, s[8:11], s52 offen lds
    s_add_u32 s52, s52, 98304
    s_mov_b32 m0, s43
    s_add_u32 s43, s43, 1024
    buffer_load_dwordx4 v200, s[8:11], s52 offen lds
    s_add_u32 s52, s52, 98304
    s_waitcnt vmcnt(4)
    s_barrier
    s_add_u32 s52, s54, 3145728
    s_add_u32 s43, s57, 0
    s_mov_b32 m0, s43
    s_add_u32 s43, s43, 1024
    buffer_load_dwordx4 v200, s[8:11], s52 offen lds
    s_add_u32 s52, s52, 98304
    s_mov_b32 m0, s43
    s_add_u32 s43, s43, 1024
    buffer_load_dwordx4 v200, s[8:11], s52 offen lds
    s_add_u32 s52, s52, 98304
    s_waitcnt vmcnt(4)
    s_barrier
    s_add_u32 s52, s54, 3932160
    s_add_u32 s43, s57, 8192
    s_mov_b32 m0, s43
    s_add_u32 s43, s43, 1024
    buffer_load_dwordx4 v200, s[8:11], s52 offen lds
    s_add_u32 s52, s52, 98304
    s_mov_b32 m0, s43
    s_add_u32 s43, s43, 1024
    buffer_load_dwordx4 v200, s[8:11], s52 offen lds
    s_add_u32 s52, s52, 98304
    s_waitcnt vmcnt(4)
    s_barrier
    s_add_u32 s52, s54, 4718592
    s_add_u32 s43, s57, 16384
    s_mov_b32 m0, s43
    s_add_u32 s43, s43, 1024
    buffer_load_dwordx4 v200, s[8:11], s52 offen lds
    s_add_u32 s52, s52, 98304
    s_mov_b32 m0, s43
    s_add_u32 s43, s43, 1024
    buffer_load_dwordx4 v200, s[8:11], s52 offen lds
    s_add_u32 s52, s52, 98304
    s_waitcnt vmcnt(4)
    s_barrier
    s_add_u32 s52, s54, 5505024
    s_add_u32 s43, s57, 24576
    s_mov_b32 m0, s43
    s_add_u32 s43, s43, 1024
    buffer_load_dwordx4 v200, s[8:11], s52 offen lds
    s_add_u32 s52, s52, 98304
    s_mov_b32 m0, s43
    s_add_u32 s43, s43, 1024
    buffer_load_dwordx4 v200, s[8:11], s52 offen lds
    s_add_u32 s52, s52, 98304
    s_waitcnt vmcnt(4)
    s_barrier
    s_add_u32 s52, s54, 6291456
    s_add_u32 s43, s57, 0
    s_mov_b32 m0, s43
    s_add_u32 s43, s43, 1024
    buffer_load_dwordx4 v200, s[8:11], s52 offen lds
    s_add_u32 s52, s52, 98304
    s_mov_b32 m0, s43
    s_add_u32 s43, s43, 1024
    buffer_load_dwordx4 v200, s[8:11], s52 offen lds
    s_add_u32 s52, s52, 98304
    s_waitcnt vmcnt(4)
    s_barrier
    s_add_u32 s52, s54, 7077888
    s_add_u32 s43, s57, 8192
    s_mov_b32 m0, s43
    s_add_u32 s43, s43, 1024
    buffer_load_dwordx4 v200, s[8:11], s52 offen lds
    s_add_u32 s52, s52, 98304
    s_mov_b32 m0, s43
    s_add_u32 s43, s43, 1024
    buffer_load_dwordx4 v200, s[8:11], s52 offen lds
    s_add_u32 s52, s52, 98304
    s_waitcnt vmcnt(4)
    s_barrier
    s_add_u32 s52, s54, 0
    s_add_u32 s43, s57, 16384
    s_mov_b32 m0, s43
    s_add_u32 s43, s43, 1024
    buffer_load_dwordx4 v200, s[60:63], s52 offen lds
    s_add_u32 s52, s52, 98304
    s_mov_b32 m0, s43
    s_add_u32 s43, s43, 1024
    buffer_load_dwordx4 v200, s[60:63], s52 offen lds
    s_add_u32 s52, s52, 98304
    s_waitcnt vmcnt(4)
    s_barrier
    s_add_u32 s52, s54, 786432
    s_add_u32 s43, s57, 24576
    s_mov_b32 m0, s43
    s_add_u32 s43, s43, 1024
    buffer_load_dwordx4 v200, s[60:63], s52 offen lds
    s_add_u32 s52, s52, 98304
    s_mov_b32 m0, s43
    s_add_u32 s43, s43, 1024
    buffer_load_dwordx4 v200, s[60:63], s52 offen lds
    s_add_u32 s52, s52, 98304
    s_waitcnt vmcnt(4)
    s_barrier
    s_add_u32 s52, s54, 1572864
    s_add_u32 s43, s57, 0
    s_mov_b32 m0, s43
    s_add_u32 s43, s43, 1024
    buffer_load_dwordx4 v200, s[60:63], s52 offen lds
    s_add_u32 s52, s52, 98304
    s_mov_b32 m0, s43
    s_add_u32 s43, s43, 1024
    buffer_load_dwordx4 v200, s[60:63], s52 offen lds
    s_add_u32 s52, s52, 98304
    s_waitcnt vmcnt(4)
    s_barrier
    s_add_u32 s52, s54, 2359296
    s_add_u32 s43, s57, 8192
    s_mov_b32 m0, s43
    s_add_u32 s43, s43, 1024
    buffer_load_dwordx4 v200, s[60:63], s52 offen lds
    s_add_u32 s52, s52, 98304
    s_mov_b32 m0, s43
    s_add_u32 s43, s43, 1024
    buffer_load_dwordx4 v200, s[60:63], s52 offen lds
    s_add_u32 s52, s52, 98304
    s_waitcnt vmcnt(4)
    s_barrier
    s_add_u32 s52, s54, 3145728
    s_add_u32 s43, s57, 16384
    s_mov_b32 m0, s43
    s_add_u32 s43, s43, 1024
    buffer_load_dwordx4 v200, s[60:63], s52 offen lds
    s_add_u32 s52, s52, 98304
    s_mov_b32 m0, s43
    s_add_u32 s43, s43, 1024
    buffer_load_dwordx4 v200, s[60:63], s52 offen lds
    s_add_u32 s52, s52, 98304
    s_waitcnt vmcnt(4)
    s_barrier
    s_add_u32 s52, s54, 3932160
    s_add_u32 s43, s57, 24576
    s_mov_b32 m0, s43
    s_add_u32 s43, s43, 1024
    buffer_load_dwordx4 v200, s[60:63], s52 offen lds
    s_add_u32 s52, s52, 98304
    s_mov_b32 m0, s43
    s_add_u32 s43, s43, 1024
    buffer_load_dwordx4 v200, s[60:63], s52 offen lds
    s_add_u32 s52, s52, 98304
    s_waitcnt vmcnt(4)
    s_barrier
    s_add_u32 s52, s54, 4718592
    s_add_u32 s43, s57, 0
    s_mov_b32 m0, s43
    s_add_u32 s43, s43, 1024
    buffer_load_dwordx4 v200, s[60:63], s52 offen lds
    s_add_u32 s52, s52, 98304
    s_mov_b32 m0, s43
    s_add_u32 s43, s43, 1024
    buffer_load_dwordx4 v200, s[60:63], s52 offen lds
    s_add_u32 s52, s52, 98304
    s_waitcnt vmcnt(4)
    s_barrier
    s_add_u32 s52, s54, 5505024
    s_add_u32 s43, s57, 8192
    s_mov_b32 m0, s43
    s_add_u32 s43, s43, 1024
    buffer_load_dwordx4 v200, s[60:63], s52 offen lds
    s_add_u32 s52, s52, 98304
    s_mov_b32 m0, s43
    s_add_u32 s43, s43, 1024
    buffer_load_dwordx4 v200, s[60:63], s52 offen lds
    s_add_u32 s52, s52, 98304
    s_waitcnt vmcnt(4)
    s_barrier
    s_add_u32 s52, s54, 6291456
    s_add_u32 s43, s57, 16384
    s_mov_b32 m0, s43
    s_add_u32 s43, s43, 1024
    buffer_load_dwordx4 v200, s[60:63], s52 offen lds
    s_add_u32 s52, s52, 98304
    s_mov_b32 m0, s43
    s_add_u32 s43, s43, 1024
    buffer_load_dwordx4 v200, s[60:63], s52 offen lds
    s_add_u32 s52, s52, 98304
    s_waitcnt vmcnt(4)
    s_barrier
    s_add_u32 s52, s54, 7077888
    s_add_u32 s43, s57, 24576
    s_mov_b32 m0, s43
    s_add_u32 s43, s43, 1024
    buffer_load_dwordx4 v200, s[60:63], s52 offen lds
    s_add_u32 s52, s52, 98304
    s_mov_b32 m0, s43
    s_add_u32 s43, s43, 1024
    buffer_load_dwordx4 v200, s[60:63], s52 offen lds
    s_add_u32 s52, s52, 98304
    s_waitcnt vmcnt(4)
    s_barrier
    s_waitcnt vmcnt(2)
    s_barrier
    s_waitcnt vmcnt(0)
    s_barrier
    v_lshlrev_b32 v244, 9, v251
    v_lshl_add_u32 v244, v250, 4, v244
    s_lshl_b32 s40, s23, 2
    s_add_u32 s40, s40, 22528
    v_add_u32 v244, s40, v244
    v_lshlrev_b32 v245, 8, v251
    v_lshl_add_u32 v245, v250, 3, v245
    s_lshl_b32 s40, s23, 10
    s_add_u32 s40, s40, 26624
    v_add_u32 v245, s40, v245
    s_mov_b32 s79, s40
    v_add_u32 v248, s58, v249
    s_mul_i32 s40, s21, 2048
    s_lshl_b32 s61, s22, 3
    s_cmp_eq_u32 s22, 2
    s_cselect_b32 s61, 1024, s61
    s_cselect_b32 s62, 3, 4
    s_add_u32 s61, s61, s40
    s_lshl_b32 s63, s22, 2
    s_add_u32 s63, s63, s40
    s_add_u32 s63, s63, 1536
    s_lshl_b32 s52, s55, 9
    s_mul_i32 s54, s19, 10240
    s_lshl_b32 s42, s20, 10
    s_add_u32 s54, s54, s42
    s_lshr_b32 s42, s54, 13
    s_lshl_b32 s42, s42, 13
    s_add_u32 s54, s54, s42
    v_lshrrev_b32 v192, 3, v255
    v_mul_u32_u24 v246, 10240, v192
    s_lshl_b32 s40, s55, 9
    s_lshl_b32 s41, s23, 7
    s_add_u32 s41, s41, s40
    v_add_u32 v246, s41, v246
    v_lshl_add_u32 v246, v252, 4, v246
    v_lshrrev_b32 v193, 13, v246
    v_lshlrev_b32 v193, 13, v193
    v_add_u32 v246, v246, v193
    v_lshrrev_b32 v192, 2, v252
    s_lshl_b32 s41, s23, 1
    v_add_u32 v192, s41, v192
    v_and_b32 v193, 3, v192
    v_lshlrev_b32 v247, 7, v193
    v_lshrrev_b32 v193, 2, v192
    v_lshl_add_u32 v247, v193, 3, v247
    v_and_b32 v193, 3, v255
    v_lshl_add_u32 v247, v193, 5, v247
    v_lshrrev_b32 v193, 5, v255
    v_lshl_add_u32 v247, v193, 4, v247
    v_bfe_u32 v193, v255, 4, 1
    v_lshl_add_u32 v247, v193, 2, v247
    v_add_u32 v247, s40, v247
    v_cmp_eq_u32 vcc, 0, v253
    s_nop 1
    v_cndmask_b32 v247, v242, v247, vcc
    v_mov_b32 v252, v243
    v_add_u32 v251, s79, v249
    v_and_b32 v250, 31, v255
    v_lshlrev_b32 v250, 2, v250
    s_lshl_b32 s40, s18, 7
    s_add_u32 s59, s40, 3609600
    s_add_u32 s40, s40, 3610624
    v_add_u32 v250, s40, v250
    s_mul_i32 s60, s18, 24
    s_add_u32 s60, s60, s16
    s_lshl_b32 s60, s60, 6
    s_add_u32 s60, s60, 3612672
    s_mul_i32 s38, s26, 10240
    s_add_u32 s38, s38, 202473472
    s_lshl_b32 s40, s20, 10
    s_add_u32 s38, s38, s40
    s_mul_i32 s37, s25, 3072
    s_add_u32 s37, s37, 196083712
    s_lshl_b32 s40, s22, 10
    s_add_u32 s37, s37, s40
    v_and_b32 v225, 7, v255
    v_lshlrev_b32 v225, 5, v225
    s_mov_b32 s73, 3000000
CEN_27:
    buffer_load_dword v224, v225, s[68:71], 0 offen sc1
    s_mov_b32 s39, 1
    s_sub_u32 s73, s73, 1
    s_cbranch_scc1 CEN_27_ok
    s_waitcnt vmcnt(0)
    v_cmp_ne_u32 vcc, 32, v224
    s_cbranch_vccz CEN_27_ok
    s_mov_b32 s72, 0
    v_readlane_b32 s75, v224, 0
    s_add_u32 s72, s72, s75
    s_cmp_lt_u32 s75, 32
    s_cselect_b32 s39, 0, s39
    v_readlane_b32 s75, v224, 1
    s_add_u32 s72, s72, s75
    s_cmp_lt_u32 s75, 32
    s_cselect_b32 s39, 0, s39
    v_readlane_b32 s75, v224, 2
    s_add_u32 s72, s72, s75
    s_cmp_lt_u32 s75, 32
    s_cselect_b32 s39, 0, s39
    v_readlane_b32 s75, v224, 3
    s_add_u32 s72, s72, s75
    s_cmp_lt_u32 s75, 32
    s_cselect_b32 s39, 0, s39
    v_readlane_b32 s75, v224, 4
    s_add_u32 s72, s72, s75
    v_readlane_b32 s75, v224, 5
    s_add_u32 s72, s72, s75
    v_readlane_b32 s75, v224, 6
    s_add_u32 s72, s72, s75
    v_readlane_b32 s75, v224, 7
    s_add_u32 s72, s72, s75
    s_cmp_ge_u32 s72, 256
    s_cbranch_scc1 CEN_27_ok
    s_sleep 4
    s_branch CEN_27
CEN_27_ok:
    s_waitcnt vmcnt(0)
    v_mov_b32 v228, 0
    s_mov_b32 s73, 3000000
    s_mov_b32 s93, 0
WINI_28:
    buffer_load_dwordx4 v[224:227], v228, s[68:71], 0 offen sc1
    s_sub_u32 s73, s73, 1
    s_cbranch_scc1 WINI_28_ok
    s_waitcnt vmcnt(0)
    v_readfirstlane_b32 s72, v225
    s_cmp_lt_u32 s72, 64
    s_cbranch_scc1 WINI_28_sl
    v_readfirstlane_b32 s93, v227
    s_cmp_lg_u32 s93, 0
    s_cbranch_scc1 WINI_28_ok
WINI_28_sl:
    s_sleep 24
    s_branch WINI_28
WINI_28_ok:
    s_waitcnt vmcnt(0)
    s_and_b32 s93, s93, 8192
    s_mov_b32 s41, s93
    s_and_b32 s41, s41, 8192
    s_add_u32 s24, s24, s41
    s_mov_b32 s57, 1
REC_rlp_29:
    buffer_load_dword v224, v250, s[12:15], s93 offen sc1
    s_sub_u32 s46, s46, 1
    s_cbranch_scc1 REC_rok_30_x
    s_waitcnt vmcnt(0)
    v_cmp_gt_u32 vcc, s57, v224
    s_cbranch_vccz REC_rok_30
    s_sleep 2
    s_branch REC_rlp_29
REC_rok_30_x:
    s_mov_b32 s46, 0
REC_rok_30:
    s_barrier
    s_waitcnt lgkmcnt(0)
    s_setprio 1
    s_cmp_eq_u32 s39, 0
    s_cbranch_scc1 RECB_loopS
REC_loopS:
    s_and_b32 s40, s27, 3
    s_add_u32 s41, s27, 2
    s_and_b32 s41, s41, 3
    s_mul_i32 s28, s40, 65536
    s_add_u32 s28, s28, s47
    s_mul_i32 s29, s41, 65536
    s_add_u32 s29, s29, s47
    s_mul_i32 s30, s40, 163840
    s_add_u32 s30, s30, s24
    s_mul_i32 s31, s41, 163840
    s_add_u32 s31, s31, s24
    s_mul_i32 s32, s40, 40960
    s_add_u32 s32, s32, s48
    s_add_u32 s41, s27, 1
    s_and_b32 s41, s41, 3
    s_mul_i32 s33, s41, 40960
    s_add_u32 s33, s33, s48
    s_add_u32 s41, s27, 3
    s_and_b32 s41, s41, 3
    s_mul_i32 s34, s41, 40960
    s_add_u32 s34, s34, s48
    s_barrier
    ds_read_b128 v[224:227], v251
    ds_read_b128 v[228:231], v249 offset:30720
    s_waitcnt lgkmcnt(0)
    s_cmp_ge_u32 s20, 10
    s_cbranch_scc1 REC_fl_31_a
    buffer_store_dwordx4 v[224:227], v249, s[12:15], s38 offen sc1
REC_fl_31_a:
    s_cmp_lg_u32 s17, 4
    s_cbranch_scc1 REC_fl_31_b
    buffer_store_dwordx4 v[228:231], v249, s[12:15], s37 offen sc1
REC_fl_31_b:
    s_add_u32 s38, s38, 327680
    s_add_u32 s37, s37, 98304
    s_cmp_lg_u32 s17, 7
    s_cbranch_scc1 REC_nopr
    s_cmp_lt_u32 s27, 2
    s_cbranch_scc1 REC_nopr
    s_sub_u32 s40, s27, 1
    v_mov_b32 v232, s40
    v_mov_b32 v233, s60
    buffer_store_dword v232, v233, s[12:15], s93 offen sc1
REC_nopr:
    s_cmp_lg_u32 s17, 6
    s_cbranch_scc1 REC_nopois
    v_mov_b32 v236, -1
    v_mov_b32 v237, -1
    v_mov_b32 v238, -1
    v_mov_b32 v239, -1
    v_lshlrev_b32 v232, s62, v255
    v_and_b32 v233, 0x1ff, v249
    s_add_u32 s40, s29, s61
    s_add_u32 s41, s29, s63
    buffer_store_dwordx2 v[236:237], v232, s[12:15], s40 offen
    buffer_store_dword v236, v233, s[12:15], s41 offen
    s_cmp_ge_u32 s20, 10
    s_cbranch_scc1 REC_nopois
    s_add_u32 s40, s31, s54
    s_add_u32 s41, s34, s52
    buffer_store_dwordx4 v[236:239], v249, s[12:15], s40 offen sc1
    buffer_store_dwordx4 v[236:239], v233, s[12:15], s41 offen
REC_nopois:
    s_cmp_lg_u32 s17, 5
    s_cbranch_scc1 REC_noprog
    s_cmp_lg_u32 s16, 11
    s_cbranch_scc1 REC_noprog
    s_add_u32 s40, s27, 1
    v_mov_b32 v232, s40
    v_mov_b32 v233, s59
    buffer_store_dword v232, v233, s[12:15], s93 offen sc1
REC_noprog:
    s_cmp_lt_u32 s20, 10
    s_cbranch_scc1 REC_yjob
    s_barrier
    s_branch REC_endS
REC_yjob:
    ds_read_b128 v[192:195], v252 offset:0
    ds_read_b128 v[196:199], v252 offset:6144
    ds_read_b128 v[208:211], v248 offset:0
    ds_read_b128 v[212:215], v248 offset:1024
    ds_read_b128 v[216:219], v248 offset:2048
    ds_read_b128 v[220:223], v248 offset:3072
    ds_read_b128 v[200:203], v252 offset:512
    ds_read_b128 v[204:207], v252 offset:6656
    s_waitcnt lgkmcnt(7)
    v_mfma_f32_16x16x32_bf16 v[224:227], v[192:195], v[0:3], 0
    s_waitcnt lgkmcnt(6)
    s_waitcnt lgkmcnt(5)
    v_mfma_f32_16x16x32_bf16 v[224:227], v[196:199], v[208:211], v[224:227]
    ds_read_b128 v[208:211], v248 offset:4096
    v_mfma_f32_16x16x32_bf16 v[228:231], v[192:195], v[4:7], 0
    s_waitcnt lgkmcnt(5)
    v_mfma_f32_16x16x32_bf16 v[228:231], v[196:199], v[212:215], v[228:231]
    ds_read_b128 v[212:215], v248 offset:5120
    v_mfma_f32_16x16x32_bf16 v[232:235], v[192:195], v[8:11], 0
    s_waitcnt lgkmcnt(5)
    v_mfma_f32_16x16x32_bf16 v[232:235], v[196:199], v[216:219], v[232:235]
    ds_read_b128 v[216:219], v248 offset:6144
    v_mfma_f32_16x16x32_bf16 v[236:239], v[192:195], v[12:15], 0
    s_waitcnt lgkmcnt(5)
    v_mfma_f32_16x16x32_bf16 v[236:239], v[196:199], v[220:223], v[236:239]
    ds_read_b128 v[220:223], v248 offset:7168
    ds_read_b128 v[192:195], v252 offset:1024
    ds_read_b128 v[196:199], v252 offset:7168
    s_waitcnt lgkmcnt(7)
    v_mfma_f32_16x16x32_bf16 v[224:227], v[200:203], v[16:19], v[224:227]
    s_waitcnt lgkmcnt(6)
    s_waitcnt lgkmcnt(5)
    v_mfma_f32_16x16x32_bf16 v[224:227], v[204:207], v[208:211], v[224:227]
    ds_read_b128 v[208:211], v248 offset:8192
    v_mfma_f32_16x16x32_bf16 v[228:231], v[200:203], v[20:23], v[228:231]
    s_waitcnt lgkmcnt(5)
    v_mfma_f32_16x16x32_bf16 v[228:231], v[204:207], v[212:215], v[228:231]
    ds_read_b128 v[212:215], v248 offset:9216
    v_mfma_f32_16x16x32_bf16 v[232:235], v[200:203], v[24:27], v[232:235]
    s_waitcnt lgkmcnt(5)
    v_mfma_f32_16x16x32_bf16 v[232:235], v[204:207], v[216:219], v[232:235]
    ds_read_b128 v[216:219], v248 offset:10240
    v_mfma_f32_16x16x32_bf16 v[236:239], v[200:203], v[28:31], v[236:239]
    s_waitcnt lgkmcnt(5)
    v_mfma_f32_16x16x32_bf16 v[236:239], v[204:207], v[220:223], v[236:239]
    ds_read_b128 v[220:223], v248 offset:11264
    s_barrier
    ds_read_b128 v[200:203], v252 offset:1536
    ds_read_b128 v[204:207], v252 offset:7680
    s_waitcnt lgkmcnt(7)
    v_mfma_f32_16x16x32_bf16 v[224:227], v[192:195], v[32:35], v[224:227]
    s_waitcnt lgkmcnt(6)
    s_waitcnt lgkmcnt(5)
    v_mfma_f32_16x16x32_bf16 v[224:227], v[196:199], v[208:211], v[224:227]
    ds_read_b128 v[208:211], v248 offset:12288
    v_mfma_f32_16x16x32_bf16 v[228:231], v[192:195], v[36:39], v[228:231]
    s_waitcnt lgkmcnt(5)
    v_mfma_f32_16x16x32_bf16 v[228:231], v[196:199], v[212:215], v[228:231]
    ds_read_b128 v[212:215], v248 offset:13312
    v_mfma_f32_16x16x32_bf16 v[232:235], v[192:195], v[40:43], v[232:235]
    s_waitcnt lgkmcnt(5)
    v_mfma_f32_16x16x32_bf16 v[232:235], v[196:199], v[216:219], v[232:235]
    ds_read_b128 v[216:219], v248 offset:14336
    v_mfma_f32_16x16x32_bf16 v[236:239], v[192:195], v[44:47], v[236:239]
    s_waitcnt lgkmcnt(5)
    v_mfma_f32_16x16x32_bf16 v[236:239], v[196:199], v[220:223], v[236:239]
    ds_read_b128 v[220:223], v248 offset:15360
    ds_read_b128 v[192:195], v252 offset:2048
    ds_read_b128 v[196:199], v252 offset:8192
    s_waitcnt lgkmcnt(7)
    v_mfma_f32_16x16x32_bf16 v[224:227], v[200:203], v[48:51], v[224:227]
    s_waitcnt lgkmcnt(6)
    s_waitcnt lgkmcnt(5)
    v_mfma_f32_16x16x32_bf16 v[224:227], v[204:207], v[208:211], v[224:227]
    ds_read_b128 v[208:211], v248 offset:16384
    v_mfma_f32_16x16x32_bf16 v[228:231], v[200:203], v[52:55], v[228:231]
    s_waitcnt lgkmcnt(5)
    v_mfma_f32_16x16x32_bf16 v[228:231], v[204:207], v[212:215], v[228:231]
    ds_read_b128 v[212:215], v248 offset:17408
    v_mfma_f32_16x16x32_bf16 v[232:235], v[200:203], v[56:59], v[232:235]
    s_waitcnt lgkmcnt(5)
    v_mfma_f32_16x16x32_bf16 v[232:235], v[204:207], v[216:219], v[232:235]
    ds_read_b128 v[216:219], v248 offset:18432
    v_mfma_f32_16x16x32_bf16 v[236:239], v[200:203], v[60:63], v[236:239]
    s_waitcnt lgkmcnt(5)
    v_mfma_f32_16x16x32_bf16 v[236:239], v[204:207], v[220:223], v[236:239]
    ds_read_b128 v[220:223], v248 offset:19456
    ds_read_b128 v[200:203], v252 offset:2560
    ds_read_b128 v[204:207], v252 offset:8704
    s_waitcnt lgkmcnt(7)
    v_mfma_f32_16x16x32_bf16 v[224:227], v[192:195], v[64:67], v[224:227]
    s_waitcnt lgkmcnt(6)
    s_waitcnt lgkmcnt(5)
    v_mfma_f32_16x16x32_bf16 v[224:227], v[196:199], v[208:211], v[224:227]
    ds_read_b128 v[208:211], v248 offset:20480
    v_mfma_f32_16x16x32_bf16 v[228:231], v[192:195], v[68:71], v[228:231]
    s_waitcnt lgkmcnt(5)
    v_mfma_f32_16x16x32_bf16 v[228:231], v[196:199], v[212:215], v[228:231]
    ds_read_b128 v[212:215], v248 offset:21504
    v_mfma_f32_16x16x32_bf16 v[232:235], v[192:195], v[72:75], v[232:235]
    s_waitcnt lgkmcnt(5)
    v_mfma_f32_16x16x32_bf16 v[232:235], v[196:199], v[216:219], v[232:235]
    ds_read_b128 v[216:219], v248 offset:22528
    v_mfma_f32_16x16x32_bf16 v[236:239], v[192:195], v[76:79], v[236:239]
    s_waitcnt lgkmcnt(5)
    v_mfma_f32_16x16x32_bf16 v[236:239], v[196:199], v[220:223], v[236:239]
    ds_read_b128 v[220:223], v248 offset:23552
    ds_read_b128 v[192:195], v252 offset:3072
    ds_read_b128 v[196:199], v252 offset:9216
    s_waitcnt lgkmcnt(7)
    v_mfma_f32_16x16x32_bf16 v[224:227], v[200:203], v[80:83], v[224:227]
    s_waitcnt lgkmcnt(6)
    s_waitcnt lgkmcnt(5)
    v_mfma_f32_16x16x32_bf16 v[224:227], v[204:207], v[208:211], v[224:227]
    ds_read_b128 v[208:211], v248 offset:24576
    v_mfma_f32_16x16x32_bf16 v[228:231], v[200:203], v[84:87], v[228:231]
    s_waitcnt lgkmcnt(5)
    v_mfma_f32_16x16x32_bf16 v[228:231], v[204:207], v[212:215], v[228:231]
    ds_read_b128 v[212:215], v248 offset:25600
    v_mfma_f32_16x16x32_bf16 v[232:235], v[200:203], v[88:91], v[232:235]
    s_waitcnt lgkmcnt(5)
    v_mfma_f32_16x16x32_bf16 v[232:235], v[204:207], v[216:219], v[232:235]
    ds_read_b128 v[216:219], v248 offset:26624
    v_mfma_f32_16x16x32_bf16 v[236:239], v[200:203], v[92:95], v[236:239]
    s_waitcnt lgkmcnt(5)
    v_mfma_f32_16x16x32_bf16 v[236:239], v[204:207], v[220:223], v[236:239]
    ds_read_b128 v[220:223], v248 offset:27648
    ds_read_b128 v[200:203], v252 offset:3584
    ds_read_b128 v[204:207], v252 offset:9728
    s_waitcnt lgkmcnt(7)
    v_mfma_f32_16x16x32_bf16 v[224:227], v[192:195], v[96:99], v[224:227]
    s_waitcnt lgkmcnt(6)
    s_waitcnt lgkmcnt(5)
    v_mfma_f32_16x16x32_bf16 v[224:227], v[196:199], v[208:211], v[224:227]
    ds_read_b128 v[208:211], v248 offset:28672
    v_mfma_f32_16x16x32_bf16 v[228:231], v[192:195], v[100:103], v[228:231]
    s_waitcnt lgkmcnt(5)
    v_mfma_f32_16x16x32_bf16 v[228:231], v[196:199], v[212:215], v[228:231]
    ds_read_b128 v[212:215], v248 offset:29696
    v_mfma_f32_16x16x32_bf16 v[232:235], v[192:195], v[104:107], v[232:235]
    s_waitcnt lgkmcnt(5)
    v_mfma_f32_16x16x32_bf16 v[232:235], v[196:199], v[216:219], v[232:235]
    ds_read_b128 v[216:219], v248 offset:30720
    v_mfma_f32_16x16x32_bf16 v[236:239], v[192:195], v[108:111], v[236:239]
    s_waitcnt lgkmcnt(5)
    v_mfma_f32_16x16x32_bf16 v[236:239], v[196:199], v[220:223], v[236:239]
    ds_read_b128 v[220:223], v248 offset:31744
    ds_read_b128 v[192:195], v252 offset:4096
    ds_read_b128 v[196:199], v252 offset:4608
    s_waitcnt lgkmcnt(7)
    v_mfma_f32_16x16x32_bf16 v[224:227], v[200:203], v[112:115], v[224:227]
    s_waitcnt lgkmcnt(6)
    s_waitcnt lgkmcnt(5)
    v_mfma_f32_16x16x32_bf16 v[224:227], v[204:207], v[208:211], v[224:227]
    v_mfma_f32_16x16x32_bf16 v[228:231], v[200:203], v[116:119], v[228:231]
    s_waitcnt lgkmcnt(4)
    v_mfma_f32_16x16x32_bf16 v[228:231], v[204:207], v[212:215], v[228:231]
    v_mfma_f32_16x16x32_bf16 v[232:235], v[200:203], v[120:123], v[232:235]
    s_waitcnt lgkmcnt(3)
    v_mfma_f32_16x16x32_bf16 v[232:235], v[204:207], v[216:219], v[232:235]
    v_mfma_f32_16x16x32_bf16 v[236:239], v[200:203], v[124:127], v[236:239]
    s_waitcnt lgkmcnt(2)
    v_mfma_f32_16x16x32_bf16 v[236:239], v[204:207], v[220:223], v[236:239]
    ds_read_b128 v[200:203], v252 offset:5120
    ds_read_b128 v[204:207], v252 offset:5632
    s_waitcnt lgkmcnt(3)
    v_mfma_f32_16x16x32_bf16 v[224:227], v[192:195], v[128:131], v[224:227]
    s_waitcnt lgkmcnt(2)
    v_mfma_f32_16x16x32_bf16 v[224:227], v[196:199], v[144:147], v[224:227]
    s_waitcnt lgkmcnt(1)
    v_mfma_f32_16x16x32_bf16 v[224:227], v[200:203], v[160:163], v[224:227]
    s_waitcnt lgkmcnt(0)
    v_mfma_f32_16x16x32_bf16 v[224:227], v[204:207], v[176:179], v[224:227]
    v_mfma_f32_16x16x32_bf16 v[228:231], v[192:195], v[132:135], v[228:231]
    v_mfma_f32_16x16x32_bf16 v[228:231], v[196:199], v[148:151], v[228:231]
    v_mfma_f32_16x16x32_bf16 v[228:231], v[200:203], v[164:167], v[228:231]
    v_mfma_f32_16x16x32_bf16 v[228:231], v[204:207], v[180:183], v[228:231]
    s_nop 3
    v_cvt_pk_bf16_f32 v208, v224, v225
    v_cvt_pk_bf16_f32 v209, v226, v227
    s_mov_b32 exec_hi, 0
    ds_write_b32 v244, v208 offset:0
    ds_write_b32 v244, v209 offset:256
    s_mov_b32 exec_hi, -1
    v_mfma_f32_16x16x32_bf16 v[232:235], v[192:195], v[136:139], v[232:235]
    v_mfma_f32_16x16x32_bf16 v[232:235], v[196:199], v[152:155], v[232:235]
    v_mfma_f32_16x16x32_bf16 v[232:235], v[200:203], v[168:171], v[232:235]
    v_mfma_f32_16x16x32_bf16 v[232:235], v[204:207], v[184:187], v[232:235]
    s_nop 3
    v_cvt_pk_bf16_f32 v210, v228, v229
    v_cvt_pk_bf16_f32 v211, v230, v231
    s_mov_b32 exec_hi, 0
    ds_write_b32 v244, v210 offset:1024
    ds_write_b32 v244, v211 offset:1280
    s_mov_b32 exec_hi, -1
    v_mfma_f32_16x16x32_bf16 v[236:239], v[192:195], v[140:143], v[236:239]
    v_mfma_f32_16x16x32_bf16 v[236:239], v[196:199], v[156:159], v[236:239]
    v_mfma_f32_16x16x32_bf16 v[236:239], v[200:203], v[172:175], v[236:239]
    v_mfma_f32_16x16x32_bf16 v[236:239], v[204:207], v[188:191], v[236:239]
    s_nop 3
    v_cvt_pk_bf16_f32 v212, v232, v233
    v_cvt_pk_bf16_f32 v213, v234, v235
    s_mov_b32 exec_hi, 0
    ds_write_b32 v244, v212 offset:2048
    ds_write_b32 v244, v213 offset:2304
    s_mov_b32 exec_hi, -1
    s_nop 1
    v_cvt_pk_bf16_f32 v214, v236, v237
    v_cvt_pk_bf16_f32 v215, v238, v239
    s_mov_b32 exec_hi, 0
    ds_write_b32 v244, v214 offset:3072
    ds_write_b32 v244, v215 offset:3328
    s_mov_b32 exec_hi, -1
    s_mov_b32 exec_hi, 0
    s_waitcnt lgkmcnt(0)
    s_barrier
    ds_write_b64 v245, v[208:209] offset:0
    ds_write_b64 v245, v[210:211] offset:128
    ds_write_b64 v245, v[212:213] offset:512
    ds_write_b64 v245, v[214:215] offset:640
    s_mov_b32 exec_hi, -1
    s_waitcnt lgkmcnt(0)
    s_cmp_eq_u32 s27, 63
    s_cbranch_scc1 REC_endS
    s_sleep 11
REC_poll_32:
    buffer_load_dwordx4 v[224:227], v246, s[12:15], s30 offen sc1
    s_sub_u32 s46, s46, 1
    s_cbranch_scc1 REC_pdone_33_x
    s_waitcnt vmcnt(0)
    v_max3_u32 v228, v224, v225, v226
    v_max_u32 v228, v228, v227
    v_cmp_eq_u32 vcc, -1, v228
    s_cbranch_vccnz REC_poll_32
    s_branch REC_pdone_33
REC_pdone_33_x:
    s_mov_b32 s46, 0
    s_waitcnt vmcnt(0)
REC_pdone_33:
    v_lshlrev_b32 v228, 16, v224
    v_and_b32 v229, 0xffff0000, v224
    v_lshlrev_b32 v232, 16, v226
    v_and_b32 v233, 0xffff0000, v226
    v_lshlrev_b32 v230, 16, v225
    v_and_b32 v231, 0xffff0000, v225
    v_lshlrev_b32 v234, 16, v227
    v_and_b32 v235, 0xffff0000, v227
    v_permlane32_swap_b32 v228, v232
    v_permlane32_swap_b32 v229, v233
    v_permlane32_swap_b32 v230, v234
    v_permlane32_swap_b32 v231, v235
    v_pk_add_f32 v[228:229], v[228:229], v[232:233]
    v_pk_add_f32 v[230:231], v[230:231], v[234:235]
    s_nop 1
    v_permlane16_swap_b32 v228, v230
    v_permlane16_swap_b32 v229, v231
    v_pk_add_f32 v[228:229], v[228:229], v[230:231]
    s_nop 1
    v_add_f32_dpp v228, v228, v228 row_ror:8 row_mask:0xf bank_mask:0xf
    v_add_f32_dpp v229, v229, v229 row_ror:8 row_mask:0xf bank_mask:0xf
    v_cvt_pk_bf16_f32 v224, v228, v229
    v_min_u32 v224, s49, v224
    buffer_store_dword v224, v247, s[12:15], s33 offen
REC_endS:
    s_add_u32 s57, s27, 2
    s_min_u32 s57, s57, 64
REC_rlp_34:
    buffer_load_dword v224, v250, s[12:15], s93 offen sc1
    s_sub_u32 s46, s46, 1
    s_cbranch_scc1 REC_rok_35_x
    s_waitcnt vmcnt(0)
    v_cmp_gt_u32 vcc, s57, v224
    s_cbranch_vccz REC_rok_35
    s_sleep 2
    s_branch REC_rlp_34
REC_rok_35_x:
    s_mov_b32 s46, 0
REC_rok_35:
    s_add_u32 s27, s27, 1
    s_cmp_lt_u32 s27, 64
    s_cbranch_scc1 REC_loopS
    s_barrier
    ds_read_b128 v[224:227], v251
    ds_read_b128 v[228:231], v249 offset:30720
    s_waitcnt lgkmcnt(0)
    s_cmp_ge_u32 s20, 10
    s_cbranch_scc1 REC_fl_36_a
    buffer_store_dwordx4 v[224:227], v249, s[12:15], s38 offen sc1
REC_fl_36_a:
    s_cmp_lg_u32 s17, 4
    s_cbranch_scc1 REC_fl_36_b
    buffer_store_dwordx4 v[228:231], v249, s[12:15], s37 offen sc1
REC_fl_36_b:
    s_add_u32 s38, s38, 327680
    s_add_u32 s37, s37, 98304
    s_cmp_lg_u32 s17, 5
    s_cbranch_scc1 REC_nofp
    s_cmp_lg_u32 s16, 11
    s_cbranch_scc1 REC_nofp
    s_mov_b32 s40, 66
    v_mov_b32 v232, s40
    v_mov_b32 v233, s59
    buffer_store_dword v232, v233, s[12:15], s93 offen sc1
REC_nofp:
    s_waitcnt vmcnt(0)
    s_barrier
    s_cmp_lg_u32 s17, 7
    s_cbranch_scc1 REC_done
    v_mov_b32 v232, s27
    v_mov_b32 v233, s60
    buffer_store_dword v232, v233, s[12:15], s93 offen sc1
REC_done:
    s_branch RECB_done
    v_and_b32 v250, 15, v255
    v_lshrrev_b32 v251, 4, v255
    v_and_b32 v252, 7, v255
    v_bfe_u32 v253, v255, 3, 1
    s_sub_u32 s24, 0, s4
    s_and_b32 s24, s24, 0x1fffff
    s_cmp_ge_u32 s16, 12
    s_cselect_b32 s19, 1, 0
    s_mul_i32 s40, s19, 12
    s_sub_u32 s20, s16, s40
    s_mul_i32 s55, s19, 10
    s_add_u32 s55, s55, s20
    s_lshl_b32 s40, s18, 1
    s_add_u32 s19, s19, s40
    s_mul_i32 s21, s20, 11
    s_lshr_b32 s21, s21, 5
    s_mul_i32 s40, s21, 3
    s_sub_u32 s22, s20, s40
    s_and_b32 s23, s17, 3
    s_lshl_b32 s25, s19, 2
    s_add_u32 s26, s25, s23
    s_add_u32 s25, s25, s21
    s_mul_i32 s47, s19, 8192
    s_add_u32 s47, s47, 3145728
    s_mul_i32 s48, s18, 10240
    s_add_u32 s48, s48, 3407872
    s_mov_b32 s49, 0xfffffffe
    s_mov_b32 s46, 4000000
    s_lshl_b32 s56, s22, 2
    s_add_u32 s56, s56, s23
    s_mul_i32 s50, s25, 384
    s_lshl_b32 s40, s56, 5
    s_add_u32 s50, s50, s40
    s_mul_i32 s51, s17, 20480
    v_lshlrev_b32 v249, 4, v255
    v_add_u32 v248, s51, v249
    v_bfe_u32 v247, v255, 2, 2
    v_and_b32 v245, 3, v255
    v_lshl_add_u32 v246, v251, 2, v247
    v_lshlrev_b32 v246, 5, v246
    v_lshl_add_u32 v246, v245, 3, v246
    v_add_u32 v246, s51, v246
    v_lshl_add_u32 v244, v251, 3, v247
    v_lshlrev_b32 v244, 7, v244
    v_lshl_add_u32 v244, v245, 3, v244
    v_add_u32 v244, s51, v244
    v_lshlrev_b32 v243, 7, v251
    v_lshl_add_u32 v243, v252, 4, v243
    v_mov_b32 v242, 2130706432
    s_mov_b32 s27, 0
    s_mul_i32 s58, s23, 32768
    s_add_u32 s58, s58, 32768
    s_lshl_b32 s51, s23, 13
    s_mov_b32 s76, s51
    s_add_u32 s77, s58, 20480
    s_add_u32 s78, s58, 26624
    s_mov_b32 s44, 0x00ff00ff
    s_mov_b32 s45, 0x00ff00ff
    s_cmp_ge_u32 s17, 4
    s_cbranch_scc1 RECB_yw
    s_cmp_ge_u32 s20, 10
    s_cbranch_scc1 RECB_qkw
    s_load_dwordx2 s[8:9], s[0:1], 40
    s_mov_b32 s10, 7864320
    s_mov_b32 s11, 0x00020000
    s_mul_i32 s54, s26, 245760
    s_lshl_b32 s40, s20, 7
    s_add_u32 s54, s54, s40
    v_lshrrev_b32 v236, 3, v255
    v_mul_u32_u24 v236, 1280, v236
    v_lshl_add_u32 v236, v252, 4, v236
    s_waitcnt lgkmcnt(0)
    buffer_load_dwordx4 v[0:3], v236, s[8:11], s54 offen
    s_add_u32 s54, s54, 10240
    buffer_load_dwordx4 v[4:7], v236, s[8:11], s54 offen
    s_add_u32 s54, s54, 10240
    buffer_load_dwordx4 v[8:11], v236, s[8:11], s54 offen
    s_add_u32 s54, s54, 10240
    buffer_load_dwordx4 v[12:15], v236, s[8:11], s54 offen
    s_add_u32 s54, s54, 10240
    buffer_load_dwordx4 v[16:19], v236, s[8:11], s54 offen
    s_add_u32 s54, s54, 10240
    buffer_load_dwordx4 v[20:23], v236, s[8:11], s54 offen
    s_add_u32 s54, s54, 10240
    buffer_load_dwordx4 v[24:27], v236, s[8:11], s54 offen
    s_add_u32 s54, s54, 10240
    buffer_load_dwordx4 v[28:31], v236, s[8:11], s54 offen
    s_add_u32 s54, s54, 10240
    buffer_load_dwordx4 v[32:35], v236, s[8:11], s54 offen
    s_add_u32 s54, s54, 10240
    buffer_load_dwordx4 v[36:39], v236, s[8:11], s54 offen
    s_add_u32 s54, s54, 10240
    buffer_load_dwordx4 v[40:43], v236, s[8:11], s54 offen
    s_add_u32 s54, s54, 10240
    buffer_load_dwordx4 v[44:47], v236, s[8:11], s54 offen
    s_add_u32 s54, s54, 10240
    buffer_load_dwordx4 v[48:51], v236, s[8:11], s54 offen
    s_add_u32 s54, s54, 10240
    buffer_load_dwordx4 v[52:55], v236, s[8:11], s54 offen
    s_add_u32 s54, s54, 10240
    buffer_load_dwordx4 v[56:59], v236, s[8:11], s54 offen
    s_add_u32 s54, s54, 10240
    buffer_load_dwordx4 v[60:63], v236, s[8:11], s54 offen
    s_add_u32 s54, s54, 10240
    buffer_load_dwordx4 v[64:67], v236, s[8:11], s54 offen
    s_add_u32 s54, s54, 10240
    buffer_load_dwordx4 v[68:71], v236, s[8:11], s54 offen
    s_add_u32 s54, s54, 10240
    buffer_load_dwordx4 v[72:75], v236, s[8:11], s54 offen
    s_add_u32 s54, s54, 10240
    buffer_load_dwordx4 v[76:79], v236, s[8:11], s54 offen
    s_add_u32 s54, s54, 10240
    buffer_load_dwordx4 v[80:83], v236, s[8:11], s54 offen
    s_add_u32 s54, s54, 10240
    buffer_load_dwordx4 v[84:87], v236, s[8:11], s54 offen
    s_add_u32 s54, s54, 10240
    buffer_load_dwordx4 v[88:91], v236, s[8:11], s54 offen
    s_add_u32 s54, s54, 10240
    buffer_load_dwordx4 v[92:95], v236, s[8:11], s54 offen
    s_add_u32 s54, s54, 10240
    v_mul_u32_u24 v237, 384, v250
    v_xor_b32 v238, v251, v252
    v_lshl_add_u32 v240, v238, 4, v237
    v_or_b32 v238, 4, v251
    v_xor_b32 v238, v238, v252
    v_lshl_add_u32 v241, v238, 4, v237
    v_add_u32 v248, s58, v249
    v_lshl_add_u32 v244, v251, 3, v247
    v_lshlrev_b32 v244, 7, v244
    v_lshl_add_u32 v244, v245, 3, v244
    v_add_u32 v244, s58, v244
    s_waitcnt vmcnt(0)
    ds_write_b128 v248, v[0:3] offset:0
    ds_write_b128 v248, v[4:7] offset:1024
    ds_write_b128 v248, v[8:11] offset:2048
    ds_write_b128 v248, v[12:15] offset:3072
    ds_write_b128 v248, v[16:19] offset:4096
    ds_write_b128 v248, v[20:23] offset:5120
    ds_write_b128 v248, v[24:27] offset:6144
    ds_write_b128 v248, v[28:31] offset:7168
    ds_write_b128 v248, v[32:35] offset:8192
    ds_write_b128 v248, v[36:39] offset:9216
    ds_write_b128 v248, v[40:43] offset:10240
    ds_write_b128 v248, v[44:47] offset:11264
    s_waitcnt lgkmcnt(0)
    ds_read_b64_tr_b16 v[0:1], v244 offset:0
    ds_read_b64_tr_b16 v[2:3], v244 offset:512
    ds_read_b64_tr_b16 v[4:5], v244 offset:32
    ds_read_b64_tr_b16 v[6:7], v244 offset:544
    ds_read_b64_tr_b16 v[8:9], v244 offset:64
    ds_read_b64_tr_b16 v[10:11], v244 offset:576
    ds_read_b64_tr_b16 v[12:13], v244 offset:96
    ds_read_b64_tr_b16 v[14:15], v244 offset:608
    ds_read_b64_tr_b16 v[16:17], v244 offset:4096
    ds_read_b64_tr_b16 v[18:19], v244 offset:4608
    ds_read_b64_tr_b16 v[20:21], v244 offset:4128
    ds_read_b64_tr_b16 v[22:23], v244 offset:4640
    ds_read_b64_tr_b16 v[24:25], v244 offset:4160
    ds_read_b64_tr_b16 v[26:27], v244 offset:4672
    ds_read_b64_tr_b16 v[28:29], v244 offset:4192
    ds_read_b64_tr_b16 v[30:31], v244 offset:4704
    ds_read_b64_tr_b16 v[32:33], v244 offset:8192
    ds_read_b64_tr_b16 v[34:35], v244 offset:8704
    ds_read_b64_tr_b16 v[36:37], v244 offset:8224
    ds_read_b64_tr_b16 v[38:39], v244 offset:8736
    ds_read_b64_tr_b16 v[40:41], v244 offset:8256
    ds_read_b64_tr_b16 v[42:43], v244 offset:8768
    ds_read_b64_tr_b16 v[44:45], v244 offset:8288
    ds_read_b64_tr_b16 v[46:47], v244 offset:8800
    s_waitcnt lgkmcnt(0)
    ds_write_b128 v248, v[48:51] offset:0
    ds_write_b128 v248, v[52:55] offset:1024
    ds_write_b128 v248, v[56:59] offset:2048
    ds_write_b128 v248, v[60:63] offset:3072
    ds_write_b128 v248, v[64:67] offset:4096
    ds_write_b128 v248, v[68:71] offset:5120
    ds_write_b128 v248, v[72:75] offset:6144
    ds_write_b128 v248, v[76:79] offset:7168
    ds_write_b128 v248, v[80:83] offset:8192
    ds_write_b128 v248, v[84:87] offset:9216
    ds_write_b128 v248, v[88:91] offset:10240
    ds_write_b128 v248, v[92:95] offset:11264
    s_waitcnt lgkmcnt(0)
    ds_read_b64_tr_b16 v[48:49], v244 offset:0
    ds_read_b64_tr_b16 v[50:51], v244 offset:512
    ds_read_b64_tr_b16 v[52:53], v244 offset:32
    ds_read_b64_tr_b16 v[54:55], v244 offset:544
    ds_read_b64_tr_b16 v[56:57], v244 offset:64
    ds_read_b64_tr_b16 v[58:59], v244 offset:576
    ds_read_b64_tr_b16 v[60:61], v244 offset:96
    ds_read_b64_tr_b16 v[62:63], v244 offset:608
    ds_read_b64_tr_b16 v[64:65], v244 offset:4096
    ds_read_b64_tr_b16 v[66:67], v244 offset:4608
    ds_read_b64_tr_b16 v[68:69], v244 offset:4128
    ds_read_b64_tr_b16 v[70:71], v244 offset:4640
    ds_read_b64_tr_b16 v[72:73], v244 offset:4160
    ds_read_b64_tr_b16 v[74:75], v244 offset:4672
    ds_read_b64_tr_b16 v[76:77], v244 offset:4192
    ds_read_b64_tr_b16 v[78:79], v244 offset:4704
    ds_read_b64_tr_b16 v[80:81], v244 offset:8192
    ds_read_b64_tr_b16 v[82:83], v244 offset:8704
    ds_read_b64_tr_b16 v[84:85], v244 offset:8224
    ds_read_b64_tr_b16 v[86:87], v244 offset:8736
    ds_read_b64_tr_b16 v[88:89], v244 offset:8256
    ds_read_b64_tr_b16 v[90:91], v244 offset:8768
    ds_read_b64_tr_b16 v[92:93], v244 offset:8288
    ds_read_b64_tr_b16 v[94:95], v244 offset:8800
    s_waitcnt lgkmcnt(0)
    s_barrier
    v_add_u32 v246, s76, v240
    v_add_u32 v244, s76, v241
    s_mov_b32 s40, s76
    s_mov_b32 s76, s77
    s_mov_b32 s77, s78
    s_mov_b32 s78, s40
    ds_read_b128 v[96:99], v246 offset:0
    ds_read_b128 v[100:103], v244 offset:0
    ds_read_b128 v[104:107], v246 offset:128
    ds_read_b128 v[108:111], v244 offset:128
    ds_read_b128 v[112:115], v246 offset:256
    ds_read_b128 v[116:119], v244 offset:256
    s_waitcnt lgkmcnt(0)
    s_mov_b32 s53, 0
RECB_bloop:
    s_barrier
    v_add_u32 v246, s76, v240
    v_add_u32 v244, s76, v241
    s_mov_b32 s40, s76
    s_mov_b32 s76, s77
    s_mov_b32 s77, s78
    s_mov_b32 s78, s40
    ds_read_b128 v[120:123], v246 offset:0
    ds_read_b128 v[124:127], v244 offset:0
    ds_read_b128 v[128:131], v246 offset:128
    ds_read_b128 v[132:135], v244 offset:128
    ds_read_b128 v[136:139], v246 offset:256
    ds_read_b128 v[140:143], v244 offset:256
    v_mfma_f32_16x16x32_bf16 v[144:147], v[96:99], v[0:3], 0
    v_mfma_f32_16x16x32_bf16 v[148:151], v[96:99], v[4:7], 0
    v_mfma_f32_16x16x32_bf16 v[152:155], v[96:99], v[8:11], 0
    v_mfma_f32_16x16x32_bf16 v[156:159], v[96:99], v[12:15], 0
    v_mfma_f32_16x16x32_bf16 v[144:147], v[100:103], v[16:19], v[144:147]
    v_mfma_f32_16x16x32_bf16 v[148:151], v[100:103], v[20:23], v[148:151]
    v_mfma_f32_16x16x32_bf16 v[152:155], v[100:103], v[24:27], v[152:155]
    v_mfma_f32_16x16x32_bf16 v[156:159], v[100:103], v[28:31], v[156:159]
    v_mfma_f32_16x16x32_bf16 v[144:147], v[104:107], v[32:35], v[144:147]
    v_mfma_f32_16x16x32_bf16 v[148:151], v[104:107], v[36:39], v[148:151]
    v_mfma_f32_16x16x32_bf16 v[152:155], v[104:107], v[40:43], v[152:155]
    v_mfma_f32_16x16x32_bf16 v[156:159], v[104:107], v[44:47], v[156:159]
    v_mfma_f32_16x16x32_bf16 v[144:147], v[108:111], v[48:51], v[144:147]
    v_mfma_f32_16x16x32_bf16 v[148:151], v[108:111], v[52:55], v[148:151]
    v_mfma_f32_16x16x32_bf16 v[152:155], v[108:111], v[56:59], v[152:155]
    v_mfma_f32_16x16x32_bf16 v[156:159], v[108:111], v[60:63], v[156:159]
    v_mfma_f32_16x16x32_bf16 v[144:147], v[112:115], v[64:67], v[144:147]
    v_mfma_f32_16x16x32_bf16 v[148:151], v[112:115], v[68:71], v[148:151]
    v_mfma_f32_16x16x32_bf16 v[152:155], v[112:115], v[72:75], v[152:155]
    v_mfma_f32_16x16x32_bf16 v[156:159], v[112:115], v[76:79], v[156:159]
    v_mfma_f32_16x16x32_bf16 v[144:147], v[116:119], v[80:83], v[144:147]
    v_mfma_f32_16x16x32_bf16 v[148:151], v[116:119], v[84:87], v[148:151]
    v_mfma_f32_16x16x32_bf16 v[152:155], v[116:119], v[88:91], v[152:155]
    v_mfma_f32_16x16x32_bf16 v[156:159], v[116:119], v[92:95], v[156:159]
    s_waitcnt lgkmcnt(0)
    s_cmp_eq_u32 s53, 19
    s_cbranch_scc1 RECB_blast
    s_barrier
    v_add_u32 v246, s76, v240
    v_add_u32 v244, s76, v241
    s_mov_b32 s40, s76
    s_mov_b32 s76, s77
    s_mov_b32 s77, s78
    s_mov_b32 s78, s40
    ds_read_b128 v[96:99], v246 offset:0
    ds_read_b128 v[100:103], v244 offset:0
    ds_read_b128 v[104:107], v246 offset:128
    ds_read_b128 v[108:111], v244 offset:128
    ds_read_b128 v[112:115], v246 offset:256
    ds_read_b128 v[116:119], v244 offset:256
RECB_blast:
    v_mfma_f32_16x16x32_bf16 v[160:163], v[120:123], v[0:3], 0
    v_mfma_f32_16x16x32_bf16 v[164:167], v[120:123], v[4:7], 0
    v_mfma_f32_16x16x32_bf16 v[168:171], v[120:123], v[8:11], 0
    v_mfma_f32_16x16x32_bf16 v[172:175], v[120:123], v[12:15], 0
    v_mfma_f32_16x16x32_bf16 v[160:163], v[124:127], v[16:19], v[160:163]
    v_mfma_f32_16x16x32_bf16 v[164:167], v[124:127], v[20:23], v[164:167]
    v_mfma_f32_16x16x32_bf16 v[168:171], v[124:127], v[24:27], v[168:171]
    v_mfma_f32_16x16x32_bf16 v[172:175], v[124:127], v[28:31], v[172:175]
    v_mfma_f32_16x16x32_bf16 v[160:163], v[128:131], v[32:35], v[160:163]
    v_mfma_f32_16x16x32_bf16 v[164:167], v[128:131], v[36:39], v[164:167]
    v_mfma_f32_16x16x32_bf16 v[168:171], v[128:131], v[40:43], v[168:171]
    v_mfma_f32_16x16x32_bf16 v[172:175], v[128:131], v[44:47], v[172:175]
    v_mfma_f32_16x16x32_bf16 v[160:163], v[132:135], v[48:51], v[160:163]
    v_mfma_f32_16x16x32_bf16 v[164:167], v[132:135], v[52:55], v[164:167]
    v_mfma_f32_16x16x32_bf16 v[168:171], v[132:135], v[56:59], v[168:171]
    v_mfma_f32_16x16x32_bf16 v[172:175], v[132:135], v[60:63], v[172:175]
    v_mfma_f32_16x16x32_bf16 v[160:163], v[136:139], v[64:67], v[160:163]
    v_mfma_f32_16x16x32_bf16 v[164:167], v[136:139], v[68:71], v[164:167]
    v_mfma_f32_16x16x32_bf16 v[168:171], v[136:139], v[72:75], v[168:171]
    v_mfma_f32_16x16x32_bf16 v[172:175], v[136:139], v[76:79], v[172:175]
    v_mfma_f32_16x16x32_bf16 v[160:163], v[140:143], v[80:83], v[160:163]
    v_mfma_f32_16x16x32_bf16 v[164:167], v[140:143], v[84:87], v[164:167]
    v_mfma_f32_16x16x32_bf16 v[168:171], v[140:143], v[88:91], v[168:171]
    v_mfma_f32_16x16x32_bf16 v[172:175], v[140:143], v[92:95], v[172:175]
    s_and_b32 s40, s53, 1
    s_lshl_b32 s40, s40, 12
    s_add_u32 s40, s40, 8192
    s_sub_u32 s41, s53, 12
    s_lshl_b32 s41, s41, 12
    s_cmp_lt_u32 s53, 12
    s_cselect_b32 s40, s40, s41
    v_add_u32 v242, s40, v248
    s_nop 3
    v_cvt_pk_bf16_f32 v224, v144, v145
    v_cvt_pk_bf16_f32 v225, v146, v147
    v_cvt_pk_bf16_f32 v226, v160, v161
    v_cvt_pk_bf16_f32 v227, v162, v163
    v_cvt_pk_bf16_f32 v228, v148, v149
    v_cvt_pk_bf16_f32 v229, v150, v151
    v_cvt_pk_bf16_f32 v230, v164, v165
    v_cvt_pk_bf16_f32 v231, v166, v167
    v_cvt_pk_bf16_f32 v232, v152, v153
    v_cvt_pk_bf16_f32 v233, v154, v155
    v_cvt_pk_bf16_f32 v234, v168, v169
    v_cvt_pk_bf16_f32 v235, v170, v171
    v_cvt_pk_bf16_f32 v236, v156, v157
    v_cvt_pk_bf16_f32 v237, v158, v159
    v_cvt_pk_bf16_f32 v238, v172, v173
    v_cvt_pk_bf16_f32 v239, v174, v175
    s_cmp_ge_u32 s53, 17
    s_cbranch_scc1 RECB_bhold
    ds_write_b128 v242, v[224:227] offset:0
    ds_write_b128 v242, v[228:231] offset:1024
    ds_write_b128 v242, v[232:235] offset:2048
    ds_write_b128 v242, v[236:239] offset:3072
    s_branch RECB_bnext
RECB_bhold:
    s_cmp_lg_u32 s53, 17
    s_cbranch_scc1 RECB_bh0
    v_mov_b32 v176, v224
    v_mov_b32 v177, v225
    v_mov_b32 v178, v226
    v_mov_b32 v179, v227
    v_mov_b32 v180, v228
    v_mov_b32 v181, v229
    v_mov_b32 v182, v230
    v_mov_b32 v183, v231
    v_mov_b32 v184, v232
    v_mov_b32 v185, v233
    v_mov_b32 v186, v234
    v_mov_b32 v187, v235
    v_mov_b32 v188, v236
    v_mov_b32 v189, v237
    v_mov_b32 v190, v238
    v_mov_b32 v191, v239
RECB_bh0:
    s_cmp_lg_u32 s53, 18
    s_cbranch_scc1 RECB_bh1
    v_mov_b32 v192, v224
    v_mov_b32 v193, v225
    v_mov_b32 v194, v226
    v_mov_b32 v195, v227
    v_mov_b32 v196, v228
    v_mov_b32 v197, v229
    v_mov_b32 v198, v230
    v_mov_b32 v199, v231
    v_mov_b32 v200, v232
    v_mov_b32 v201, v233
    v_mov_b32 v202, v234
    v_mov_b32 v203, v235
    v_mov_b32 v204, v236
    v_mov_b32 v205, v237
    v_mov_b32 v206, v238
    v_mov_b32 v207, v239
RECB_bh1:
    s_cmp_lg_u32 s53, 19
    s_cbranch_scc1 RECB_bh2
    v_mov_b32 v208, v224
    v_mov_b32 v209, v225
    v_mov_b32 v210, v226
    v_mov_b32 v211, v227
    v_mov_b32 v212, v228
    v_mov_b32 v213, v229
    v_mov_b32 v214, v230
    v_mov_b32 v215, v231
    v_mov_b32 v216, v232
    v_mov_b32 v217, v233
    v_mov_b32 v218, v234
    v_mov_b32 v219, v235
    v_mov_b32 v220, v236
    v_mov_b32 v221, v237
    v_mov_b32 v222, v238
    v_mov_b32 v223, v239
RECB_bh2:
RECB_bnext:
    s_waitcnt lgkmcnt(0)
    s_add_u32 s53, s53, 1
    s_cmp_lt_u32 s53, 20
    s_cbranch_scc1 RECB_bloop
    v_mov_b32 v242, 2130706432
    ds_write_b128 v248, v[176:179] offset:20480
    ds_write_b128 v248, v[180:183] offset:21504
    ds_write_b128 v248, v[184:187] offset:22528
    ds_write_b128 v248, v[188:191] offset:23552
    ds_write_b128 v248, v[192:195] offset:24576
    ds_write_b128 v248, v[196:199] offset:25600
    ds_write_b128 v248, v[200:203] offset:26624
    ds_write_b128 v248, v[204:207] offset:27648
    ds_write_b128 v248, v[208:211] offset:28672
    ds_write_b128 v248, v[212:215] offset:29696
    ds_write_b128 v248, v[216:219] offset:30720
    ds_write_b128 v248, v[220:223] offset:31744
    s_waitcnt lgkmcnt(0)
RECB_qkw:
    v_lshl_add_u32 v246, v251, 2, v247
    v_bfe_u32 v244, v246, 1, 2
    v_xor_b32 v244, s23, v244
    v_lshlrev_b32 v246, 7, v246
    v_lshl_add_u32 v246, v244, 5, v246
    v_lshl_add_u32 v246, v245, 3, v246
    s_barrier
    s_cmp_lg_u32 s23, 0
    s_cbranch_scc1 RECB_qk1
    s_barrier
    ds_read_b64_tr_b16 v[0:1], v246 offset:0
    ds_read_b64_tr_b16 v[2:3], v246 offset:2048
    ds_read_b64_tr_b16 v[4:5], v246 offset:4096
    ds_read_b64_tr_b16 v[6:7], v246 offset:6144
    s_waitcnt lgkmcnt(0)
    s_barrier
    ds_read_b64_tr_b16 v[8:9], v246 offset:8192
    ds_read_b64_tr_b16 v[10:11], v246 offset:10240
    ds_read_b64_tr_b16 v[12:13], v246 offset:12288
    ds_read_b64_tr_b16 v[14:15], v246 offset:14336
    s_waitcnt lgkmcnt(0)
    s_barrier
    ds_read_b64_tr_b16 v[16:17], v246 offset:16384
    ds_read_b64_tr_b16 v[18:19], v246 offset:18432
    ds_read_b64_tr_b16 v[20:21], v246 offset:20480
    ds_read_b64_tr_b16 v[22:23], v246 offset:22528
    s_waitcnt lgkmcnt(0)
    s_barrier
    ds_read_b64_tr_b16 v[24:25], v246 offset:24576
    ds_read_b64_tr_b16 v[26:27], v246 offset:26624
    ds_read_b64_tr_b16 v[28:29], v246 offset:28672
    ds_read_b64_tr_b16 v[30:31], v246 offset:30720
    s_waitcnt lgkmcnt(0)
    s_barrier
    ds_read_b64_tr_b16 v[32:33], v246 offset:0
    ds_read_b64_tr_b16 v[34:35], v246 offset:2048
    ds_read_b64_tr_b16 v[36:37], v246 offset:4096
    ds_read_b64_tr_b16 v[38:39], v246 offset:6144
    s_waitcnt lgkmcnt(0)
    s_barrier
    ds_read_b64_tr_b16 v[40:41], v246 offset:8192
    ds_read_b64_tr_b16 v[42:43], v246 offset:10240
    ds_read_b64_tr_b16 v[44:45], v246 offset:12288
    ds_read_b64_tr_b16 v[46:47], v246 offset:14336
    s_waitcnt lgkmcnt(0)
    s_barrier
    ds_read_b64_tr_b16 v[48:49], v246 offset:16384
    ds_read_b64_tr_b16 v[50:51], v246 offset:18432
    ds_read_b64_tr_b16 v[52:53], v246 offset:20480
    ds_read_b64_tr_b16 v[54:55], v246 offset:22528
    s_waitcnt lgkmcnt(0)
    s_barrier
    ds_read_b64_tr_b16 v[56:57], v246 offset:24576
    ds_read_b64_tr_b16 v[58:59], v246 offset:26624
    ds_read_b64_tr_b16 v[60:61], v246 offset:28672
    ds_read_b64_tr_b16 v[62:63], v246 offset:30720
    s_waitcnt lgkmcnt(0)
    s_barrier
    ds_read_b64_tr_b16 v[64:65], v246 offset:0
    ds_read_b64_tr_b16 v[66:67], v246 offset:2048
    ds_read_b64_tr_b16 v[68:69], v246 offset:4096
    ds_read_b64_tr_b16 v[70:71], v246 offset:6144
    s_waitcnt lgkmcnt(0)
    s_barrier
    ds_read_b64_tr_b16 v[72:73], v246 offset:8192
    ds_read_b64_tr_b16 v[74:75], v246 offset:10240
    ds_read_b64_tr_b16 v[76:77], v246 offset:12288
    ds_read_b64_tr_b16 v[78:79], v246 offset:14336
    s_waitcnt lgkmcnt(0)
    s_barrier
    ds_read_b64_tr_b16 v[80:81], v246 offset:16384
    ds_read_b64_tr_b16 v[82:83], v246 offset:18432
    ds_read_b64_tr_b16 v[84:85], v246 offset:20480
    ds_read_b64_tr_b16 v[86:87], v246 offset:22528
    s_waitcnt lgkmcnt(0)
    s_barrier
    ds_read_b64_tr_b16 v[88:89], v246 offset:24576
    ds_read_b64_tr_b16 v[90:91], v246 offset:26624
    ds_read_b64_tr_b16 v[92:93], v246 offset:28672
    ds_read_b64_tr_b16 v[94:95], v246 offset:30720
    s_waitcnt lgkmcnt(0)
    s_barrier
    ds_read_b64_tr_b16 v[96:97], v246 offset:0
    ds_read_b64_tr_b16 v[98:99], v246 offset:2048
    ds_read_b64_tr_b16 v[100:101], v246 offset:4096
    ds_read_b64_tr_b16 v[102:103], v246 offset:6144
    s_waitcnt lgkmcnt(0)
    s_barrier
    ds_read_b64_tr_b16 v[104:105], v246 offset:8192
    ds_read_b64_tr_b16 v[106:107], v246 offset:10240
    ds_read_b64_tr_b16 v[108:109], v246 offset:12288
    ds_read_b64_tr_b16 v[110:111], v246 offset:14336
    s_waitcnt lgkmcnt(0)
    s_barrier
    ds_read_b64_tr_b16 v[112:113], v246 offset:16384
    ds_read_b64_tr_b16 v[114:115], v246 offset:18432
    ds_read_b64_tr_b16 v[116:117], v246 offset:20480
    ds_read_b64_tr_b16 v[118:119], v246 offset:22528
    s_waitcnt lgkmcnt(0)
    s_barrier
    ds_read_b64_tr_b16 v[120:121], v246 offset:24576
    ds_read_b64_tr_b16 v[122:123], v246 offset:26624
    ds_read_b64_tr_b16 v[124:125], v246 offset:28672
    ds_read_b64_tr_b16 v[126:127], v246 offset:30720
    s_waitcnt lgkmcnt(0)
    s_barrier
    ds_read_b64_tr_b16 v[128:129], v246 offset:0
    ds_read_b64_tr_b16 v[130:131], v246 offset:2048
    ds_read_b64_tr_b16 v[132:133], v246 offset:4096
    ds_read_b64_tr_b16 v[134:135], v246 offset:6144
    s_waitcnt lgkmcnt(0)
    s_barrier
    ds_read_b64_tr_b16 v[136:137], v246 offset:8192
    ds_read_b64_tr_b16 v[138:139], v246 offset:10240
    ds_read_b64_tr_b16 v[140:141], v246 offset:12288
    ds_read_b64_tr_b16 v[142:143], v246 offset:14336
    s_waitcnt lgkmcnt(0)
    s_barrier
    ds_read_b64_tr_b16 v[144:145], v246 offset:16384
    ds_read_b64_tr_b16 v[146:147], v246 offset:18432
    ds_read_b64_tr_b16 v[148:149], v246 offset:20480
    ds_read_b64_tr_b16 v[150:151], v246 offset:22528
    s_waitcnt lgkmcnt(0)
    s_barrier
    ds_read_b64_tr_b16 v[152:153], v246 offset:24576
    ds_read_b64_tr_b16 v[154:155], v246 offset:26624
    ds_read_b64_tr_b16 v[156:157], v246 offset:28672
    ds_read_b64_tr_b16 v[158:159], v246 offset:30720
    s_waitcnt lgkmcnt(0)
    s_branch RECB_qkd
RECB_qk1:
    s_cmp_lg_u32 s23, 1
    s_cbranch_scc1 RECB_qk2
    s_barrier
    ds_read_b64_tr_b16 v[60:61], v246 offset:0
    ds_read_b64_tr_b16 v[62:63], v246 offset:2048
    ds_read_b64_tr_b16 v[64:65], v246 offset:4096
    ds_read_b64_tr_b16 v[66:67], v246 offset:6144
    s_waitcnt lgkmcnt(0)
    s_barrier
    ds_read_b64_tr_b16 v[68:69], v246 offset:8192
    ds_read_b64_tr_b16 v[70:71], v246 offset:10240
    ds_read_b64_tr_b16 v[72:73], v246 offset:12288
    ds_read_b64_tr_b16 v[74:75], v246 offset:14336
    s_waitcnt lgkmcnt(0)
    s_barrier
    ds_read_b64_tr_b16 v[76:77], v246 offset:16384
    ds_read_b64_tr_b16 v[78:79], v246 offset:18432
    ds_read_b64_tr_b16 v[0:1], v246 offset:20480
    ds_read_b64_tr_b16 v[2:3], v246 offset:22528
    s_waitcnt lgkmcnt(0)
    s_barrier
    ds_read_b64_tr_b16 v[4:5], v246 offset:24576
    ds_read_b64_tr_b16 v[6:7], v246 offset:26624
    ds_read_b64_tr_b16 v[8:9], v246 offset:28672
    ds_read_b64_tr_b16 v[10:11], v246 offset:30720
    s_waitcnt lgkmcnt(0)
    s_barrier
    ds_read_b64_tr_b16 v[12:13], v246 offset:0
    ds_read_b64_tr_b16 v[14:15], v246 offset:2048
    ds_read_b64_tr_b16 v[16:17], v246 offset:4096
    ds_read_b64_tr_b16 v[18:19], v246 offset:6144
    s_waitcnt lgkmcnt(0)
    s_barrier
    ds_read_b64_tr_b16 v[20:21], v246 offset:8192
    ds_read_b64_tr_b16 v[22:23], v246 offset:10240
    ds_read_b64_tr_b16 v[24:25], v246 offset:12288
    ds_read_b64_tr_b16 v[26:27], v246 offset:14336
    s_waitcnt lgkmcnt(0)
    s_barrier
    ds_read_b64_tr_b16 v[28:29], v246 offset:16384
    ds_read_b64_tr_b16 v[30:31], v246 offset:18432
    ds_read_b64_tr_b16 v[32:33], v246 offset:20480
    ds_read_b64_tr_b16 v[34:35], v246 offset:22528
    s_waitcnt lgkmcnt(0)
    s_barrier
    ds_read_b64_tr_b16 v[36:37], v246 offset:24576
    ds_read_b64_tr_b16 v[38:39], v246 offset:26624
    ds_read_b64_tr_b16 v[40:41], v246 offset:28672
    ds_read_b64_tr_b16 v[42:43], v246 offset:30720
    s_waitcnt lgkmcnt(0)
    s_barrier
    ds_read_b64_tr_b16 v[44:45], v246 offset:0
    ds_read_b64_tr_b16 v[46:47], v246 offset:2048
    ds_read_b64_tr_b16 v[48:49], v246 offset:4096
    ds_read_b64_tr_b16 v[50:51], v246 offset:6144
    s_waitcnt lgkmcnt(0)
    s_barrier
    ds_read_b64_tr_b16 v[52:53], v246 offset:8192
    ds_read_b64_tr_b16 v[54:55], v246 offset:10240
    ds_read_b64_tr_b16 v[56:57], v246 offset:12288
    ds_read_b64_tr_b16 v[58:59], v246 offset:14336
    s_waitcnt lgkmcnt(0)
    s_barrier
    ds_read_b64_tr_b16 v[140:141], v246 offset:16384
    ds_read_b64_tr_b16 v[142:143], v246 offset:18432
    ds_read_b64_tr_b16 v[144:145], v246 offset:20480
    ds_read_b64_tr_b16 v[146:147], v246 offset:22528
    s_waitcnt lgkmcnt(0)
    s_barrier
    ds_read_b64_tr_b16 v[148:149], v246 offset:24576
    ds_read_b64_tr_b16 v[150:151], v246 offset:26624
    ds_read_b64_tr_b16 v[152:153], v246 offset:28672
    ds_read_b64_tr_b16 v[154:155], v246 offset:30720
    s_waitcnt lgkmcnt(0)
    s_barrier
    ds_read_b64_tr_b16 v[156:157], v246 offset:0
    ds_read_b64_tr_b16 v[158:159], v246 offset:2048
    ds_read_b64_tr_b16 v[80:81], v246 offset:4096
    ds_read_b64_tr_b16 v[82:83], v246 offset:6144
    s_waitcnt lgkmcnt(0)
    s_barrier
    ds_read_b64_tr_b16 v[84:85], v246 offset:8192
    ds_read_b64_tr_b16 v[86:87], v246 offset:10240
    ds_read_b64_tr_b16 v[88:89], v246 offset:12288
    ds_read_b64_tr_b16 v[90:91], v246 offset:14336
    s_waitcnt lgkmcnt(0)
    s_barrier
    ds_read_b64_tr_b16 v[92:93], v246 offset:16384
    ds_read_b64_tr_b16 v[94:95], v246 offset:18432
    ds_read_b64_tr_b16 v[96:97], v246 offset:20480
    ds_read_b64_tr_b16 v[98:99], v246 offset:22528
    s_waitcnt lgkmcnt(0)
    s_barrier
    ds_read_b64_tr_b16 v[100:101], v246 offset:24576
    ds_read_b64_tr_b16 v[102:103], v246 offset:26624
    ds_read_b64_tr_b16 v[104:105], v246 offset:28672
    ds_read_b64_tr_b16 v[106:107], v246 offset:30720
    s_waitcnt lgkmcnt(0)
    s_barrier
    ds_read_b64_tr_b16 v[108:109], v246 offset:0
    ds_read_b64_tr_b16 v[110:111], v246 offset:2048
    ds_read_b64_tr_b16 v[112:113], v246 offset:4096
    ds_read_b64_tr_b16 v[114:115], v246 offset:6144
    s_waitcnt lgkmcnt(0)
    s_barrier
    ds_read_b64_tr_b16 v[116:117], v246 offset:8192
    ds_read_b64_tr_b16 v[118:119], v246 offset:10240
    ds_read_b64_tr_b16 v[120:121], v246 offset:12288
    ds_read_b64_tr_b16 v[122:123], v246 offset:14336
    s_waitcnt lgkmcnt(0)
    s_barrier
    ds_read_b64_tr_b16 v[124:125], v246 offset:16384
    ds_read_b64_tr_b16 v[126:127], v246 offset:18432
    ds_read_b64_tr_b16 v[128:129], v246 offset:20480
    ds_read_b64_tr_b16 v[130:131], v246 offset:22528
    s_waitcnt lgkmcnt(0)
    s_barrier
    ds_read_b64_tr_b16 v[132:133], v246 offset:24576
    ds_read_b64_tr_b16 v[134:135], v246 offset:26624
    ds_read_b64_tr_b16 v[136:137], v246 offset:28672
    ds_read_b64_tr_b16 v[138:139], v246 offset:30720
    s_waitcnt lgkmcnt(0)
    s_branch RECB_qkd
RECB_qk2:
    s_cmp_lg_u32 s23, 2
    s_cbranch_scc1 RECB_qk3
    s_barrier
    ds_read_b64_tr_b16 v[40:41], v246 offset:0
    ds_read_b64_tr_b16 v[42:43], v246 offset:2048
    ds_read_b64_tr_b16 v[44:45], v246 offset:4096
    ds_read_b64_tr_b16 v[46:47], v246 offset:6144
    s_waitcnt lgkmcnt(0)
    s_barrier
    ds_read_b64_tr_b16 v[48:49], v246 offset:8192
    ds_read_b64_tr_b16 v[50:51], v246 offset:10240
    ds_read_b64_tr_b16 v[52:53], v246 offset:12288
    ds_read_b64_tr_b16 v[54:55], v246 offset:14336
    s_waitcnt lgkmcnt(0)
    s_barrier
    ds_read_b64_tr_b16 v[56:57], v246 offset:16384
    ds_read_b64_tr_b16 v[58:59], v246 offset:18432
    ds_read_b64_tr_b16 v[60:61], v246 offset:20480
    ds_read_b64_tr_b16 v[62:63], v246 offset:22528
    s_waitcnt lgkmcnt(0)
    s_barrier
    ds_read_b64_tr_b16 v[64:65], v246 offset:24576
    ds_read_b64_tr_b16 v[66:67], v246 offset:26624
    ds_read_b64_tr_b16 v[68:69], v246 offset:28672
    ds_read_b64_tr_b16 v[70:71], v246 offset:30720
    s_waitcnt lgkmcnt(0)
    s_barrier
    ds_read_b64_tr_b16 v[72:73], v246 offset:0
    ds_read_b64_tr_b16 v[74:75], v246 offset:2048
    ds_read_b64_tr_b16 v[76:77], v246 offset:4096
    ds_read_b64_tr_b16 v[78:79], v246 offset:6144
    s_waitcnt lgkmcnt(0)
    s_barrier
    ds_read_b64_tr_b16 v[0:1], v246 offset:8192
    ds_read_b64_tr_b16 v[2:3], v246 offset:10240
    ds_read_b64_tr_b16 v[4:5], v246 offset:12288
    ds_read_b64_tr_b16 v[6:7], v246 offset:14336
    s_waitcnt lgkmcnt(0)
    s_barrier
    ds_read_b64_tr_b16 v[8:9], v246 offset:16384
    ds_read_b64_tr_b16 v[10:11], v246 offset:18432
    ds_read_b64_tr_b16 v[12:13], v246 offset:20480
    ds_read_b64_tr_b16 v[14:15], v246 offset:22528
    s_waitcnt lgkmcnt(0)
    s_barrier
    ds_read_b64_tr_b16 v[16:17], v246 offset:24576
    ds_read_b64_tr_b16 v[18:19], v246 offset:26624
    ds_read_b64_tr_b16 v[20:21], v246 offset:28672
    ds_read_b64_tr_b16 v[22:23], v246 offset:30720
    s_waitcnt lgkmcnt(0)
    s_barrier
    ds_read_b64_tr_b16 v[24:25], v246 offset:0
    ds_read_b64_tr_b16 v[26:27], v246 offset:2048
    ds_read_b64_tr_b16 v[28:29], v246 offset:4096
    ds_read_b64_tr_b16 v[30:31], v246 offset:6144
    s_waitcnt lgkmcnt(0)
    s_barrier
    ds_read_b64_tr_b16 v[32:33], v246 offset:8192
    ds_read_b64_tr_b16 v[34:35], v246 offset:10240
    ds_read_b64_tr_b16 v[36:37], v246 offset:12288
    ds_read_b64_tr_b16 v[38:39], v246 offset:14336
    s_waitcnt lgkmcnt(0)
    s_barrier
    ds_read_b64_tr_b16 v[120:121], v246 offset:16384
    ds_read_b64_tr_b16 v[122:123], v246 offset:18432
    ds_read_b64_tr_b16 v[124:125], v246 offset:20480
    ds_read_b64_tr_b16 v[126:127], v246 offset:22528
    s_waitcnt lgkmcnt(0)
    s_barrier
    ds_read_b64_tr_b16 v[128:129], v246 offset:24576
    ds_read_b64_tr_b16 v[130:131], v246 offset:26624
    ds_read_b64_tr_b16 v[132:133], v246 offset:28672
    ds_read_b64_tr_b16 v[134:135], v246 offset:30720
    s_waitcnt lgkmcnt(0)
    s_barrier
    ds_read_b64_tr_b16 v[136:137], v246 offset:0
    ds_read_b64_tr_b16 v[138:139], v246 offset:2048
    ds_read_b64_tr_b16 v[140:141], v246 offset:4096
    ds_read_b64_tr_b16 v[142:143], v246 offset:6144
    s_waitcnt lgkmcnt(0)
    s_barrier
    ds_read_b64_tr_b16 v[144:145], v246 offset:8192
    ds_read_b64_tr_b16 v[146:147], v246 offset:10240
    ds_read_b64_tr_b16 v[148:149], v246 offset:12288
    ds_read_b64_tr_b16 v[150:151], v246 offset:14336
    s_waitcnt lgkmcnt(0)
    s_barrier
    ds_read_b64_tr_b16 v[152:153], v246 offset:16384
    ds_read_b64_tr_b16 v[154:155], v246 offset:18432
    ds_read_b64_tr_b16 v[156:157], v246 offset:20480
    ds_read_b64_tr_b16 v[158:159], v246 offset:22528
    s_waitcnt lgkmcnt(0)
    s_barrier
    ds_read_b64_tr_b16 v[80:81], v246 offset:24576
    ds_read_b64_tr_b16 v[82:83], v246 offset:26624
    ds_read_b64_tr_b16 v[84:85], v246 offset:28672
    ds_read_b64_tr_b16 v[86:87], v246 offset:30720
    s_waitcnt lgkmcnt(0)
    s_barrier
    ds_read_b64_tr_b16 v[88:89], v246 offset:0
    ds_read_b64_tr_b16 v[90:91], v246 offset:2048
    ds_read_b64_tr_b16 v[92:93], v246 offset:4096
    ds_read_b64_tr_b16 v[94:95], v246 offset:6144
    s_waitcnt lgkmcnt(0)
    s_barrier
    ds_read_b64_tr_b16 v[96:97], v246 offset:8192
    ds_read_b64_tr_b16 v[98:99], v246 offset:10240
    ds_read_b64_tr_b16 v[100:101], v246 offset:12288
    ds_read_b64_tr_b16 v[102:103], v246 offset:14336
    s_waitcnt lgkmcnt(0)
    s_barrier
    ds_read_b64_tr_b16 v[104:105], v246 offset:16384
    ds_read_b64_tr_b16 v[106:107], v246 offset:18432
    ds_read_b64_tr_b16 v[108:109], v246 offset:20480
    ds_read_b64_tr_b16 v[110:111], v246 offset:22528
    s_waitcnt lgkmcnt(0)
    s_barrier
    ds_read_b64_tr_b16 v[112:113], v246 offset:24576
    ds_read_b64_tr_b16 v[114:115], v246 offset:26624
    ds_read_b64_tr_b16 v[116:117], v246 offset:28672
    ds_read_b64_tr_b16 v[118:119], v246 offset:30720
    s_waitcnt lgkmcnt(0)
    s_branch RECB_qkd
RECB_qk3:
    s_barrier
    ds_read_b64_tr_b16 v[20:21], v246 offset:0
    ds_read_b64_tr_b16 v[22:23], v246 offset:2048
    ds_read_b64_tr_b16 v[24:25], v246 offset:4096
    ds_read_b64_tr_b16 v[26:27], v246 offset:6144
    s_waitcnt lgkmcnt(0)
    s_barrier
    ds_read_b64_tr_b16 v[28:29], v246 offset:8192
    ds_read_b64_tr_b16 v[30:31], v246 offset:10240
    ds_read_b64_tr_b16 v[32:33], v246 offset:12288
    ds_read_b64_tr_b16 v[34:35], v246 offset:14336
    s_waitcnt lgkmcnt(0)
    s_barrier
    ds_read_b64_tr_b16 v[36:37], v246 offset:16384
    ds_read_b64_tr_b16 v[38:39], v246 offset:18432
    ds_read_b64_tr_b16 v[40:41], v246 offset:20480
    ds_read_b64_tr_b16 v[42:43], v246 offset:22528
    s_waitcnt lgkmcnt(0)
    s_barrier
    ds_read_b64_tr_b16 v[44:45], v246 offset:24576
    ds_read_b64_tr_b16 v[46:47], v246 offset:26624
    ds_read_b64_tr_b16 v[48:49], v246 offset:28672
    ds_read_b64_tr_b16 v[50:51], v246 offset:30720
    s_waitcnt lgkmcnt(0)
    s_barrier
    ds_read_b64_tr_b16 v[52:53], v246 offset:0
    ds_read_b64_tr_b16 v[54:55], v246 offset:2048
    ds_read_b64_tr_b16 v[56:57], v246 offset:4096
    ds_read_b64_tr_b16 v[58:59], v246 offset:6144
    s_waitcnt lgkmcnt(0)
    s_barrier
    ds_read_b64_tr_b16 v[60:61], v246 offset:8192
    ds_read_b64_tr_b16 v[62:63], v246 offset:10240
    ds_read_b64_tr_b16 v[64:65], v246 offset:12288
    ds_read_b64_tr_b16 v[66:67], v246 offset:14336
    s_waitcnt lgkmcnt(0)
    s_barrier
    ds_read_b64_tr_b16 v[68:69], v246 offset:16384
    ds_read_b64_tr_b16 v[70:71], v246 offset:18432
    ds_read_b64_tr_b16 v[72:73], v246 offset:20480
    ds_read_b64_tr_b16 v[74:75], v246 offset:22528
    s_waitcnt lgkmcnt(0)
    s_barrier
    ds_read_b64_tr_b16 v[76:77], v246 offset:24576
    ds_read_b64_tr_b16 v[78:79], v246 offset:26624
    ds_read_b64_tr_b16 v[0:1], v246 offset:28672
    ds_read_b64_tr_b16 v[2:3], v246 offset:30720
    s_waitcnt lgkmcnt(0)
    s_barrier
    ds_read_b64_tr_b16 v[4:5], v246 offset:0
    ds_read_b64_tr_b16 v[6:7], v246 offset:2048
    ds_read_b64_tr_b16 v[8:9], v246 offset:4096
    ds_read_b64_tr_b16 v[10:11], v246 offset:6144
    s_waitcnt lgkmcnt(0)
    s_barrier
    ds_read_b64_tr_b16 v[12:13], v246 offset:8192
    ds_read_b64_tr_b16 v[14:15], v246 offset:10240
    ds_read_b64_tr_b16 v[16:17], v246 offset:12288
    ds_read_b64_tr_b16 v[18:19], v246 offset:14336
    s_waitcnt lgkmcnt(0)
    s_barrier
    ds_read_b64_tr_b16 v[100:101], v246 offset:16384
    ds_read_b64_tr_b16 v[102:103], v246 offset:18432
    ds_read_b64_tr_b16 v[104:105], v246 offset:20480
    ds_read_b64_tr_b16 v[106:107], v246 offset:22528
    s_waitcnt lgkmcnt(0)
    s_barrier
    ds_read_b64_tr_b16 v[108:109], v246 offset:24576
    ds_read_b64_tr_b16 v[110:111], v246 offset:26624
    ds_read_b64_tr_b16 v[112:113], v246 offset:28672
    ds_read_b64_tr_b16 v[114:115], v246 offset:30720
    s_waitcnt lgkmcnt(0)
    s_barrier
    ds_read_b64_tr_b16 v[116:117], v246 offset:0
    ds_read_b64_tr_b16 v[118:119], v246 offset:2048
    ds_read_b64_tr_b16 v[120:121], v246 offset:4096
    ds_read_b64_tr_b16 v[122:123], v246 offset:6144
    s_waitcnt lgkmcnt(0)
    s_barrier
    ds_read_b64_tr_b16 v[124:125], v246 offset:8192
    ds_read_b64_tr_b16 v[126:127], v246 offset:10240
    ds_read_b64_tr_b16 v[128:129], v246 offset:12288
    ds_read_b64_tr_b16 v[130:131], v246 offset:14336
    s_waitcnt lgkmcnt(0)
    s_barrier
    ds_read_b64_tr_b16 v[132:133], v246 offset:16384
    ds_read_b64_tr_b16 v[134:135], v246 offset:18432
    ds_read_b64_tr_b16 v[136:137], v246 offset:20480
    ds_read_b64_tr_b16 v[138:139], v246 offset:22528
    s_waitcnt lgkmcnt(0)
    s_barrier
    ds_read_b64_tr_b16 v[140:141], v246 offset:24576
    ds_read_b64_tr_b16 v[142:143], v246 offset:26624
    ds_read_b64_tr_b16 v[144:145], v246 offset:28672
    ds_read_b64_tr_b16 v[146:147], v246 offset:30720
    s_waitcnt lgkmcnt(0)
    s_barrier
    ds_read_b64_tr_b16 v[148:149], v246 offset:0
    ds_read_b64_tr_b16 v[150:151], v246 offset:2048
    ds_read_b64_tr_b16 v[152:153], v246 offset:4096
    ds_read_b64_tr_b16 v[154:155], v246 offset:6144
    s_waitcnt lgkmcnt(0)
    s_barrier
    ds_read_b64_tr_b16 v[156:157], v246 offset:8192
    ds_read_b64_tr_b16 v[158:159], v246 offset:10240
    ds_read_b64_tr_b16 v[80:81], v246 offset:12288
    ds_read_b64_tr_b16 v[82:83], v246 offset:14336
    s_waitcnt lgkmcnt(0)
    s_barrier
    ds_read_b64_tr_b16 v[84:85], v246 offset:16384
    ds_read_b64_tr_b16 v[86:87], v246 offset:18432
    ds_read_b64_tr_b16 v[88:89], v246 offset:20480
    ds_read_b64_tr_b16 v[90:91], v246 offset:22528
    s_waitcnt lgkmcnt(0)
    s_barrier
    ds_read_b64_tr_b16 v[92:93], v246 offset:24576
    ds_read_b64_tr_b16 v[94:95], v246 offset:26624
    ds_read_b64_tr_b16 v[96:97], v246 offset:28672
    ds_read_b64_tr_b16 v[98:99], v246 offset:30720
    s_waitcnt lgkmcnt(0)
RECB_qkd:
    s_mul_i32 s40, s23, 2560
    v_add_u32 v225, s40, v243
    v_lshl_add_u32 v224, v253, 9, v225
    s_lshl_b32 s41, s56, 10
    v_lshl_add_u32 v160, v253, 4, v252
    v_lshlrev_b32 v228, 4, v160
    v_and_b32 v161, 1, v251
    v_lshrrev_b32 v162, 1, v251
    v_lshl_add_u32 v228, v161, 9, v228
    v_lshl_add_u32 v228, v162, 3, v228
    v_add_u32 v228, s41, v228
    s_lshl_b32 s41, s23, 8
    s_add_u32 s41, s41, 30720
    v_lshlrev_b32 v231, 7, v161
    v_lshl_add_u32 v231, v252, 4, v231
    v_lshl_add_u32 v231, v162, 3, v231
    v_add_u32 v231, s41, v231
    v_cmp_eq_u32 vcc, 0, v253
    s_lshl_b32 s40, s17, 10
    v_add_u32 v229, s40, v249
    s_mul_i32 s40, s17, 3072
    v_add_u32 v248, s40, v249
    s_lshl_b32 s40, s17, 2
    v_add_u32 v240, s40, v249
    s_mul_i32 s40, s21, 2048
    s_cmp_ge_u32 s17, 2
    s_cbranch_scc1 RECB_sst2
    v_lshl_add_u32 v230, v251, 4, v252
    s_lshl_b32 s41, s17, 3
    v_add_u32 v230, s41, v230
    s_cmp_eq_u32 s22, 2
    s_cbranch_scc1 RECB_sstc2
    s_lshl_b32 s41, s22, 3
    s_add_u32 s40, s40, s41
    v_lshlrev_b32 v230, 4, v230
    s_branch RECB_sstc
RECB_sstc2:
    s_add_u32 s40, s40, 1024
    v_lshlrev_b32 v230, 3, v230
RECB_sstc:
    v_add_u32 v230, s40, v230
    v_cndmask_b32 v230, v242, v230, vcc
    s_branch RECB_sstd
RECB_sst2:
    s_lshl_b32 s41, s22, 2
    s_add_u32 s40, s40, s41
    s_add_u32 s40, s40, 1536
    v_lshlrev_b32 v230, 4, v252
    v_lshl_add_u32 v230, v251, 8, v230
    v_add_u32 v230, s40, v230
    v_cndmask_b32 v230, v242, v230, vcc
    v_cmp_gt_u32 vcc, 2, v251
    s_nop 1
    v_cndmask_b32 v230, v242, v230, vcc
RECB_sstd:
    s_add_u32 s40, s23, 1
    s_and_b32 s40, s40, 3
    s_mul_i32 s40, s40, 2560
    s_add_u32 s40, s40, 0
    v_add_u32 v232, s40, v243
    s_add_u32 s40, s23, 2
    s_and_b32 s40, s40, 3
    s_mul_i32 s40, s40, 2560
    s_add_u32 s40, s40, 0
    v_add_u32 v233, s40, v243
    s_add_u32 s40, s23, 3
    s_and_b32 s40, s40, 3
    s_mul_i32 s40, s40, 2560
    s_add_u32 s40, s40, 0
    v_add_u32 v234, s40, v243
    s_mul_i32 s40, s23, 2048
    v_add_u32 v235, s40, v249
    v_lshlrev_b32 v236, 3, v255
    v_add_u32 v236, s40, v236
    v_add_u32 v237, s40, v243
    v_lshlrev_b32 v238, 9, v251
    v_lshl_add_u32 v238, v250, 4, v238
    s_lshl_b32 s36, s19, 2
    s_mul_i32 s36, s36, 40960
    s_add_u32 s36, s36, 91226112
    s_min_u32 s40, s20, 9
    s_lshl_b32 s40, s40, 12
    s_add_u32 s36, s36, s40
    s_lshr_b32 s40, s23, 1
    s_lshl_b32 s40, s40, 11
    s_add_u32 s36, s36, s40
    s_and_b32 s40, s23, 1
    s_lshl_b32 s40, s40, 8
    s_add_u32 s36, s36, s40
    s_mul_i32 s40, s19, 10240
    s_lshl_b32 s41, s20, 10
    s_add_u32 s40, s40, s41
    s_lshl_b32 s41, s23, 8
    s_add_u32 s40, s40, s41
    v_lshlrev_b32 v239, 6, v251
    v_lshl_add_u32 v239, v252, 3, v239
    v_add_u32 v239, s40, v239
    v_lshrrev_b32 v160, 13, v239
    v_lshlrev_b32 v160, 13, v160
    v_add_u32 v239, v239, v160
    v_cmp_eq_u32 vcc, 0, v253
    s_nop 1
    v_cndmask_b32 v239, v242, v239, vcc
    s_mov_b32 s53, 0x3dd53b95
    v_lshrrev_b32 v160, 3, v255
    v_mul_u32_u24 v226, 10240, v160
    s_lshl_b32 s40, s55, 9
    s_lshl_b32 s41, s23, 7
    s_add_u32 s41, s41, s40
    v_add_u32 v226, s41, v226
    v_lshl_add_u32 v226, v252, 4, v226
    v_lshrrev_b32 v161, 13, v226
    v_lshlrev_b32 v161, 13, v161
    v_add_u32 v226, v226, v161
    v_lshrrev_b32 v160, 2, v252
    s_lshl_b32 s41, s23, 1
    v_add_u32 v160, s41, v160
    v_and_b32 v161, 3, v160
    v_lshlrev_b32 v227, 7, v161
    v_lshrrev_b32 v161, 2, v160
    v_lshl_add_u32 v227, v161, 3, v227
    v_and_b32 v161, 3, v255
    v_lshl_add_u32 v227, v161, 5, v227
    v_lshrrev_b32 v161, 5, v255
    v_lshl_add_u32 v227, v161, 4, v227
    v_bfe_u32 v161, v255, 4, 1
    v_lshl_add_u32 v227, v161, 2, v227
    v_add_u32 v227, s40, v227
    v_cmp_eq_u32 vcc, 0, v253
    s_nop 1
    v_cndmask_b32 v227, v242, v227, vcc
    v_and_b32 v161, 7, v255
    v_lshlrev_b32 v161, 5, v161
    s_mov_b32 s73, 3000000
CEN_37:
    buffer_load_dword v160, v161, s[68:71], 0 offen sc1
    s_mov_b32 s39, 1
    s_sub_u32 s73, s73, 1
    s_cbranch_scc1 CEN_37_ok
    s_waitcnt vmcnt(0)
    v_cmp_ne_u32 vcc, 32, v160
    s_cbranch_vccz CEN_37_ok
    s_mov_b32 s72, 0
    v_readlane_b32 s75, v160, 0
    s_add_u32 s72, s72, s75
    s_cmp_lt_u32 s75, 32
    s_cselect_b32 s39, 0, s39
    v_readlane_b32 s75, v160, 1
    s_add_u32 s72, s72, s75
    s_cmp_lt_u32 s75, 32
    s_cselect_b32 s39, 0, s39
    v_readlane_b32 s75, v160, 2
    s_add_u32 s72, s72, s75
    s_cmp_lt_u32 s75, 32
    s_cselect_b32 s39, 0, s39
    v_readlane_b32 s75, v160, 3
    s_add_u32 s72, s72, s75
    s_cmp_lt_u32 s75, 32
    s_cselect_b32 s39, 0, s39
    v_readlane_b32 s75, v160, 4
    s_add_u32 s72, s72, s75
    v_readlane_b32 s75, v160, 5
    s_add_u32 s72, s72, s75
    v_readlane_b32 s75, v160, 6
    s_add_u32 s72, s72, s75
    v_readlane_b32 s75, v160, 7
    s_add_u32 s72, s72, s75
    s_cmp_ge_u32 s72, 256
    s_cbranch_scc1 CEN_37_ok
    s_sleep 4
    s_branch CEN_37
CEN_37_ok:
    s_waitcnt vmcnt(0)
    v_mov_b32 v164, 0
    s_mov_b32 s73, 3000000
    s_mov_b32 s93, 0
WINI_38:
    buffer_load_dwordx4 v[160:163], v164, s[68:71], 0 offen sc1
    s_sub_u32 s73, s73, 1
    s_cbranch_scc1 WINI_38_ok
    s_waitcnt vmcnt(0)
    v_readfirstlane_b32 s72, v161
    s_cmp_lt_u32 s72, 64
    s_cbranch_scc1 WINI_38_sl
    v_readfirstlane_b32 s93, v163
    s_cmp_lg_u32 s93, 0
    s_cbranch_scc1 WINI_38_ok
WINI_38_sl:
    s_sleep 24
    s_branch WINI_38
WINI_38_ok:
    s_waitcnt vmcnt(0)
    s_and_b32 s93, s93, 8192
    s_mov_b32 s41, s93
    s_and_b32 s41, s41, 8192
    s_add_u32 s24, s24, s41
    s_mul_i32 s35, s25, 12288
    s_add_u32 s35, s35, 34603008
    s_barrier
    s_waitcnt lgkmcnt(0)
    s_cmp_eq_u32 s17, 1
    s_waitcnt lgkmcnt(0)
    s_setprio 3
RECB_loopA:
    s_and_b32 s40, s27, 3
    s_add_u32 s41, s27, 2
    s_and_b32 s41, s41, 3
    s_mul_i32 s28, s40, 65536
    s_add_u32 s28, s28, s47
    s_mul_i32 s29, s41, 65536
    s_add_u32 s29, s29, s47
    s_mul_i32 s30, s40, 163840
    s_add_u32 s30, s30, s24
    s_mul_i32 s31, s41, 163840
    s_add_u32 s31, s31, s24
    s_mul_i32 s32, s40, 40960
    s_add_u32 s32, s32, s48
    s_add_u32 s41, s27, 1
    s_and_b32 s41, s41, 3
    s_mul_i32 s33, s41, 40960
    s_add_u32 s33, s33, s48
    s_add_u32 s41, s27, 3
    s_and_b32 s41, s41, 3
    s_mul_i32 s34, s41, 40960
    s_add_u32 s34, s34, s48
RECB_poll_39:
    buffer_load_dwordx4 v[160:163], v224, s[12:15], s32 offen sc1
    buffer_load_dwordx4 v[164:167], v224, s[12:15], s32 offen offset:1024 sc1
    buffer_load_dwordx4 v[168:171], v225, s[12:15], s32 offen offset:2048 sc1
    s_sub_u32 s46, s46, 1
    s_cbranch_scc1 RECB_pdone_40_x
    s_waitcnt vmcnt(0)
    v_max3_u32 v198, v160, v161, v162
    v_max3_u32 v198, v198, v163, v164
    v_max3_u32 v198, v198, v165, v166
    v_max3_u32 v198, v198, v167, v168
    v_max3_u32 v198, v198, v169, v170
    v_max_u32 v198, v198, v171
    v_cmp_eq_u32 vcc, -1, v198
    s_cbranch_vccnz RECB_poll_39
    s_branch RECB_pdone_40
RECB_pdone_40_x:
    s_mov_b32 s46, 0
    s_waitcnt vmcnt(0)
RECB_pdone_40:
    ds_write_b128 v224, v[160:163] offset:0
    ds_write_b128 v224, v[164:167] offset:1024
    ds_write_b128 v225, v[168:171] offset:2048
    v_mfma_f32_16x16x32_bf16 v[200:203], v[0:3], v[160:163], 0
    v_mfma_f32_16x16x32_bf16 v[204:207], v[80:83], v[160:163], 0
    v_mov_b32_dpp v172, v160 row_ror:8 row_mask:0xf bank_mask:0xf
    v_mov_b32_dpp v173, v161 row_ror:8 row_mask:0xf bank_mask:0xf
    v_mov_b32_dpp v174, v162 row_ror:8 row_mask:0xf bank_mask:0xf
    v_mov_b32_dpp v175, v163 row_ror:8 row_mask:0xf bank_mask:0xf
    v_mfma_f32_16x16x32_bf16 v[200:203], v[8:11], v[164:167], v[200:203]
    v_mfma_f32_16x16x32_bf16 v[204:207], v[88:91], v[164:167], v[204:207]
    v_mov_b32_dpp v176, v164 row_ror:8 row_mask:0xf bank_mask:0xf
    v_mov_b32_dpp v177, v165 row_ror:8 row_mask:0xf bank_mask:0xf
    v_mov_b32_dpp v178, v166 row_ror:8 row_mask:0xf bank_mask:0xf
    v_mov_b32_dpp v179, v167 row_ror:8 row_mask:0xf bank_mask:0xf
    s_waitcnt lgkmcnt(0)
    s_barrier
    ds_read_b128 v[180:183], v232 offset:0
    ds_read_b128 v[184:187], v232 offset:512
    ds_read_b128 v[188:191], v232 offset:1024
    ds_read_b128 v[192:195], v232 offset:1536
    v_mfma_f32_16x16x32_bf16 v[200:203], v[16:19], v[168:171], v[200:203]
    v_mfma_f32_16x16x32_bf16 v[204:207], v[96:99], v[168:171], v[204:207]
    v_mfma_f32_16x16x32_bf16 v[200:203], v[4:7], v[172:175], v[200:203]
    v_mfma_f32_16x16x32_bf16 v[204:207], v[84:87], v[172:175], v[204:207]
    v_mfma_f32_16x16x32_bf16 v[200:203], v[12:15], v[176:179], v[200:203]
    v_mfma_f32_16x16x32_bf16 v[204:207], v[92:95], v[176:179], v[204:207]
    s_waitcnt lgkmcnt(3)
    v_mfma_f32_16x16x32_bf16 v[200:203], v[20:23], v[180:183], v[200:203]
    v_mfma_f32_16x16x32_bf16 v[204:207], v[100:103], v[180:183], v[204:207]
    ds_read_b128 v[196:199], v232 offset:2048
    buffer_load_dwordx2 v[244:245], v228, s[12:15], s35 offen
    s_waitcnt lgkmcnt(3)
    v_mfma_f32_16x16x32_bf16 v[200:203], v[24:27], v[184:187], v[200:203]
    v_mfma_f32_16x16x32_bf16 v[204:207], v[104:107], v[184:187], v[204:207]
    ds_read_b128 v[180:183], v233 offset:0
    buffer_load_dwordx2 v[246:247], v228, s[12:15], s35 offen offset:128
    s_waitcnt lgkmcnt(3)
    v_mfma_f32_16x16x32_bf16 v[200:203], v[28:31], v[188:191], v[200:203]
    v_mfma_f32_16x16x32_bf16 v[204:207], v[108:111], v[188:191], v[204:207]
    ds_read_b128 v[184:187], v233 offset:512
    s_add_u32 s35, s35, 393216
    s_waitcnt lgkmcnt(3)
    v_mfma_f32_16x16x32_bf16 v[200:203], v[32:35], v[192:195], v[200:203]
    v_mfma_f32_16x16x32_bf16 v[204:207], v[112:115], v[192:195], v[204:207]
    ds_read_b128 v[188:191], v233 offset:1024
    s_add_u32 s40, s36, 0
    buffer_load_dwordx4 v[208:211], v238, s[12:15], s40 offen
    s_waitcnt lgkmcnt(3)
    v_mfma_f32_16x16x32_bf16 v[200:203], v[36:39], v[196:199], v[200:203]
    v_mfma_f32_16x16x32_bf16 v[204:207], v[116:119], v[196:199], v[204:207]
    ds_read_b128 v[192:195], v233 offset:1536
    s_add_u32 s40, s36, 40960
    buffer_load_dwordx4 v[212:215], v238, s[12:15], s40 offen
    s_waitcnt lgkmcnt(3)
    v_mfma_f32_16x16x32_bf16 v[200:203], v[40:43], v[180:183], v[200:203]
    v_mfma_f32_16x16x32_bf16 v[204:207], v[120:123], v[180:183], v[204:207]
    ds_read_b128 v[196:199], v233 offset:2048
    s_add_u32 s40, s36, 81920
    buffer_load_dwordx4 v[216:219], v238, s[12:15], s40 offen
    s_waitcnt lgkmcnt(3)
    v_mfma_f32_16x16x32_bf16 v[200:203], v[44:47], v[184:187], v[200:203]
    v_mfma_f32_16x16x32_bf16 v[204:207], v[124:127], v[184:187], v[204:207]
    ds_read_b128 v[180:183], v234 offset:0
    s_add_u32 s40, s36, 122880
    buffer_load_dwordx4 v[220:223], v238, s[12:15], s40 offen
    s_waitcnt lgkmcnt(3)
    v_mfma_f32_16x16x32_bf16 v[200:203], v[48:51], v[188:191], v[200:203]
    v_mfma_f32_16x16x32_bf16 v[204:207], v[128:131], v[188:191], v[204:207]
    ds_read_b128 v[184:187], v234 offset:512
    s_add_u32 s36, s36, 1310720
    s_waitcnt lgkmcnt(3)
    v_mfma_f32_16x16x32_bf16 v[200:203], v[52:55], v[192:195], v[200:203]
    v_mfma_f32_16x16x32_bf16 v[204:207], v[132:135], v[192:195], v[204:207]
    ds_read_b128 v[188:191], v234 offset:1024
    s_waitcnt lgkmcnt(3)
    v_mfma_f32_16x16x32_bf16 v[200:203], v[56:59], v[196:199], v[200:203]
    v_mfma_f32_16x16x32_bf16 v[204:207], v[136:139], v[196:199], v[204:207]
    ds_read_b128 v[192:195], v234 offset:1536
    s_waitcnt lgkmcnt(3)
    v_mfma_f32_16x16x32_bf16 v[200:203], v[60:63], v[180:183], v[200:203]
    v_mfma_f32_16x16x32_bf16 v[204:207], v[140:143], v[180:183], v[204:207]
    ds_read_b128 v[196:199], v234 offset:2048
    s_waitcnt lgkmcnt(3)
    v_mfma_f32_16x16x32_bf16 v[200:203], v[64:67], v[184:187], v[200:203]
    v_mfma_f32_16x16x32_bf16 v[204:207], v[144:147], v[184:187], v[204:207]
    s_waitcnt lgkmcnt(2)
    v_mfma_f32_16x16x32_bf16 v[200:203], v[68:71], v[188:191], v[200:203]
    v_mfma_f32_16x16x32_bf16 v[204:207], v[148:151], v[188:191], v[204:207]
    s_waitcnt lgkmcnt(1)
    v_mfma_f32_16x16x32_bf16 v[200:203], v[72:75], v[192:195], v[200:203]
    v_mfma_f32_16x16x32_bf16 v[204:207], v[152:155], v[192:195], v[204:207]
    s_waitcnt lgkmcnt(0)
    v_mfma_f32_16x16x32_bf16 v[200:203], v[76:79], v[196:199], v[200:203]
    v_mfma_f32_16x16x32_bf16 v[204:207], v[156:159], v[196:199], v[204:207]
    s_nop 6
    v_cvt_pk_bf16_f32 v192, v200, v201
    v_cvt_pk_bf16_f32 v193, v202, v203
    v_cvt_pk_bf16_f32 v194, v204, v205
    v_cvt_pk_bf16_f32 v195, v206, v207
    s_waitcnt vmcnt(4)
    v_mfma_f32_16x16x16_bf16 v[160:163], v[244:245], v[192:193], 0
    v_mfma_f32_16x16x16_bf16 v[164:167], v[246:247], v[192:193], 0
    v_mfma_f32_16x16x16_bf16 v[168:171], v[194:195], v[192:193], 0
    s_nop 5
    ds_write_b128 v248, v[160:163] offset:10240
    ds_write_b128 v248, v[164:167] offset:11264
    ds_write_b128 v248, v[168:171] offset:12288
    s_waitcnt lgkmcnt(0)
    s_barrier
    s_cmp_eq_u32 s17, 3
    s_cbranch_scc1 RECB_std
    ds_read_b128 v[160:163], v229 offset:10240
    ds_read_b128 v[164:167], v229 offset:13312
    ds_read_b128 v[172:175], v229 offset:16384
    ds_read_b128 v[176:179], v229 offset:19456
    s_waitcnt lgkmcnt(2)
    v_add_f32 v160, v160, v164
    v_add_f32 v161, v161, v165
    v_add_f32 v162, v162, v166
    v_add_f32 v163, v163, v167
    s_waitcnt lgkmcnt(0)
    v_add_f32 v172, v172, v176
    v_add_f32 v173, v173, v177
    v_add_f32 v174, v174, v178
    v_add_f32 v175, v175, v179
    v_add_f32 v160, v160, v172
    v_add_f32 v161, v161, v173
    v_add_f32 v162, v162, v174
    v_add_f32 v163, v163, v175
    v_cvt_pk_bf16_f32 v172, v160, v161
    v_cvt_pk_bf16_f32 v173, v162, v163
    v_min_u32 v172, s49, v172
    v_min_u32 v173, s49, v173
    s_cmp_eq_u32 s17, 2
    s_cbranch_scc1 RECB_st2
    buffer_store_dwordx2 v[172:173], v230, s[12:15], s28 offen sc1
    s_branch RECB_std
RECB_st2:
    buffer_store_dword v172, v230, s[12:15], s28 offen sc1
    buffer_store_dword v173, v230, s[12:15], s28 offen offset:128 sc1
RECB_std:
    s_mov_b64 exec, s[44:45]
    ds_write_b64 v231, v[194:195]
    s_mov_b64 exec, -1
    s_cmp_ge_u32 s20, 10
    s_cbranch_scc1 RECB_endA
    s_sleep 3
RECB_poll_41:
    buffer_load_dwordx4 v[160:163], v235, s[12:15], s28 offen sc1
    buffer_load_dwordx2 v[164:165], v236, s[12:15], s28 offen offset:1024 sc1
    buffer_load_dwordx3 v[166:168], v237, s[12:15], s28 offen offset:1536 sc1
    s_sub_u32 s46, s46, 1
    s_cbranch_scc1 RECB_pdone_42_x
    s_waitcnt vmcnt(0)
    v_max3_u32 v198, v160, v161, v162
    v_max3_u32 v198, v198, v163, v164
    v_max3_u32 v198, v198, v165, v166
    v_max3_u32 v198, v198, v167, v168
    v_cmp_eq_u32 vcc, -1, v198
    s_cbranch_vccnz RECB_poll_41
    s_branch RECB_pdone_42
RECB_pdone_42_x:
    s_mov_b32 s46, 0
    s_waitcnt vmcnt(0)
RECB_pdone_42:
    v_lshlrev_b32 v172, 16, v160
    v_and_b32 v173, 0xffff0000, v160
    v_lshlrev_b32 v174, 16, v161
    v_and_b32 v175, 0xffff0000, v161
    v_lshlrev_b32 v176, 16, v162
    v_and_b32 v177, 0xffff0000, v162
    v_lshlrev_b32 v178, 16, v163
    v_and_b32 v179, 0xffff0000, v163
    v_lshlrev_b32 v180, 16, v164
    v_and_b32 v181, 0xffff0000, v164
    v_lshlrev_b32 v182, 16, v165
    v_and_b32 v183, 0xffff0000, v165
    v_lshlrev_b32 v184, 16, v166
    v_and_b32 v185, 0xffff0000, v166
    v_lshlrev_b32 v186, 16, v167
    v_and_b32 v187, 0xffff0000, v167
    v_lshlrev_b32 v188, 16, v168
    v_and_b32 v189, 0xffff0000, v168
    v_add_f32 v172, v172, v176
    v_add_f32 v173, v173, v177
    v_add_f32 v174, v174, v178
    v_add_f32 v175, v175, v179
    v_add_f32 v176, v184, v186
    v_add_f32 v177, v185, v187
    v_add_f32 v172, v172, v180
    v_add_f32 v173, v173, v181
    v_add_f32 v174, v174, v182
    v_add_f32 v175, v175, v183
    v_add_f32 v176, v176, v188
    v_add_f32 v177, v177, v189
    v_max3_f32 v198, v172, v173, v174
    v_max3_f32 v199, v175, v176, v177
    v_max_f32 v198, v198, v199
    s_nop 1
    v_max_f32_dpp v198, v198, v198 row_ror:8 row_mask:0xf bank_mask:0xf
    v_mov_b32 v199, v198
    s_nop 1
    v_permlane32_swap_b32 v198, v199
    v_max_f32 v198, v198, v199
    v_mov_b32 v199, v198
    s_nop 1
    v_permlane16_swap_b32 v198, v199
    v_max_f32 v198, v198, v199
    v_mul_f32 v198, s53, v198
    v_fma_f32 v172, v172, s53, -v198
    v_fma_f32 v173, v173, s53, -v198
    v_fma_f32 v174, v174, s53, -v198
    v_fma_f32 v175, v175, s53, -v198
    v_fma_f32 v176, v176, s53, -v198
    v_fma_f32 v177, v177, s53, -v198
    v_exp_f32 v172, v172
    v_exp_f32 v173, v173
    v_exp_f32 v174, v174
    v_exp_f32 v175, v175
    v_exp_f32 v176, v176
    v_exp_f32 v177, v177
    v_add_f32 v200, v172, v174
    v_add_f32 v201, v173, v175
    v_add_f32 v199, v176, v177
    v_add_f32 v200, v200, v201
    v_fmac_f32 v200, 0.5, v199
    s_nop 1
    v_add_f32_dpp v200, v200, v200 row_ror:8 row_mask:0xf bank_mask:0xf
    v_mov_b32 v199, v200
    s_nop 1
    v_permlane32_swap_b32 v200, v199
    v_add_f32 v200, v200, v199
    v_mov_b32 v199, v200
    s_nop 1
    v_permlane16_swap_b32 v200, v199
    v_add_f32 v200, v200, v199
    v_rcp_f32 v200, v200
    s_nop 0
    v_mul_f32 v172, v172, v200
    v_mul_f32 v173, v173, v200
    v_mul_f32 v174, v174, v200
    v_mul_f32 v175, v175, v200
    v_mul_f32 v176, v176, v200
    v_mul_f32 v177, v177, v200
    v_cvt_pk_bf16_f32 v192, v172, v173
    v_cvt_pk_bf16_f32 v193, v174, v175
    v_cvt_pk_bf16_f32 v196, v176, v177
    v_mov_b32_dpp v194, v192 row_ror:8 row_mask:0xf bank_mask:0xf
    v_mov_b32_dpp v195, v193 row_ror:8 row_mask:0xf bank_mask:0xf
    ds_write_b32 v240, v196 offset:14336
    ds_write_b128 v229, v[192:195] offset:10240
    s_waitcnt lgkmcnt(0) vmcnt(0)
    s_barrier
    ds_read_b128 v[160:163], v249 offset:10240
    ds_read_b128 v[164:167], v249 offset:11264
    ds_read_b128 v[168:171], v249 offset:12288
    ds_read_b128 v[172:175], v249 offset:13312
    ds_read_b128 v[180:183], v249 offset:14336
    ds_read_b128 v[176:179], v229 offset:22528
    s_waitcnt lgkmcnt(5)
    v_mfma_f32_16x16x32_bf16 v[184:187], v[208:211], v[160:163], 0
    s_waitcnt lgkmcnt(4)
    v_mfma_f32_16x16x32_bf16 v[184:187], v[212:215], v[164:167], v[184:187]
    s_waitcnt lgkmcnt(3)
    v_mfma_f32_16x16x32_bf16 v[184:187], v[216:219], v[168:171], v[184:187]
    s_waitcnt lgkmcnt(2)
    v_mfma_f32_16x16x32_bf16 v[184:187], v[220:223], v[172:175], v[184:187]
    s_waitcnt lgkmcnt(0)
    v_mfma_f32_16x16x32_bf16 v[184:187], v[176:179], v[180:183], v[184:187]
    s_nop 7
    v_cvt_pk_bf16_f32 v198, v184, v185
    v_cvt_pk_bf16_f32 v199, v186, v187
    v_min_u32 v198, s49, v198
    v_min_u32 v199, s49, v199
    buffer_store_dwordx2 v[198:199], v239, s[12:15], s30 offen sc1
    s_sleep 7
    s_cmp_eq_u32 s27, 63
    s_cbranch_scc1 RECB_endA
RECB_poll_43:
    buffer_load_dwordx4 v[160:163], v226, s[12:15], s30 offen sc1
    s_sub_u32 s46, s46, 1
    s_cbranch_scc1 RECB_pdone_44_x
    s_waitcnt vmcnt(0)
    v_max3_u32 v164, v160, v161, v162
    v_max_u32 v164, v164, v163
    v_cmp_eq_u32 vcc, -1, v164
    s_cbranch_vccnz RECB_poll_43
    s_branch RECB_pdone_44
RECB_pdone_44_x:
    s_mov_b32 s46, 0
    s_waitcnt vmcnt(0)
RECB_pdone_44:
    v_lshlrev_b32 v164, 16, v160
    v_and_b32 v165, 0xffff0000, v160
    v_lshlrev_b32 v168, 16, v162
    v_and_b32 v169, 0xffff0000, v162
    v_lshlrev_b32 v166, 16, v161
    v_and_b32 v167, 0xffff0000, v161
    v_lshlrev_b32 v170, 16, v163
    v_and_b32 v171, 0xffff0000, v163
    v_permlane32_swap_b32 v164, v168
    v_permlane32_swap_b32 v165, v169
    v_permlane32_swap_b32 v166, v170
    v_permlane32_swap_b32 v167, v171
    v_pk_add_f32 v[164:165], v[164:165], v[168:169]
    v_pk_add_f32 v[166:167], v[166:167], v[170:171]
    s_nop 1
    v_permlane16_swap_b32 v164, v166
    v_permlane16_swap_b32 v165, v167
    v_pk_add_f32 v[164:165], v[164:165], v[166:167]
    s_nop 1
    v_add_f32_dpp v164, v164, v164 row_ror:8 row_mask:0xf bank_mask:0xf
    v_add_f32_dpp v165, v165, v165 row_ror:8 row_mask:0xf bank_mask:0xf
    v_cvt_pk_bf16_f32 v160, v164, v165
    v_min_u32 v160, s49, v160
    buffer_store_dword v160, v227, s[12:15], s33 offen sc1
RECB_endA:
    s_add_u32 s27, s27, 1
    s_cmp_lt_u32 s27, 64
    s_cbranch_scc1 RECB_loopA
    s_waitcnt lgkmcnt(0)
    s_barrier
    s_barrier
    s_branch RECB_done
RECB_yw:
    s_cmp_ge_u32 s20, 10
    s_cbranch_scc1 RECB_norecv
    v_add_u32 v248, s58, v249
    s_load_dwordx2 s[8:9], s[0:1], 32
    s_mov_b32 s10, 7864320
    s_mov_b32 s11, 0x00020000
    s_mul_i32 s52, s26, 384
    v_add_u32 v237, 0, v255
    v_mul_u32_u24 v238, 2731, v237
    v_lshrrev_b32 v238, 16, v238
    v_mul_u32_u24 v239, 24, v238
    v_sub_u32 v239, v237, v239
    v_and_b32 v240, 7, v238
    v_xor_b32 v239, v239, v240
    v_mul_u32_u24 v238, 12288, v238
    v_lshl_add_u32 v200, v239, 4, v238
    v_add_u32 v237, 64, v255
    v_mul_u32_u24 v238, 2731, v237
    v_lshrrev_b32 v238, 16, v238
    v_mul_u32_u24 v239, 24, v238
    v_sub_u32 v239, v237, v239
    v_and_b32 v240, 7, v238
    v_xor_b32 v239, v239, v240
    v_mul_u32_u24 v238, 12288, v238
    v_lshl_add_u32 v201, v239, 4, v238
    v_add_u32 v237, 128, v255
    v_mul_u32_u24 v238, 2731, v237
    v_lshrrev_b32 v238, 16, v238
    v_mul_u32_u24 v239, 24, v238
    v_sub_u32 v239, v237, v239
    v_and_b32 v240, 7, v238
    v_xor_b32 v239, v239, v240
    v_mul_u32_u24 v238, 12288, v238
    v_lshl_add_u32 v202, v239, 4, v238
    v_add_u32 v237, 192, v255
    v_mul_u32_u24 v238, 2731, v237
    v_lshrrev_b32 v238, 16, v238
    v_mul_u32_u24 v239, 24, v238
    v_sub_u32 v239, v237, v239
    v_and_b32 v240, 7, v238
    v_xor_b32 v239, v239, v240
    v_mul_u32_u24 v238, 12288, v238
    v_lshl_add_u32 v203, v239, 4, v238
    v_add_u32 v237, 256, v255
    v_mul_u32_u24 v238, 2731, v237
    v_lshrrev_b32 v238, 16, v238
    v_mul_u32_u24 v239, 24, v238
    v_sub_u32 v239, v237, v239
    v_and_b32 v240, 7, v238
    v_xor_b32 v239, v239, v240
    v_mul_u32_u24 v238, 12288, v238
    v_lshl_add_u32 v204, v239, 4, v238
    v_add_u32 v237, 320, v255
    v_mul_u32_u24 v238, 2731, v237
    v_lshrrev_b32 v238, 16, v238
    v_mul_u32_u24 v239, 24, v238
    v_sub_u32 v239, v237, v239
    v_and_b32 v240, 7, v238
    v_xor_b32 v239, v239, v240
    v_mul_u32_u24 v238, 12288, v238
    v_lshl_add_u32 v205, v239, 4, v238
    s_waitcnt lgkmcnt(0)
    s_mov_b32 s43, s76
    s_mov_b32 m0, s43
    s_add_u32 s43, s43, 1024
    buffer_load_dwordx4 v200, s[8:11], s52 offen lds
    s_mov_b32 m0, s43
    s_add_u32 s43, s43, 1024
    buffer_load_dwordx4 v201, s[8:11], s52 offen lds
    s_mov_b32 m0, s43
    s_add_u32 s43, s43, 1024
    buffer_load_dwordx4 v202, s[8:11], s52 offen lds
    s_mov_b32 m0, s43
    s_add_u32 s43, s43, 1024
    buffer_load_dwordx4 v203, s[8:11], s52 offen lds
    s_mov_b32 m0, s43
    s_add_u32 s43, s43, 1024
    buffer_load_dwordx4 v204, s[8:11], s52 offen lds
    s_mov_b32 m0, s43
    s_add_u32 s43, s43, 1024
    buffer_load_dwordx4 v205, s[8:11], s52 offen lds
    s_add_u32 s52, s52, 196608
    s_mov_b32 s43, s77
    s_mov_b32 m0, s43
    s_add_u32 s43, s43, 1024
    buffer_load_dwordx4 v200, s[8:11], s52 offen lds
    s_mov_b32 m0, s43
    s_add_u32 s43, s43, 1024
    buffer_load_dwordx4 v201, s[8:11], s52 offen lds
    s_mov_b32 m0, s43
    s_add_u32 s43, s43, 1024
    buffer_load_dwordx4 v202, s[8:11], s52 offen lds
    s_mov_b32 m0, s43
    s_add_u32 s43, s43, 1024
    buffer_load_dwordx4 v203, s[8:11], s52 offen lds
    s_mov_b32 m0, s43
    s_add_u32 s43, s43, 1024
    buffer_load_dwordx4 v204, s[8:11], s52 offen lds
    s_mov_b32 m0, s43
    s_add_u32 s43, s43, 1024
    buffer_load_dwordx4 v205, s[8:11], s52 offen lds
    s_add_u32 s52, s52, 196608
    s_waitcnt vmcnt(6)
    s_barrier
    s_mov_b32 s43, s78
    s_mov_b32 m0, s43
    s_add_u32 s43, s43, 1024
    buffer_load_dwordx4 v200, s[8:11], s52 offen lds
    s_mov_b32 m0, s43
    s_add_u32 s43, s43, 1024
    buffer_load_dwordx4 v201, s[8:11], s52 offen lds
    s_mov_b32 m0, s43
    s_add_u32 s43, s43, 1024
    buffer_load_dwordx4 v202, s[8:11], s52 offen lds
    s_mov_b32 m0, s43
    s_add_u32 s43, s43, 1024
    buffer_load_dwordx4 v203, s[8:11], s52 offen lds
    s_mov_b32 m0, s43
    s_add_u32 s43, s43, 1024
    buffer_load_dwordx4 v204, s[8:11], s52 offen lds
    s_mov_b32 m0, s43
    s_add_u32 s43, s43, 1024
    buffer_load_dwordx4 v205, s[8:11], s52 offen lds
    s_add_u32 s52, s52, 196608
    s_waitcnt vmcnt(6)
    s_barrier
    s_mov_b32 s43, s76
    s_mov_b32 m0, s43
    s_add_u32 s43, s43, 1024
    buffer_load_dwordx4 v200, s[8:11], s52 offen lds
    s_mov_b32 m0, s43
    s_add_u32 s43, s43, 1024
    buffer_load_dwordx4 v201, s[8:11], s52 offen lds
    s_mov_b32 m0, s43
    s_add_u32 s43, s43, 1024
    buffer_load_dwordx4 v202, s[8:11], s52 offen lds
    s_mov_b32 m0, s43
    s_add_u32 s43, s43, 1024
    buffer_load_dwordx4 v203, s[8:11], s52 offen lds
    s_mov_b32 m0, s43
    s_add_u32 s43, s43, 1024
    buffer_load_dwordx4 v204, s[8:11], s52 offen lds
    s_mov_b32 m0, s43
    s_add_u32 s43, s43, 1024
    buffer_load_dwordx4 v205, s[8:11], s52 offen lds
    s_add_u32 s52, s52, 196608
    s_waitcnt vmcnt(6)
    s_barrier
    s_mov_b32 s43, s77
    s_mov_b32 m0, s43
    s_add_u32 s43, s43, 1024
    buffer_load_dwordx4 v200, s[8:11], s52 offen lds
    s_mov_b32 m0, s43
    s_add_u32 s43, s43, 1024
    buffer_load_dwordx4 v201, s[8:11], s52 offen lds
    s_mov_b32 m0, s43
    s_add_u32 s43, s43, 1024
    buffer_load_dwordx4 v202, s[8:11], s52 offen lds
    s_mov_b32 m0, s43
    s_add_u32 s43, s43, 1024
    buffer_load_dwordx4 v203, s[8:11], s52 offen lds
    s_mov_b32 m0, s43
    s_add_u32 s43, s43, 1024
    buffer_load_dwordx4 v204, s[8:11], s52 offen lds
    s_mov_b32 m0, s43
    s_add_u32 s43, s43, 1024
    buffer_load_dwordx4 v205, s[8:11], s52 offen lds
    s_add_u32 s52, s52, 196608
    s_waitcnt vmcnt(6)
    s_barrier
    s_mov_b32 s43, s78
    s_mov_b32 m0, s43
    s_add_u32 s43, s43, 1024
    buffer_load_dwordx4 v200, s[8:11], s52 offen lds
    s_mov_b32 m0, s43
    s_add_u32 s43, s43, 1024
    buffer_load_dwordx4 v201, s[8:11], s52 offen lds
    s_mov_b32 m0, s43
    s_add_u32 s43, s43, 1024
    buffer_load_dwordx4 v202, s[8:11], s52 offen lds
    s_mov_b32 m0, s43
    s_add_u32 s43, s43, 1024
    buffer_load_dwordx4 v203, s[8:11], s52 offen lds
    s_mov_b32 m0, s43
    s_add_u32 s43, s43, 1024
    buffer_load_dwordx4 v204, s[8:11], s52 offen lds
    s_mov_b32 m0, s43
    s_add_u32 s43, s43, 1024
    buffer_load_dwordx4 v205, s[8:11], s52 offen lds
    s_add_u32 s52, s52, 196608
    ds_read_b128 v[0:3], v248 offset:8192
    ds_read_b128 v[4:7], v248 offset:9216
    ds_read_b128 v[8:11], v248 offset:10240
    ds_read_b128 v[12:15], v248 offset:11264
    s_waitcnt lgkmcnt(0)
    s_waitcnt vmcnt(6)
    s_barrier
    s_mov_b32 s43, s76
    s_mov_b32 m0, s43
    s_add_u32 s43, s43, 1024
    buffer_load_dwordx4 v200, s[8:11], s52 offen lds
    s_mov_b32 m0, s43
    s_add_u32 s43, s43, 1024
    buffer_load_dwordx4 v201, s[8:11], s52 offen lds
    s_mov_b32 m0, s43
    s_add_u32 s43, s43, 1024
    buffer_load_dwordx4 v202, s[8:11], s52 offen lds
    s_mov_b32 m0, s43
    s_add_u32 s43, s43, 1024
    buffer_load_dwordx4 v203, s[8:11], s52 offen lds
    s_mov_b32 m0, s43
    s_add_u32 s43, s43, 1024
    buffer_load_dwordx4 v204, s[8:11], s52 offen lds
    s_mov_b32 m0, s43
    s_add_u32 s43, s43, 1024
    buffer_load_dwordx4 v205, s[8:11], s52 offen lds
    s_add_u32 s52, s52, 196608
    s_waitcnt vmcnt(6)
    s_barrier
    s_mov_b32 s43, s77
    s_mov_b32 m0, s43
    s_add_u32 s43, s43, 1024
    buffer_load_dwordx4 v200, s[8:11], s52 offen lds
    s_mov_b32 m0, s43
    s_add_u32 s43, s43, 1024
    buffer_load_dwordx4 v201, s[8:11], s52 offen lds
    s_mov_b32 m0, s43
    s_add_u32 s43, s43, 1024
    buffer_load_dwordx4 v202, s[8:11], s52 offen lds
    s_mov_b32 m0, s43
    s_add_u32 s43, s43, 1024
    buffer_load_dwordx4 v203, s[8:11], s52 offen lds
    s_mov_b32 m0, s43
    s_add_u32 s43, s43, 1024
    buffer_load_dwordx4 v204, s[8:11], s52 offen lds
    s_mov_b32 m0, s43
    s_add_u32 s43, s43, 1024
    buffer_load_dwordx4 v205, s[8:11], s52 offen lds
    s_add_u32 s52, s52, 196608
    ds_read_b128 v[16:19], v248 offset:12288
    ds_read_b128 v[20:23], v248 offset:13312
    ds_read_b128 v[24:27], v248 offset:14336
    ds_read_b128 v[28:31], v248 offset:15360
    s_waitcnt lgkmcnt(0)
    s_waitcnt vmcnt(6)
    s_barrier
    s_mov_b32 s43, s78
    s_mov_b32 m0, s43
    s_add_u32 s43, s43, 1024
    buffer_load_dwordx4 v200, s[8:11], s52 offen lds
    s_mov_b32 m0, s43
    s_add_u32 s43, s43, 1024
    buffer_load_dwordx4 v201, s[8:11], s52 offen lds
    s_mov_b32 m0, s43
    s_add_u32 s43, s43, 1024
    buffer_load_dwordx4 v202, s[8:11], s52 offen lds
    s_mov_b32 m0, s43
    s_add_u32 s43, s43, 1024
    buffer_load_dwordx4 v203, s[8:11], s52 offen lds
    s_mov_b32 m0, s43
    s_add_u32 s43, s43, 1024
    buffer_load_dwordx4 v204, s[8:11], s52 offen lds
    s_mov_b32 m0, s43
    s_add_u32 s43, s43, 1024
    buffer_load_dwordx4 v205, s[8:11], s52 offen lds
    s_add_u32 s52, s52, 196608
    s_waitcnt vmcnt(6)
    s_barrier
    s_mov_b32 s43, s76
    s_mov_b32 m0, s43
    s_add_u32 s43, s43, 1024
    buffer_load_dwordx4 v200, s[8:11], s52 offen lds
    s_mov_b32 m0, s43
    s_add_u32 s43, s43, 1024
    buffer_load_dwordx4 v201, s[8:11], s52 offen lds
    s_mov_b32 m0, s43
    s_add_u32 s43, s43, 1024
    buffer_load_dwordx4 v202, s[8:11], s52 offen lds
    s_mov_b32 m0, s43
    s_add_u32 s43, s43, 1024
    buffer_load_dwordx4 v203, s[8:11], s52 offen lds
    s_mov_b32 m0, s43
    s_add_u32 s43, s43, 1024
    buffer_load_dwordx4 v204, s[8:11], s52 offen lds
    s_mov_b32 m0, s43
    s_add_u32 s43, s43, 1024
    buffer_load_dwordx4 v205, s[8:11], s52 offen lds
    s_add_u32 s52, s52, 196608
    ds_read_b128 v[32:35], v248 offset:8192
    ds_read_b128 v[36:39], v248 offset:9216
    ds_read_b128 v[40:43], v248 offset:10240
    ds_read_b128 v[44:47], v248 offset:11264
    s_waitcnt lgkmcnt(0)
    s_waitcnt vmcnt(6)
    s_barrier
    s_mov_b32 s43, s77
    s_mov_b32 m0, s43
    s_add_u32 s43, s43, 1024
    buffer_load_dwordx4 v200, s[8:11], s52 offen lds
    s_mov_b32 m0, s43
    s_add_u32 s43, s43, 1024
    buffer_load_dwordx4 v201, s[8:11], s52 offen lds
    s_mov_b32 m0, s43
    s_add_u32 s43, s43, 1024
    buffer_load_dwordx4 v202, s[8:11], s52 offen lds
    s_mov_b32 m0, s43
    s_add_u32 s43, s43, 1024
    buffer_load_dwordx4 v203, s[8:11], s52 offen lds
    s_mov_b32 m0, s43
    s_add_u32 s43, s43, 1024
    buffer_load_dwordx4 v204, s[8:11], s52 offen lds
    s_mov_b32 m0, s43
    s_add_u32 s43, s43, 1024
    buffer_load_dwordx4 v205, s[8:11], s52 offen lds
    s_add_u32 s52, s52, 196608
    s_waitcnt vmcnt(6)
    s_barrier
    s_mov_b32 s43, s78
    s_mov_b32 m0, s43
    s_add_u32 s43, s43, 1024
    buffer_load_dwordx4 v200, s[8:11], s52 offen lds
    s_mov_b32 m0, s43
    s_add_u32 s43, s43, 1024
    buffer_load_dwordx4 v201, s[8:11], s52 offen lds
    s_mov_b32 m0, s43
    s_add_u32 s43, s43, 1024
    buffer_load_dwordx4 v202, s[8:11], s52 offen lds
    s_mov_b32 m0, s43
    s_add_u32 s43, s43, 1024
    buffer_load_dwordx4 v203, s[8:11], s52 offen lds
    s_mov_b32 m0, s43
    s_add_u32 s43, s43, 1024
    buffer_load_dwordx4 v204, s[8:11], s52 offen lds
    s_mov_b32 m0, s43
    s_add_u32 s43, s43, 1024
    buffer_load_dwordx4 v205, s[8:11], s52 offen lds
    s_add_u32 s52, s52, 196608
    ds_read_b128 v[48:51], v248 offset:12288
    ds_read_b128 v[52:55], v248 offset:13312
    ds_read_b128 v[56:59], v248 offset:14336
    ds_read_b128 v[60:63], v248 offset:15360
    s_waitcnt lgkmcnt(0)
    s_waitcnt vmcnt(6)
    s_barrier
    s_mov_b32 s43, s76
    s_mov_b32 m0, s43
    s_add_u32 s43, s43, 1024
    buffer_load_dwordx4 v200, s[8:11], s52 offen lds
    s_mov_b32 m0, s43
    s_add_u32 s43, s43, 1024
    buffer_load_dwordx4 v201, s[8:11], s52 offen lds
    s_mov_b32 m0, s43
    s_add_u32 s43, s43, 1024
    buffer_load_dwordx4 v202, s[8:11], s52 offen lds
    s_mov_b32 m0, s43
    s_add_u32 s43, s43, 1024
    buffer_load_dwordx4 v203, s[8:11], s52 offen lds
    s_mov_b32 m0, s43
    s_add_u32 s43, s43, 1024
    buffer_load_dwordx4 v204, s[8:11], s52 offen lds
    s_mov_b32 m0, s43
    s_add_u32 s43, s43, 1024
    buffer_load_dwordx4 v205, s[8:11], s52 offen lds
    s_add_u32 s52, s52, 196608
    s_waitcnt vmcnt(6)
    s_barrier
    s_mov_b32 s43, s77
    s_mov_b32 m0, s43
    s_add_u32 s43, s43, 1024
    buffer_load_dwordx4 v200, s[8:11], s52 offen lds
    s_mov_b32 m0, s43
    s_add_u32 s43, s43, 1024
    buffer_load_dwordx4 v201, s[8:11], s52 offen lds
    s_mov_b32 m0, s43
    s_add_u32 s43, s43, 1024
    buffer_load_dwordx4 v202, s[8:11], s52 offen lds
    s_mov_b32 m0, s43
    s_add_u32 s43, s43, 1024
    buffer_load_dwordx4 v203, s[8:11], s52 offen lds
    s_mov_b32 m0, s43
    s_add_u32 s43, s43, 1024
    buffer_load_dwordx4 v204, s[8:11], s52 offen lds
    s_mov_b32 m0, s43
    s_add_u32 s43, s43, 1024
    buffer_load_dwordx4 v205, s[8:11], s52 offen lds
    s_add_u32 s52, s52, 196608
    ds_read_b128 v[64:67], v248 offset:8192
    ds_read_b128 v[68:71], v248 offset:9216
    ds_read_b128 v[72:75], v248 offset:10240
    ds_read_b128 v[76:79], v248 offset:11264
    s_waitcnt lgkmcnt(0)
    s_waitcnt vmcnt(6)
    s_barrier
    s_mov_b32 s43, s78
    s_mov_b32 m0, s43
    s_add_u32 s43, s43, 1024
    buffer_load_dwordx4 v200, s[8:11], s52 offen lds
    s_mov_b32 m0, s43
    s_add_u32 s43, s43, 1024
    buffer_load_dwordx4 v201, s[8:11], s52 offen lds
    s_mov_b32 m0, s43
    s_add_u32 s43, s43, 1024
    buffer_load_dwordx4 v202, s[8:11], s52 offen lds
    s_mov_b32 m0, s43
    s_add_u32 s43, s43, 1024
    buffer_load_dwordx4 v203, s[8:11], s52 offen lds
    s_mov_b32 m0, s43
    s_add_u32 s43, s43, 1024
    buffer_load_dwordx4 v204, s[8:11], s52 offen lds
    s_mov_b32 m0, s43
    s_add_u32 s43, s43, 1024
    buffer_load_dwordx4 v205, s[8:11], s52 offen lds
    s_add_u32 s52, s52, 196608
    s_waitcnt vmcnt(6)
    s_barrier
    s_mov_b32 s43, s76
    s_mov_b32 m0, s43
    s_add_u32 s43, s43, 1024
    buffer_load_dwordx4 v200, s[8:11], s52 offen lds
    s_mov_b32 m0, s43
    s_add_u32 s43, s43, 1024
    buffer_load_dwordx4 v201, s[8:11], s52 offen lds
    s_mov_b32 m0, s43
    s_add_u32 s43, s43, 1024
    buffer_load_dwordx4 v202, s[8:11], s52 offen lds
    s_mov_b32 m0, s43
    s_add_u32 s43, s43, 1024
    buffer_load_dwordx4 v203, s[8:11], s52 offen lds
    s_mov_b32 m0, s43
    s_add_u32 s43, s43, 1024
    buffer_load_dwordx4 v204, s[8:11], s52 offen lds
    s_mov_b32 m0, s43
    s_add_u32 s43, s43, 1024
    buffer_load_dwordx4 v205, s[8:11], s52 offen lds
    s_add_u32 s52, s52, 196608
    ds_read_b128 v[80:83], v248 offset:12288
    ds_read_b128 v[84:87], v248 offset:13312
    ds_read_b128 v[88:91], v248 offset:14336
    ds_read_b128 v[92:95], v248 offset:15360
    s_waitcnt lgkmcnt(0)
    s_waitcnt vmcnt(6)
    s_barrier
    s_mov_b32 s43, s77
    s_mov_b32 m0, s43
    s_add_u32 s43, s43, 1024
    buffer_load_dwordx4 v200, s[8:11], s52 offen lds
    s_mov_b32 m0, s43
    s_add_u32 s43, s43, 1024
    buffer_load_dwordx4 v201, s[8:11], s52 offen lds
    s_mov_b32 m0, s43
    s_add_u32 s43, s43, 1024
    buffer_load_dwordx4 v202, s[8:11], s52 offen lds
    s_mov_b32 m0, s43
    s_add_u32 s43, s43, 1024
    buffer_load_dwordx4 v203, s[8:11], s52 offen lds
    s_mov_b32 m0, s43
    s_add_u32 s43, s43, 1024
    buffer_load_dwordx4 v204, s[8:11], s52 offen lds
    s_mov_b32 m0, s43
    s_add_u32 s43, s43, 1024
    buffer_load_dwordx4 v205, s[8:11], s52 offen lds
    s_add_u32 s52, s52, 196608
    s_waitcnt vmcnt(6)
    s_barrier
    s_mov_b32 s43, s78
    s_mov_b32 m0, s43
    s_add_u32 s43, s43, 1024
    buffer_load_dwordx4 v200, s[8:11], s52 offen lds
    s_mov_b32 m0, s43
    s_add_u32 s43, s43, 1024
    buffer_load_dwordx4 v201, s[8:11], s52 offen lds
    s_mov_b32 m0, s43
    s_add_u32 s43, s43, 1024
    buffer_load_dwordx4 v202, s[8:11], s52 offen lds
    s_mov_b32 m0, s43
    s_add_u32 s43, s43, 1024
    buffer_load_dwordx4 v203, s[8:11], s52 offen lds
    s_mov_b32 m0, s43
    s_add_u32 s43, s43, 1024
    buffer_load_dwordx4 v204, s[8:11], s52 offen lds
    s_mov_b32 m0, s43
    s_add_u32 s43, s43, 1024
    buffer_load_dwordx4 v205, s[8:11], s52 offen lds
    s_add_u32 s52, s52, 196608
    ds_read_b128 v[96:99], v248 offset:8192
    ds_read_b128 v[100:103], v248 offset:9216
    ds_read_b128 v[104:107], v248 offset:10240
    ds_read_b128 v[108:111], v248 offset:11264
    s_waitcnt lgkmcnt(0)
    s_waitcnt vmcnt(6)
    s_barrier
    s_mov_b32 s43, s76
    s_mov_b32 m0, s43
    s_add_u32 s43, s43, 1024
    buffer_load_dwordx4 v200, s[8:11], s52 offen lds
    s_mov_b32 m0, s43
    s_add_u32 s43, s43, 1024
    buffer_load_dwordx4 v201, s[8:11], s52 offen lds
    s_mov_b32 m0, s43
    s_add_u32 s43, s43, 1024
    buffer_load_dwordx4 v202, s[8:11], s52 offen lds
    s_mov_b32 m0, s43
    s_add_u32 s43, s43, 1024
    buffer_load_dwordx4 v203, s[8:11], s52 offen lds
    s_mov_b32 m0, s43
    s_add_u32 s43, s43, 1024
    buffer_load_dwordx4 v204, s[8:11], s52 offen lds
    s_mov_b32 m0, s43
    s_add_u32 s43, s43, 1024
    buffer_load_dwordx4 v205, s[8:11], s52 offen lds
    s_add_u32 s52, s52, 196608
    s_waitcnt vmcnt(6)
    s_barrier
    s_mov_b32 s43, s77
    s_mov_b32 m0, s43
    s_add_u32 s43, s43, 1024
    buffer_load_dwordx4 v200, s[8:11], s52 offen lds
    s_mov_b32 m0, s43
    s_add_u32 s43, s43, 1024
    buffer_load_dwordx4 v201, s[8:11], s52 offen lds
    s_mov_b32 m0, s43
    s_add_u32 s43, s43, 1024
    buffer_load_dwordx4 v202, s[8:11], s52 offen lds
    s_mov_b32 m0, s43
    s_add_u32 s43, s43, 1024
    buffer_load_dwordx4 v203, s[8:11], s52 offen lds
    s_mov_b32 m0, s43
    s_add_u32 s43, s43, 1024
    buffer_load_dwordx4 v204, s[8:11], s52 offen lds
    s_mov_b32 m0, s43
    s_add_u32 s43, s43, 1024
    buffer_load_dwordx4 v205, s[8:11], s52 offen lds
    s_add_u32 s52, s52, 196608
    ds_read_b128 v[112:115], v248 offset:12288
    ds_read_b128 v[116:119], v248 offset:13312
    ds_read_b128 v[120:123], v248 offset:14336
    ds_read_b128 v[124:127], v248 offset:15360
    s_waitcnt lgkmcnt(0)
    s_waitcnt vmcnt(6)
    s_barrier
    s_mov_b32 s43, s78
    s_mov_b32 m0, s43
    s_add_u32 s43, s43, 1024
    buffer_load_dwordx4 v200, s[8:11], s52 offen lds
    s_mov_b32 m0, s43
    s_add_u32 s43, s43, 1024
    buffer_load_dwordx4 v201, s[8:11], s52 offen lds
    s_mov_b32 m0, s43
    s_add_u32 s43, s43, 1024
    buffer_load_dwordx4 v202, s[8:11], s52 offen lds
    s_mov_b32 m0, s43
    s_add_u32 s43, s43, 1024
    buffer_load_dwordx4 v203, s[8:11], s52 offen lds
    s_mov_b32 m0, s43
    s_add_u32 s43, s43, 1024
    buffer_load_dwordx4 v204, s[8:11], s52 offen lds
    s_mov_b32 m0, s43
    s_add_u32 s43, s43, 1024
    buffer_load_dwordx4 v205, s[8:11], s52 offen lds
    s_add_u32 s52, s52, 196608
    s_waitcnt vmcnt(6)
    s_barrier
    s_mov_b32 s43, s76
    s_mov_b32 m0, s43
    s_add_u32 s43, s43, 1024
    buffer_load_dwordx4 v200, s[8:11], s52 offen lds
    s_mov_b32 m0, s43
    s_add_u32 s43, s43, 1024
    buffer_load_dwordx4 v201, s[8:11], s52 offen lds
    s_mov_b32 m0, s43
    s_add_u32 s43, s43, 1024
    buffer_load_dwordx4 v202, s[8:11], s52 offen lds
    s_mov_b32 m0, s43
    s_add_u32 s43, s43, 1024
    buffer_load_dwordx4 v203, s[8:11], s52 offen lds
    s_mov_b32 m0, s43
    s_add_u32 s43, s43, 1024
    buffer_load_dwordx4 v204, s[8:11], s52 offen lds
    s_mov_b32 m0, s43
    s_add_u32 s43, s43, 1024
    buffer_load_dwordx4 v205, s[8:11], s52 offen lds
    s_add_u32 s52, s52, 196608
    ds_read_b128 v[128:131], v248 offset:8192
    ds_read_b128 v[132:135], v248 offset:9216
    ds_read_b128 v[136:139], v248 offset:10240
    ds_read_b128 v[140:143], v248 offset:11264
    s_waitcnt lgkmcnt(0)
    s_waitcnt vmcnt(6)
    s_barrier
    s_mov_b32 s43, s77
    s_mov_b32 m0, s43
    s_add_u32 s43, s43, 1024
    buffer_load_dwordx4 v200, s[8:11], s52 offen lds
    s_mov_b32 m0, s43
    s_add_u32 s43, s43, 1024
    buffer_load_dwordx4 v201, s[8:11], s52 offen lds
    s_mov_b32 m0, s43
    s_add_u32 s43, s43, 1024
    buffer_load_dwordx4 v202, s[8:11], s52 offen lds
    s_mov_b32 m0, s43
    s_add_u32 s43, s43, 1024
    buffer_load_dwordx4 v203, s[8:11], s52 offen lds
    s_mov_b32 m0, s43
    s_add_u32 s43, s43, 1024
    buffer_load_dwordx4 v204, s[8:11], s52 offen lds
    s_mov_b32 m0, s43
    s_add_u32 s43, s43, 1024
    buffer_load_dwordx4 v205, s[8:11], s52 offen lds
    s_add_u32 s52, s52, 196608
    s_waitcnt vmcnt(6)
    s_barrier
    s_mov_b32 s43, s78
    s_mov_b32 m0, s43
    s_add_u32 s43, s43, 1024
    buffer_load_dwordx4 v200, s[8:11], s52 offen lds
    s_mov_b32 m0, s43
    s_add_u32 s43, s43, 1024
    buffer_load_dwordx4 v201, s[8:11], s52 offen lds
    s_mov_b32 m0, s43
    s_add_u32 s43, s43, 1024
    buffer_load_dwordx4 v202, s[8:11], s52 offen lds
    s_mov_b32 m0, s43
    s_add_u32 s43, s43, 1024
    buffer_load_dwordx4 v203, s[8:11], s52 offen lds
    s_mov_b32 m0, s43
    s_add_u32 s43, s43, 1024
    buffer_load_dwordx4 v204, s[8:11], s52 offen lds
    s_mov_b32 m0, s43
    s_add_u32 s43, s43, 1024
    buffer_load_dwordx4 v205, s[8:11], s52 offen lds
    s_add_u32 s52, s52, 196608
    ds_read_b128 v[144:147], v248 offset:12288
    ds_read_b128 v[148:151], v248 offset:13312
    ds_read_b128 v[152:155], v248 offset:14336
    ds_read_b128 v[156:159], v248 offset:15360
    s_waitcnt lgkmcnt(0)
    s_waitcnt vmcnt(6)
    s_barrier
    s_mov_b32 s43, s76
    s_mov_b32 m0, s43
    s_add_u32 s43, s43, 1024
    buffer_load_dwordx4 v200, s[8:11], s52 offen lds
    s_mov_b32 m0, s43
    s_add_u32 s43, s43, 1024
    buffer_load_dwordx4 v201, s[8:11], s52 offen lds
    s_mov_b32 m0, s43
    s_add_u32 s43, s43, 1024
    buffer_load_dwordx4 v202, s[8:11], s52 offen lds
    s_mov_b32 m0, s43
    s_add_u32 s43, s43, 1024
    buffer_load_dwordx4 v203, s[8:11], s52 offen lds
    s_mov_b32 m0, s43
    s_add_u32 s43, s43, 1024
    buffer_load_dwordx4 v204, s[8:11], s52 offen lds
    s_mov_b32 m0, s43
    s_add_u32 s43, s43, 1024
    buffer_load_dwordx4 v205, s[8:11], s52 offen lds
    s_add_u32 s52, s52, 196608
    s_waitcnt vmcnt(6)
    s_barrier
    s_mov_b32 s43, s77
    s_mov_b32 m0, s43
    s_add_u32 s43, s43, 1024
    buffer_load_dwordx4 v200, s[8:11], s52 offen lds
    s_mov_b32 m0, s43
    s_add_u32 s43, s43, 1024
    buffer_load_dwordx4 v201, s[8:11], s52 offen lds
    s_mov_b32 m0, s43
    s_add_u32 s43, s43, 1024
    buffer_load_dwordx4 v202, s[8:11], s52 offen lds
    s_mov_b32 m0, s43
    s_add_u32 s43, s43, 1024
    buffer_load_dwordx4 v203, s[8:11], s52 offen lds
    s_mov_b32 m0, s43
    s_add_u32 s43, s43, 1024
    buffer_load_dwordx4 v204, s[8:11], s52 offen lds
    s_mov_b32 m0, s43
    s_add_u32 s43, s43, 1024
    buffer_load_dwordx4 v205, s[8:11], s52 offen lds
    s_add_u32 s52, s52, 196608
    ds_read_b128 v[160:163], v248 offset:8192
    ds_read_b128 v[164:167], v248 offset:9216
    ds_read_b128 v[168:171], v248 offset:10240
    ds_read_b128 v[172:175], v248 offset:11264
    s_waitcnt lgkmcnt(0)
    s_waitcnt vmcnt(6)
    s_barrier
    s_mov_b32 s43, s78
    s_mov_b32 m0, s43
    s_add_u32 s43, s43, 1024
    buffer_load_dwordx4 v200, s[8:11], s52 offen lds
    s_mov_b32 m0, s43
    s_add_u32 s43, s43, 1024
    buffer_load_dwordx4 v201, s[8:11], s52 offen lds
    s_mov_b32 m0, s43
    s_add_u32 s43, s43, 1024
    buffer_load_dwordx4 v202, s[8:11], s52 offen lds
    s_mov_b32 m0, s43
    s_add_u32 s43, s43, 1024
    buffer_load_dwordx4 v203, s[8:11], s52 offen lds
    s_mov_b32 m0, s43
    s_add_u32 s43, s43, 1024
    buffer_load_dwordx4 v204, s[8:11], s52 offen lds
    s_mov_b32 m0, s43
    s_add_u32 s43, s43, 1024
    buffer_load_dwordx4 v205, s[8:11], s52 offen lds
    s_add_u32 s52, s52, 196608
    s_waitcnt vmcnt(6)
    s_barrier
    s_mov_b32 s43, s76
    s_mov_b32 m0, s43
    s_add_u32 s43, s43, 1024
    buffer_load_dwordx4 v200, s[8:11], s52 offen lds
    s_mov_b32 m0, s43
    s_add_u32 s43, s43, 1024
    buffer_load_dwordx4 v201, s[8:11], s52 offen lds
    s_mov_b32 m0, s43
    s_add_u32 s43, s43, 1024
    buffer_load_dwordx4 v202, s[8:11], s52 offen lds
    s_mov_b32 m0, s43
    s_add_u32 s43, s43, 1024
    buffer_load_dwordx4 v203, s[8:11], s52 offen lds
    s_mov_b32 m0, s43
    s_add_u32 s43, s43, 1024
    buffer_load_dwordx4 v204, s[8:11], s52 offen lds
    s_mov_b32 m0, s43
    s_add_u32 s43, s43, 1024
    buffer_load_dwordx4 v205, s[8:11], s52 offen lds
    s_add_u32 s52, s52, 196608
    ds_read_b128 v[176:179], v248 offset:12288
    ds_read_b128 v[180:183], v248 offset:13312
    ds_read_b128 v[184:187], v248 offset:14336
    ds_read_b128 v[188:191], v248 offset:15360
    s_waitcnt lgkmcnt(0)
    s_waitcnt vmcnt(6)
    s_barrier
    s_mov_b32 s43, s77
    s_mov_b32 m0, s43
    s_add_u32 s43, s43, 1024
    buffer_load_dwordx4 v200, s[8:11], s52 offen lds
    s_mov_b32 m0, s43
    s_add_u32 s43, s43, 1024
    buffer_load_dwordx4 v201, s[8:11], s52 offen lds
    s_mov_b32 m0, s43
    s_add_u32 s43, s43, 1024
    buffer_load_dwordx4 v202, s[8:11], s52 offen lds
    s_mov_b32 m0, s43
    s_add_u32 s43, s43, 1024
    buffer_load_dwordx4 v203, s[8:11], s52 offen lds
    s_mov_b32 m0, s43
    s_add_u32 s43, s43, 1024
    buffer_load_dwordx4 v204, s[8:11], s52 offen lds
    s_mov_b32 m0, s43
    s_add_u32 s43, s43, 1024
    buffer_load_dwordx4 v205, s[8:11], s52 offen lds
    s_add_u32 s52, s52, 196608
    s_waitcnt vmcnt(6)
    s_barrier
    s_mov_b32 s43, s78
    s_mov_b32 m0, s43
    s_add_u32 s43, s43, 1024
    buffer_load_dwordx4 v200, s[8:11], s52 offen lds
    s_mov_b32 m0, s43
    s_add_u32 s43, s43, 1024
    buffer_load_dwordx4 v201, s[8:11], s52 offen lds
    s_mov_b32 m0, s43
    s_add_u32 s43, s43, 1024
    buffer_load_dwordx4 v202, s[8:11], s52 offen lds
    s_mov_b32 m0, s43
    s_add_u32 s43, s43, 1024
    buffer_load_dwordx4 v203, s[8:11], s52 offen lds
    s_mov_b32 m0, s43
    s_add_u32 s43, s43, 1024
    buffer_load_dwordx4 v204, s[8:11], s52 offen lds
    s_mov_b32 m0, s43
    s_add_u32 s43, s43, 1024
    buffer_load_dwordx4 v205, s[8:11], s52 offen lds
    s_add_u32 s52, s52, 196608
    s_waitcnt vmcnt(6)
    s_barrier
    s_mov_b32 s43, s76
    s_mov_b32 m0, s43
    s_add_u32 s43, s43, 1024
    buffer_load_dwordx4 v200, s[8:11], s52 offen lds
    s_mov_b32 m0, s43
    s_add_u32 s43, s43, 1024
    buffer_load_dwordx4 v201, s[8:11], s52 offen lds
    s_mov_b32 m0, s43
    s_add_u32 s43, s43, 1024
    buffer_load_dwordx4 v202, s[8:11], s52 offen lds
    s_mov_b32 m0, s43
    s_add_u32 s43, s43, 1024
    buffer_load_dwordx4 v203, s[8:11], s52 offen lds
    s_mov_b32 m0, s43
    s_add_u32 s43, s43, 1024
    buffer_load_dwordx4 v204, s[8:11], s52 offen lds
    s_mov_b32 m0, s43
    s_add_u32 s43, s43, 1024
    buffer_load_dwordx4 v205, s[8:11], s52 offen lds
    s_add_u32 s52, s52, 196608
    s_waitcnt vmcnt(6)
    s_barrier
    s_mov_b32 s43, s77
    s_mov_b32 m0, s43
    s_add_u32 s43, s43, 1024
    buffer_load_dwordx4 v200, s[8:11], s52 offen lds
    s_mov_b32 m0, s43
    s_add_u32 s43, s43, 1024
    buffer_load_dwordx4 v201, s[8:11], s52 offen lds
    s_mov_b32 m0, s43
    s_add_u32 s43, s43, 1024
    buffer_load_dwordx4 v202, s[8:11], s52 offen lds
    s_mov_b32 m0, s43
    s_add_u32 s43, s43, 1024
    buffer_load_dwordx4 v203, s[8:11], s52 offen lds
    s_mov_b32 m0, s43
    s_add_u32 s43, s43, 1024
    buffer_load_dwordx4 v204, s[8:11], s52 offen lds
    s_mov_b32 m0, s43
    s_add_u32 s43, s43, 1024
    buffer_load_dwordx4 v205, s[8:11], s52 offen lds
    s_add_u32 s52, s52, 196608
    s_waitcnt vmcnt(6)
    s_barrier
    s_mov_b32 s43, s78
    s_mov_b32 m0, s43
    s_add_u32 s43, s43, 1024
    buffer_load_dwordx4 v200, s[8:11], s52 offen lds
    s_mov_b32 m0, s43
    s_add_u32 s43, s43, 1024
    buffer_load_dwordx4 v201, s[8:11], s52 offen lds
    s_mov_b32 m0, s43
    s_add_u32 s43, s43, 1024
    buffer_load_dwordx4 v202, s[8:11], s52 offen lds
    s_mov_b32 m0, s43
    s_add_u32 s43, s43, 1024
    buffer_load_dwordx4 v203, s[8:11], s52 offen lds
    s_mov_b32 m0, s43
    s_add_u32 s43, s43, 1024
    buffer_load_dwordx4 v204, s[8:11], s52 offen lds
    s_mov_b32 m0, s43
    s_add_u32 s43, s43, 1024
    buffer_load_dwordx4 v205, s[8:11], s52 offen lds
    s_add_u32 s52, s52, 196608
    s_waitcnt vmcnt(6)
    s_barrier
    s_mov_b32 s43, s76
    s_mov_b32 m0, s43
    s_add_u32 s43, s43, 1024
    buffer_load_dwordx4 v200, s[8:11], s52 offen lds
    s_mov_b32 m0, s43
    s_add_u32 s43, s43, 1024
    buffer_load_dwordx4 v201, s[8:11], s52 offen lds
    s_mov_b32 m0, s43
    s_add_u32 s43, s43, 1024
    buffer_load_dwordx4 v202, s[8:11], s52 offen lds
    s_mov_b32 m0, s43
    s_add_u32 s43, s43, 1024
    buffer_load_dwordx4 v203, s[8:11], s52 offen lds
    s_mov_b32 m0, s43
    s_add_u32 s43, s43, 1024
    buffer_load_dwordx4 v204, s[8:11], s52 offen lds
    s_mov_b32 m0, s43
    s_add_u32 s43, s43, 1024
    buffer_load_dwordx4 v205, s[8:11], s52 offen lds
    s_add_u32 s52, s52, 196608
    s_waitcnt vmcnt(6)
    s_barrier
    s_mov_b32 s43, s77
    s_mov_b32 m0, s43
    s_add_u32 s43, s43, 1024
    buffer_load_dwordx4 v200, s[8:11], s52 offen lds
    s_mov_b32 m0, s43
    s_add_u32 s43, s43, 1024
    buffer_load_dwordx4 v201, s[8:11], s52 offen lds
    s_mov_b32 m0, s43
    s_add_u32 s43, s43, 1024
    buffer_load_dwordx4 v202, s[8:11], s52 offen lds
    s_mov_b32 m0, s43
    s_add_u32 s43, s43, 1024
    buffer_load_dwordx4 v203, s[8:11], s52 offen lds
    s_mov_b32 m0, s43
    s_add_u32 s43, s43, 1024
    buffer_load_dwordx4 v204, s[8:11], s52 offen lds
    s_mov_b32 m0, s43
    s_add_u32 s43, s43, 1024
    buffer_load_dwordx4 v205, s[8:11], s52 offen lds
    s_add_u32 s52, s52, 196608
    s_waitcnt vmcnt(6)
    s_barrier
    s_mov_b32 s43, s78
    s_mov_b32 m0, s43
    s_add_u32 s43, s43, 1024
    buffer_load_dwordx4 v200, s[8:11], s52 offen lds
    s_mov_b32 m0, s43
    s_add_u32 s43, s43, 1024
    buffer_load_dwordx4 v201, s[8:11], s52 offen lds
    s_mov_b32 m0, s43
    s_add_u32 s43, s43, 1024
    buffer_load_dwordx4 v202, s[8:11], s52 offen lds
    s_mov_b32 m0, s43
    s_add_u32 s43, s43, 1024
    buffer_load_dwordx4 v203, s[8:11], s52 offen lds
    s_mov_b32 m0, s43
    s_add_u32 s43, s43, 1024
    buffer_load_dwordx4 v204, s[8:11], s52 offen lds
    s_mov_b32 m0, s43
    s_add_u32 s43, s43, 1024
    buffer_load_dwordx4 v205, s[8:11], s52 offen lds
    s_add_u32 s52, s52, 196608
    s_waitcnt vmcnt(6)
    s_barrier
    s_mov_b32 s43, s76
    s_mov_b32 m0, s43
    s_add_u32 s43, s43, 1024
    buffer_load_dwordx4 v200, s[8:11], s52 offen lds
    s_mov_b32 m0, s43
    s_add_u32 s43, s43, 1024
    buffer_load_dwordx4 v201, s[8:11], s52 offen lds
    s_mov_b32 m0, s43
    s_add_u32 s43, s43, 1024
    buffer_load_dwordx4 v202, s[8:11], s52 offen lds
    s_mov_b32 m0, s43
    s_add_u32 s43, s43, 1024
    buffer_load_dwordx4 v203, s[8:11], s52 offen lds
    s_mov_b32 m0, s43
    s_add_u32 s43, s43, 1024
    buffer_load_dwordx4 v204, s[8:11], s52 offen lds
    s_mov_b32 m0, s43
    s_add_u32 s43, s43, 1024
    buffer_load_dwordx4 v205, s[8:11], s52 offen lds
    s_add_u32 s52, s52, 196608
    s_waitcnt vmcnt(6)
    s_barrier
    s_mov_b32 s43, s77
    s_mov_b32 m0, s43
    s_add_u32 s43, s43, 1024
    buffer_load_dwordx4 v200, s[8:11], s52 offen lds
    s_mov_b32 m0, s43
    s_add_u32 s43, s43, 1024
    buffer_load_dwordx4 v201, s[8:11], s52 offen lds
    s_mov_b32 m0, s43
    s_add_u32 s43, s43, 1024
    buffer_load_dwordx4 v202, s[8:11], s52 offen lds
    s_mov_b32 m0, s43
    s_add_u32 s43, s43, 1024
    buffer_load_dwordx4 v203, s[8:11], s52 offen lds
    s_mov_b32 m0, s43
    s_add_u32 s43, s43, 1024
    buffer_load_dwordx4 v204, s[8:11], s52 offen lds
    s_mov_b32 m0, s43
    s_add_u32 s43, s43, 1024
    buffer_load_dwordx4 v205, s[8:11], s52 offen lds
    s_add_u32 s52, s52, 196608
    s_waitcnt vmcnt(6)
    s_barrier
    s_mov_b32 s43, s78
    s_mov_b32 m0, s43
    s_add_u32 s43, s43, 1024
    buffer_load_dwordx4 v200, s[8:11], s52 offen lds
    s_mov_b32 m0, s43
    s_add_u32 s43, s43, 1024
    buffer_load_dwordx4 v201, s[8:11], s52 offen lds
    s_mov_b32 m0, s43
    s_add_u32 s43, s43, 1024
    buffer_load_dwordx4 v202, s[8:11], s52 offen lds
    s_mov_b32 m0, s43
    s_add_u32 s43, s43, 1024
    buffer_load_dwordx4 v203, s[8:11], s52 offen lds
    s_mov_b32 m0, s43
    s_add_u32 s43, s43, 1024
    buffer_load_dwordx4 v204, s[8:11], s52 offen lds
    s_mov_b32 m0, s43
    s_add_u32 s43, s43, 1024
    buffer_load_dwordx4 v205, s[8:11], s52 offen lds
    s_add_u32 s52, s52, 196608
    s_waitcnt vmcnt(6)
    s_barrier
    s_mov_b32 s43, s76
    s_mov_b32 m0, s43
    s_add_u32 s43, s43, 1024
    buffer_load_dwordx4 v200, s[8:11], s52 offen lds
    s_mov_b32 m0, s43
    s_add_u32 s43, s43, 1024
    buffer_load_dwordx4 v201, s[8:11], s52 offen lds
    s_mov_b32 m0, s43
    s_add_u32 s43, s43, 1024
    buffer_load_dwordx4 v202, s[8:11], s52 offen lds
    s_mov_b32 m0, s43
    s_add_u32 s43, s43, 1024
    buffer_load_dwordx4 v203, s[8:11], s52 offen lds
    s_mov_b32 m0, s43
    s_add_u32 s43, s43, 1024
    buffer_load_dwordx4 v204, s[8:11], s52 offen lds
    s_mov_b32 m0, s43
    s_add_u32 s43, s43, 1024
    buffer_load_dwordx4 v205, s[8:11], s52 offen lds
    s_add_u32 s52, s52, 196608
    s_waitcnt vmcnt(6)
    s_barrier
    s_waitcnt vmcnt(0)
    s_barrier
RECB_norecv:
    s_cmp_lg_u32 s16, 11
    s_cbranch_scc1 RECB_nopb
    s_cmp_lg_u32 s18, 0
    s_cbranch_scc1 RECB_nopb
    s_cmp_lg_u32 s17, 7
    s_cbranch_scc1 RECB_nopb
    v_mov_b32 v8, -1
    v_mov_b32 v3, 0
    s_mov_b32 s34, 0x7fffffff
    s_mov_b32 s35, 0x7fffffff
    s_add_u32 s33, s24, 0
    buffer_store_dword v8, v3, s[12:15], s33 offen sc1
    s_waitcnt vmcnt(0)
    s_memtime s[36:37]
    s_waitcnt lgkmcnt(0)
    buffer_load_dword v5, v3, s[12:15], s33 offen sc1
    s_waitcnt vmcnt(0)
    s_memtime s[38:39]
    s_waitcnt lgkmcnt(0)
    s_sub_u32 s38, s38, s36
    s_min_u32 s34, s34, s38
    s_add_u32 s33, s24, 8192
    buffer_store_dword v8, v3, s[12:15], s33 offen sc1
    s_waitcnt vmcnt(0)
    s_memtime s[36:37]
    s_waitcnt lgkmcnt(0)
    buffer_load_dword v5, v3, s[12:15], s33 offen sc1
    s_waitcnt vmcnt(0)
    s_memtime s[38:39]
    s_waitcnt lgkmcnt(0)
    s_sub_u32 s38, s38, s36
    s_min_u32 s35, s35, s38
    s_add_u32 s33, s24, 82944
    buffer_store_dword v8, v3, s[12:15], s33 offen sc1
    s_waitcnt vmcnt(0)
    s_memtime s[36:37]
    s_waitcnt lgkmcnt(0)
    buffer_load_dword v5, v3, s[12:15], s33 offen sc1
    s_waitcnt vmcnt(0)
    s_memtime s[38:39]
    s_waitcnt lgkmcnt(0)
    s_sub_u32 s38, s38, s36
    s_min_u32 s34, s34, s38
    s_add_u32 s33, s24, 91136
    buffer_store_dword v8, v3, s[12:15], s33 offen sc1
    s_waitcnt vmcnt(0)
    s_memtime s[36:37]
    s_waitcnt lgkmcnt(0)
    buffer_load_dword v5, v3, s[12:15], s33 offen sc1
    s_waitcnt vmcnt(0)
    s_memtime s[38:39]
    s_waitcnt lgkmcnt(0)
    s_sub_u32 s38, s38, s36
    s_min_u32 s35, s35, s38
    s_add_u32 s33, s24, 165888
    buffer_store_dword v8, v3, s[12:15], s33 offen sc1
    s_waitcnt vmcnt(0)
    s_memtime s[36:37]
    s_waitcnt lgkmcnt(0)
    buffer_load_dword v5, v3, s[12:15], s33 offen sc1
    s_waitcnt vmcnt(0)
    s_memtime s[38:39]
    s_waitcnt lgkmcnt(0)
    s_sub_u32 s38, s38, s36
    s_min_u32 s34, s34, s38
    s_add_u32 s33, s24, 174080
    buffer_store_dword v8, v3, s[12:15], s33 offen sc1
    s_waitcnt vmcnt(0)
    s_memtime s[36:37]
    s_waitcnt lgkmcnt(0)
    buffer_load_dword v5, v3, s[12:15], s33 offen sc1
    s_waitcnt vmcnt(0)
    s_memtime s[38:39]
    s_waitcnt lgkmcnt(0)
    s_sub_u32 s38, s38, s36
    s_min_u32 s35, s35, s38
    s_add_u32 s33, s24, 248832
    buffer_store_dword v8, v3, s[12:15], s33 offen sc1
    s_waitcnt vmcnt(0)
    s_memtime s[36:37]
    s_waitcnt lgkmcnt(0)
    buffer_load_dword v5, v3, s[12:15], s33 offen sc1
    s_waitcnt vmcnt(0)
    s_memtime s[38:39]
    s_waitcnt lgkmcnt(0)
    s_sub_u32 s38, s38, s36
    s_min_u32 s34, s34, s38
    s_add_u32 s33, s24, 257024
    buffer_store_dword v8, v3, s[12:15], s33 offen sc1
    s_waitcnt vmcnt(0)
    s_memtime s[36:37]
    s_waitcnt lgkmcnt(0)
    buffer_load_dword v5, v3, s[12:15], s33 offen sc1
    s_waitcnt vmcnt(0)
    s_memtime s[38:39]
    s_waitcnt lgkmcnt(0)
    s_sub_u32 s38, s38, s36
    s_min_u32 s35, s35, s38
    s_add_u32 s33, s24, 331776
    buffer_store_dword v8, v3, s[12:15], s33 offen sc1
    s_waitcnt vmcnt(0)
    s_memtime s[36:37]
    s_waitcnt lgkmcnt(0)
    buffer_load_dword v5, v3, s[12:15], s33 offen sc1
    s_waitcnt vmcnt(0)
    s_memtime s[38:39]
    s_waitcnt lgkmcnt(0)
    s_sub_u32 s38, s38, s36
    s_min_u32 s34, s34, s38
    s_add_u32 s33, s24, 339968
    buffer_store_dword v8, v3, s[12:15], s33 offen sc1
    s_waitcnt vmcnt(0)
    s_memtime s[36:37]
    s_waitcnt lgkmcnt(0)
    buffer_load_dword v5, v3, s[12:15], s33 offen sc1
    s_waitcnt vmcnt(0)
    s_memtime s[38:39]
    s_waitcnt lgkmcnt(0)
    s_sub_u32 s38, s38, s36
    s_min_u32 s35, s35, s38
    s_add_u32 s33, s24, 414720
    buffer_store_dword v8, v3, s[12:15], s33 offen sc1
    s_waitcnt vmcnt(0)
    s_memtime s[36:37]
    s_waitcnt lgkmcnt(0)
    buffer_load_dword v5, v3, s[12:15], s33 offen sc1
    s_waitcnt vmcnt(0)
    s_memtime s[38:39]
    s_waitcnt lgkmcnt(0)
    s_sub_u32 s38, s38, s36
    s_min_u32 s34, s34, s38
    s_add_u32 s33, s24, 422912
    buffer_store_dword v8, v3, s[12:15], s33 offen sc1
    s_waitcnt vmcnt(0)
    s_memtime s[36:37]
    s_waitcnt lgkmcnt(0)
    buffer_load_dword v5, v3, s[12:15], s33 offen sc1
    s_waitcnt vmcnt(0)
    s_memtime s[38:39]
    s_waitcnt lgkmcnt(0)
    s_sub_u32 s38, s38, s36
    s_min_u32 s35, s35, s38
    s_add_u32 s33, s24, 497664
    buffer_store_dword v8, v3, s[12:15], s33 offen sc1
    s_waitcnt vmcnt(0)
    s_memtime s[36:37]
    s_waitcnt lgkmcnt(0)
    buffer_load_dword v5, v3, s[12:15], s33 offen sc1
    s_waitcnt vmcnt(0)
    s_memtime s[38:39]
    s_waitcnt lgkmcnt(0)
    s_sub_u32 s38, s38, s36
    s_min_u32 s34, s34, s38
    s_add_u32 s33, s24, 505856
    buffer_store_dword v8, v3, s[12:15], s33 offen sc1
    s_waitcnt vmcnt(0)
    s_memtime s[36:37]
    s_waitcnt lgkmcnt(0)
    buffer_load_dword v5, v3, s[12:15], s33 offen sc1
    s_waitcnt vmcnt(0)
    s_memtime s[38:39]
    s_waitcnt lgkmcnt(0)
    s_sub_u32 s38, s38, s36
    s_min_u32 s35, s35, s38
    s_getreg_b32 s36, hwreg(HW_REG_XCC_ID)
    s_lshr_b32 s36, s36, 2
    s_and_b32 s36, s36, 1
    s_cmp_lt_u32 s35, s34
    s_cselect_b32 s37, 1, 0
    s_xor_b32 s37, s37, s36
    s_lshl_b32 s37, s37, 13
    s_add_u32 s37, s37, 1
    v_mov_b32 v4, s37
    v_mov_b32 v3, 12
    buffer_store_dword v4, v3, s[68:71], 0 offen sc1
RECB_nopb:
    s_waitcnt lgkmcnt(0)
    s_load_dwordx2 s[8:9], s[0:1], 16
    s_load_dwordx2 s[60:61], s[0:1], 24
    s_mov_b32 s10, 7864320
    s_mov_b32 s11, 0x00020000
    s_mov_b32 s62, 7864320
    s_mov_b32 s63, 0x00020000
    v_lshrrev_b32 v200, 3, v255
    v_bfe_u32 v201, v200, 1, 2
    v_lshlrev_b32 v201, 1, v201
    v_xor_b32 v201, v201, v252
    v_mul_u32_u24 v200, 12288, v200
    v_lshl_add_u32 v200, v201, 4, v200
    s_mul_i32 s54, s25, 384
    s_lshl_b32 s40, s22, 7
    s_add_u32 s54, s54, s40
    s_mul_i32 s40, s23, 196608
    s_add_u32 s54, s54, s40
    s_lshl_b32 s57, s23, 11
    s_waitcnt lgkmcnt(0)
    s_barrier
    s_add_u32 s52, s54, 0
    s_add_u32 s43, s57, 0
    s_mov_b32 m0, s43
    s_add_u32 s43, s43, 1024
    buffer_load_dwordx4 v200, s[8:11], s52 offen lds
    s_add_u32 s52, s52, 98304
    s_mov_b32 m0, s43
    s_add_u32 s43, s43, 1024
    buffer_load_dwordx4 v200, s[8:11], s52 offen lds
    s_add_u32 s52, s52, 98304
    s_add_u32 s52, s54, 786432
    s_add_u32 s43, s57, 8192
    s_mov_b32 m0, s43
    s_add_u32 s43, s43, 1024
    buffer_load_dwordx4 v200, s[8:11], s52 offen lds
    s_add_u32 s52, s52, 98304
    s_mov_b32 m0, s43
    s_add_u32 s43, s43, 1024
    buffer_load_dwordx4 v200, s[8:11], s52 offen lds
    s_add_u32 s52, s52, 98304
    s_add_u32 s52, s54, 1572864
    s_add_u32 s43, s57, 16384
    s_mov_b32 m0, s43
    s_add_u32 s43, s43, 1024
    buffer_load_dwordx4 v200, s[8:11], s52 offen lds
    s_add_u32 s52, s52, 98304
    s_mov_b32 m0, s43
    s_add_u32 s43, s43, 1024
    buffer_load_dwordx4 v200, s[8:11], s52 offen lds
    s_add_u32 s52, s52, 98304
    s_waitcnt vmcnt(4)
    s_barrier
    s_add_u32 s52, s54, 2359296
    s_add_u32 s43, s57, 24576
    s_mov_b32 m0, s43
    s_add_u32 s43, s43, 1024
    buffer_load_dwordx4 v200, s[8:11], s52 offen lds
    s_add_u32 s52, s52, 98304
    s_mov_b32 m0, s43
    s_add_u32 s43, s43, 1024
    buffer_load_dwordx4 v200, s[8:11], s52 offen lds
    s_add_u32 s52, s52, 98304
    s_waitcnt vmcnt(4)
    s_barrier
    s_add_u32 s52, s54, 3145728
    s_add_u32 s43, s57, 0
    s_mov_b32 m0, s43
    s_add_u32 s43, s43, 1024
    buffer_load_dwordx4 v200, s[8:11], s52 offen lds
    s_add_u32 s52, s52, 98304
    s_mov_b32 m0, s43
    s_add_u32 s43, s43, 1024
    buffer_load_dwordx4 v200, s[8:11], s52 offen lds
    s_add_u32 s52, s52, 98304
    s_waitcnt vmcnt(4)
    s_barrier
    s_add_u32 s52, s54, 3932160
    s_add_u32 s43, s57, 8192
    s_mov_b32 m0, s43
    s_add_u32 s43, s43, 1024
    buffer_load_dwordx4 v200, s[8:11], s52 offen lds
    s_add_u32 s52, s52, 98304
    s_mov_b32 m0, s43
    s_add_u32 s43, s43, 1024
    buffer_load_dwordx4 v200, s[8:11], s52 offen lds
    s_add_u32 s52, s52, 98304
    s_waitcnt vmcnt(4)
    s_barrier
    s_add_u32 s52, s54, 4718592
    s_add_u32 s43, s57, 16384
    s_mov_b32 m0, s43
    s_add_u32 s43, s43, 1024
    buffer_load_dwordx4 v200, s[8:11], s52 offen lds
    s_add_u32 s52, s52, 98304
    s_mov_b32 m0, s43
    s_add_u32 s43, s43, 1024
    buffer_load_dwordx4 v200, s[8:11], s52 offen lds
    s_add_u32 s52, s52, 98304
    s_waitcnt vmcnt(4)
    s_barrier
    s_add_u32 s52, s54, 5505024
    s_add_u32 s43, s57, 24576
    s_mov_b32 m0, s43
    s_add_u32 s43, s43, 1024
    buffer_load_dwordx4 v200, s[8:11], s52 offen lds
    s_add_u32 s52, s52, 98304
    s_mov_b32 m0, s43
    s_add_u32 s43, s43, 1024
    buffer_load_dwordx4 v200, s[8:11], s52 offen lds
    s_add_u32 s52, s52, 98304
    s_waitcnt vmcnt(4)
    s_barrier
    s_add_u32 s52, s54, 6291456
    s_add_u32 s43, s57, 0
    s_mov_b32 m0, s43
    s_add_u32 s43, s43, 1024
    buffer_load_dwordx4 v200, s[8:11], s52 offen lds
    s_add_u32 s52, s52, 98304
    s_mov_b32 m0, s43
    s_add_u32 s43, s43, 1024
    buffer_load_dwordx4 v200, s[8:11], s52 offen lds
    s_add_u32 s52, s52, 98304
    s_waitcnt vmcnt(4)
    s_barrier
    s_add_u32 s52, s54, 7077888
    s_add_u32 s43, s57, 8192
    s_mov_b32 m0, s43
    s_add_u32 s43, s43, 1024
    buffer_load_dwordx4 v200, s[8:11], s52 offen lds
    s_add_u32 s52, s52, 98304
    s_mov_b32 m0, s43
    s_add_u32 s43, s43, 1024
    buffer_load_dwordx4 v200, s[8:11], s52 offen lds
    s_add_u32 s52, s52, 98304
    s_waitcnt vmcnt(4)
    s_barrier
    s_add_u32 s52, s54, 0
    s_add_u32 s43, s57, 16384
    s_mov_b32 m0, s43
    s_add_u32 s43, s43, 1024
    buffer_load_dwordx4 v200, s[60:63], s52 offen lds
    s_add_u32 s52, s52, 98304
    s_mov_b32 m0, s43
    s_add_u32 s43, s43, 1024
    buffer_load_dwordx4 v200, s[60:63], s52 offen lds
    s_add_u32 s52, s52, 98304
    s_waitcnt vmcnt(4)
    s_barrier
    s_add_u32 s52, s54, 786432
    s_add_u32 s43, s57, 24576
    s_mov_b32 m0, s43
    s_add_u32 s43, s43, 1024
    buffer_load_dwordx4 v200, s[60:63], s52 offen lds
    s_add_u32 s52, s52, 98304
    s_mov_b32 m0, s43
    s_add_u32 s43, s43, 1024
    buffer_load_dwordx4 v200, s[60:63], s52 offen lds
    s_add_u32 s52, s52, 98304
    s_waitcnt vmcnt(4)
    s_barrier
    s_add_u32 s52, s54, 1572864
    s_add_u32 s43, s57, 0
    s_mov_b32 m0, s43
    s_add_u32 s43, s43, 1024
    buffer_load_dwordx4 v200, s[60:63], s52 offen lds
    s_add_u32 s52, s52, 98304
    s_mov_b32 m0, s43
    s_add_u32 s43, s43, 1024
    buffer_load_dwordx4 v200, s[60:63], s52 offen lds
    s_add_u32 s52, s52, 98304
    s_waitcnt vmcnt(4)
    s_barrier
    s_add_u32 s52, s54, 2359296
    s_add_u32 s43, s57, 8192
    s_mov_b32 m0, s43
    s_add_u32 s43, s43, 1024
    buffer_load_dwordx4 v200, s[60:63], s52 offen lds
    s_add_u32 s52, s52, 98304
    s_mov_b32 m0, s43
    s_add_u32 s43, s43, 1024
    buffer_load_dwordx4 v200, s[60:63], s52 offen lds
    s_add_u32 s52, s52, 98304
    s_waitcnt vmcnt(4)
    s_barrier
    s_add_u32 s52, s54, 3145728
    s_add_u32 s43, s57, 16384
    s_mov_b32 m0, s43
    s_add_u32 s43, s43, 1024
    buffer_load_dwordx4 v200, s[60:63], s52 offen lds
    s_add_u32 s52, s52, 98304
    s_mov_b32 m0, s43
    s_add_u32 s43, s43, 1024
    buffer_load_dwordx4 v200, s[60:63], s52 offen lds
    s_add_u32 s52, s52, 98304
    s_waitcnt vmcnt(4)
    s_barrier
    s_add_u32 s52, s54, 3932160
    s_add_u32 s43, s57, 24576
    s_mov_b32 m0, s43
    s_add_u32 s43, s43, 1024
    buffer_load_dwordx4 v200, s[60:63], s52 offen lds
    s_add_u32 s52, s52, 98304
    s_mov_b32 m0, s43
    s_add_u32 s43, s43, 1024
    buffer_load_dwordx4 v200, s[60:63], s52 offen lds
    s_add_u32 s52, s52, 98304
    s_waitcnt vmcnt(4)
    s_barrier
    s_add_u32 s52, s54, 4718592
    s_add_u32 s43, s57, 0
    s_mov_b32 m0, s43
    s_add_u32 s43, s43, 1024
    buffer_load_dwordx4 v200, s[60:63], s52 offen lds
    s_add_u32 s52, s52, 98304
    s_mov_b32 m0, s43
    s_add_u32 s43, s43, 1024
    buffer_load_dwordx4 v200, s[60:63], s52 offen lds
    s_add_u32 s52, s52, 98304
    s_waitcnt vmcnt(4)
    s_barrier
    s_add_u32 s52, s54, 5505024
    s_add_u32 s43, s57, 8192
    s_mov_b32 m0, s43
    s_add_u32 s43, s43, 1024
    buffer_load_dwordx4 v200, s[60:63], s52 offen lds
    s_add_u32 s52, s52, 98304
    s_mov_b32 m0, s43
    s_add_u32 s43, s43, 1024
    buffer_load_dwordx4 v200, s[60:63], s52 offen lds
    s_add_u32 s52, s52, 98304
    s_waitcnt vmcnt(4)
    s_barrier
    s_add_u32 s52, s54, 6291456
    s_add_u32 s43, s57, 16384
    s_mov_b32 m0, s43
    s_add_u32 s43, s43, 1024
    buffer_load_dwordx4 v200, s[60:63], s52 offen lds
    s_add_u32 s52, s52, 98304
    s_mov_b32 m0, s43
    s_add_u32 s43, s43, 1024
    buffer_load_dwordx4 v200, s[60:63], s52 offen lds
    s_add_u32 s52, s52, 98304
    s_waitcnt vmcnt(4)
    s_barrier
    s_add_u32 s52, s54, 7077888
    s_add_u32 s43, s57, 24576
    s_mov_b32 m0, s43
    s_add_u32 s43, s43, 1024
    buffer_load_dwordx4 v200, s[60:63], s52 offen lds
    s_add_u32 s52, s52, 98304
    s_mov_b32 m0, s43
    s_add_u32 s43, s43, 1024
    buffer_load_dwordx4 v200, s[60:63], s52 offen lds
    s_add_u32 s52, s52, 98304
    s_waitcnt vmcnt(4)
    s_barrier
    s_waitcnt vmcnt(2)
    s_barrier
    s_waitcnt vmcnt(0)
    s_barrier
    v_lshlrev_b32 v244, 9, v251
    v_lshl_add_u32 v244, v250, 4, v244
    s_lshl_b32 s40, s23, 2
    s_add_u32 s40, s40, 22528
    v_add_u32 v244, s40, v244
    v_lshlrev_b32 v245, 8, v251
    v_lshl_add_u32 v245, v250, 3, v245
    s_lshl_b32 s40, s23, 10
    s_add_u32 s40, s40, 26624
    v_add_u32 v245, s40, v245
    s_mov_b32 s79, s40
    v_add_u32 v248, s58, v249
    s_mul_i32 s40, s21, 2048
    s_lshl_b32 s61, s22, 3
    s_cmp_eq_u32 s22, 2
    s_cselect_b32 s61, 1024, s61
    s_cselect_b32 s62, 3, 4
    s_add_u32 s61, s61, s40
    s_lshl_b32 s63, s22, 2
    s_add_u32 s63, s63, s40
    s_add_u32 s63, s63, 1536
    s_lshl_b32 s52, s55, 9
    s_mul_i32 s54, s19, 10240
    s_lshl_b32 s42, s20, 10
    s_add_u32 s54, s54, s42
    s_lshr_b32 s42, s54, 13
    s_lshl_b32 s42, s42, 13
    s_add_u32 s54, s54, s42
    v_lshrrev_b32 v192, 3, v255
    v_mul_u32_u24 v246, 10240, v192
    s_lshl_b32 s40, s55, 9
    s_lshl_b32 s41, s23, 7
    s_add_u32 s41, s41, s40
    v_add_u32 v246, s41, v246
    v_lshl_add_u32 v246, v252, 4, v246
    v_lshrrev_b32 v193, 13, v246
    v_lshlrev_b32 v193, 13, v193
    v_add_u32 v246, v246, v193
    v_lshrrev_b32 v192, 2, v252
    s_lshl_b32 s41, s23, 1
    v_add_u32 v192, s41, v192
    v_and_b32 v193, 3, v192
    v_lshlrev_b32 v247, 7, v193
    v_lshrrev_b32 v193, 2, v192
    v_lshl_add_u32 v247, v193, 3, v247
    v_and_b32 v193, 3, v255
    v_lshl_add_u32 v247, v193, 5, v247
    v_lshrrev_b32 v193, 5, v255
    v_lshl_add_u32 v247, v193, 4, v247
    v_bfe_u32 v193, v255, 4, 1
    v_lshl_add_u32 v247, v193, 2, v247
    v_add_u32 v247, s40, v247
    v_cmp_eq_u32 vcc, 0, v253
    s_nop 1
    v_cndmask_b32 v247, v242, v247, vcc
    v_mov_b32 v252, v243
    v_add_u32 v251, s79, v249
    v_and_b32 v250, 31, v255
    v_lshlrev_b32 v250, 2, v250
    s_lshl_b32 s40, s18, 7
    s_add_u32 s59, s40, 3609600
    s_add_u32 s40, s40, 3610624
    v_add_u32 v250, s40, v250
    s_mul_i32 s60, s18, 24
    s_add_u32 s60, s60, s16
    s_lshl_b32 s60, s60, 6
    s_add_u32 s60, s60, 3612672
    s_mul_i32 s38, s26, 10240
    s_add_u32 s38, s38, 202473472
    s_lshl_b32 s40, s20, 10
    s_add_u32 s38, s38, s40
    s_mul_i32 s37, s25, 3072
    s_add_u32 s37, s37, 196083712
    s_lshl_b32 s40, s22, 10
    s_add_u32 s37, s37, s40
    v_and_b32 v225, 7, v255
    v_lshlrev_b32 v225, 5, v225
    s_mov_b32 s73, 3000000
CEN_45:
    buffer_load_dword v224, v225, s[68:71], 0 offen sc1
    s_mov_b32 s39, 1
    s_sub_u32 s73, s73, 1
    s_cbranch_scc1 CEN_45_ok
    s_waitcnt vmcnt(0)
    v_cmp_ne_u32 vcc, 32, v224
    s_cbranch_vccz CEN_45_ok
    s_mov_b32 s72, 0
    v_readlane_b32 s75, v224, 0
    s_add_u32 s72, s72, s75
    s_cmp_lt_u32 s75, 32
    s_cselect_b32 s39, 0, s39
    v_readlane_b32 s75, v224, 1
    s_add_u32 s72, s72, s75
    s_cmp_lt_u32 s75, 32
    s_cselect_b32 s39, 0, s39
    v_readlane_b32 s75, v224, 2
    s_add_u32 s72, s72, s75
    s_cmp_lt_u32 s75, 32
    s_cselect_b32 s39, 0, s39
    v_readlane_b32 s75, v224, 3
    s_add_u32 s72, s72, s75
    s_cmp_lt_u32 s75, 32
    s_cselect_b32 s39, 0, s39
    v_readlane_b32 s75, v224, 4
    s_add_u32 s72, s72, s75
    v_readlane_b32 s75, v224, 5
    s_add_u32 s72, s72, s75
    v_readlane_b32 s75, v224, 6
    s_add_u32 s72, s72, s75
    v_readlane_b32 s75, v224, 7
    s_add_u32 s72, s72, s75
    s_cmp_ge_u32 s72, 256
    s_cbranch_scc1 CEN_45_ok
    s_sleep 4
    s_branch CEN_45
CEN_45_ok:
    s_waitcnt vmcnt(0)
    v_mov_b32 v228, 0
    s_mov_b32 s73, 3000000
    s_mov_b32 s93, 0
WINI_46:
    buffer_load_dwordx4 v[224:227], v228, s[68:71], 0 offen sc1
    s_sub_u32 s73, s73, 1
    s_cbranch_scc1 WINI_46_ok
    s_waitcnt vmcnt(0)
    v_readfirstlane_b32 s72, v225
    s_cmp_lt_u32 s72, 64
    s_cbranch_scc1 WINI_46_sl
    v_readfirstlane_b32 s93, v227
    s_cmp_lg_u32 s93, 0
    s_cbranch_scc1 WINI_46_ok
WINI_46_sl:
    s_sleep 24
    s_branch WINI_46
WINI_46_ok:
    s_waitcnt vmcnt(0)
    s_and_b32 s93, s93, 8192
    s_mov_b32 s41, s93
    s_and_b32 s41, s41, 8192
    s_add_u32 s24, s24, s41
    s_mov_b32 s57, 1
RECB_rlp_47:
    buffer_load_dword v224, v250, s[12:15], s93 offen sc1
    s_sub_u32 s46, s46, 1
    s_cbranch_scc1 RECB_rok_48_x
    s_waitcnt vmcnt(0)
    v_cmp_gt_u32 vcc, s57, v224
    s_cbranch_vccz RECB_rok_48
    s_sleep 2
    s_branch RECB_rlp_47
RECB_rok_48_x:
    s_mov_b32 s46, 0
RECB_rok_48:
    s_barrier
    s_waitcnt lgkmcnt(0)
    s_setprio 1
RECB_loopS:
    s_and_b32 s40, s27, 3
    s_add_u32 s41, s27, 2
    s_and_b32 s41, s41, 3
    s_mul_i32 s28, s40, 65536
    s_add_u32 s28, s28, s47
    s_mul_i32 s29, s41, 65536
    s_add_u32 s29, s29, s47
    s_mul_i32 s30, s40, 163840
    s_add_u32 s30, s30, s24
    s_mul_i32 s31, s41, 163840
    s_add_u32 s31, s31, s24
    s_mul_i32 s32, s40, 40960
    s_add_u32 s32, s32, s48
    s_add_u32 s41, s27, 1
    s_and_b32 s41, s41, 3
    s_mul_i32 s33, s41, 40960
    s_add_u32 s33, s33, s48
    s_add_u32 s41, s27, 3
    s_and_b32 s41, s41, 3
    s_mul_i32 s34, s41, 40960
    s_add_u32 s34, s34, s48
    s_barrier
    ds_read_b128 v[224:227], v251
    ds_read_b128 v[228:231], v249 offset:30720
    s_waitcnt lgkmcnt(0)
    s_cmp_ge_u32 s20, 10
    s_cbranch_scc1 RECB_fl_49_a
    buffer_store_dwordx4 v[224:227], v249, s[12:15], s38 offen sc1
RECB_fl_49_a:
    s_cmp_lg_u32 s17, 4
    s_cbranch_scc1 RECB_fl_49_b
    buffer_store_dwordx4 v[228:231], v249, s[12:15], s37 offen sc1
RECB_fl_49_b:
    s_add_u32 s38, s38, 327680
    s_add_u32 s37, s37, 98304
    s_cmp_lg_u32 s17, 7
    s_cbranch_scc1 RECB_nopr
    s_cmp_lt_u32 s27, 2
    s_cbranch_scc1 RECB_nopr
    s_sub_u32 s40, s27, 1
    v_mov_b32 v232, s40
    v_mov_b32 v233, s60
    buffer_store_dword v232, v233, s[12:15], s93 offen sc1
RECB_nopr:
    s_cmp_lg_u32 s17, 6
    s_cbranch_scc1 RECB_nopois
    v_mov_b32 v236, -1
    v_mov_b32 v237, -1
    v_mov_b32 v238, -1
    v_mov_b32 v239, -1
    v_lshlrev_b32 v232, s62, v255
    v_and_b32 v233, 0x1ff, v249
    s_add_u32 s40, s29, s61
    s_add_u32 s41, s29, s63
    buffer_store_dwordx2 v[236:237], v232, s[12:15], s40 offen sc1
    buffer_store_dword v236, v233, s[12:15], s41 offen sc1
    s_cmp_ge_u32 s20, 10
    s_cbranch_scc1 RECB_nopois
    s_add_u32 s40, s31, s54
    s_add_u32 s41, s34, s52
    buffer_store_dwordx4 v[236:239], v249, s[12:15], s40 offen sc1
    buffer_store_dwordx4 v[236:239], v233, s[12:15], s41 offen sc1
RECB_nopois:
    s_cmp_lg_u32 s17, 5
    s_cbranch_scc1 RECB_noprog
    s_cmp_lg_u32 s16, 11
    s_cbranch_scc1 RECB_noprog
    s_add_u32 s40, s27, 1
    v_mov_b32 v232, s40
    v_mov_b32 v233, s59
    buffer_store_dword v232, v233, s[12:15], s93 offen sc1
RECB_noprog:
    s_cmp_lt_u32 s20, 10
    s_cbranch_scc1 RECB_yjob
    s_barrier
    s_branch RECB_endS
RECB_yjob:
    ds_read_b128 v[192:195], v252 offset:0
    ds_read_b128 v[196:199], v252 offset:6144
    ds_read_b128 v[208:211], v248 offset:0
    ds_read_b128 v[212:215], v248 offset:1024
    ds_read_b128 v[216:219], v248 offset:2048
    ds_read_b128 v[220:223], v248 offset:3072
    ds_read_b128 v[200:203], v252 offset:512
    ds_read_b128 v[204:207], v252 offset:6656
    s_waitcnt lgkmcnt(7)
    v_mfma_f32_16x16x32_bf16 v[224:227], v[192:195], v[0:3], 0
    s_waitcnt lgkmcnt(6)
    s_waitcnt lgkmcnt(5)
    v_mfma_f32_16x16x32_bf16 v[224:227], v[196:199], v[208:211], v[224:227]
    ds_read_b128 v[208:211], v248 offset:4096
    v_mfma_f32_16x16x32_bf16 v[228:231], v[192:195], v[4:7], 0
    s_waitcnt lgkmcnt(5)
    v_mfma_f32_16x16x32_bf16 v[228:231], v[196:199], v[212:215], v[228:231]
    ds_read_b128 v[212:215], v248 offset:5120
    v_mfma_f32_16x16x32_bf16 v[232:235], v[192:195], v[8:11], 0
    s_waitcnt lgkmcnt(5)
    v_mfma_f32_16x16x32_bf16 v[232:235], v[196:199], v[216:219], v[232:235]
    ds_read_b128 v[216:219], v248 offset:6144
    v_mfma_f32_16x16x32_bf16 v[236:239], v[192:195], v[12:15], 0
    s_waitcnt lgkmcnt(5)
    v_mfma_f32_16x16x32_bf16 v[236:239], v[196:199], v[220:223], v[236:239]
    ds_read_b128 v[220:223], v248 offset:7168
    ds_read_b128 v[192:195], v252 offset:1024
    ds_read_b128 v[196:199], v252 offset:7168
    s_waitcnt lgkmcnt(7)
    v_mfma_f32_16x16x32_bf16 v[224:227], v[200:203], v[16:19], v[224:227]
    s_waitcnt lgkmcnt(6)
    s_waitcnt lgkmcnt(5)
    v_mfma_f32_16x16x32_bf16 v[224:227], v[204:207], v[208:211], v[224:227]
    ds_read_b128 v[208:211], v248 offset:8192
    v_mfma_f32_16x16x32_bf16 v[228:231], v[200:203], v[20:23], v[228:231]
    s_waitcnt lgkmcnt(5)
    v_mfma_f32_16x16x32_bf16 v[228:231], v[204:207], v[212:215], v[228:231]
    ds_read_b128 v[212:215], v248 offset:9216
    v_mfma_f32_16x16x32_bf16 v[232:235], v[200:203], v[24:27], v[232:235]
    s_waitcnt lgkmcnt(5)
    v_mfma_f32_16x16x32_bf16 v[232:235], v[204:207], v[216:219], v[232:235]
    ds_read_b128 v[216:219], v248 offset:10240
    v_mfma_f32_16x16x32_bf16 v[236:239], v[200:203], v[28:31], v[236:239]
    s_waitcnt lgkmcnt(5)
    v_mfma_f32_16x16x32_bf16 v[236:239], v[204:207], v[220:223], v[236:239]
    ds_read_b128 v[220:223], v248 offset:11264
    s_barrier
    ds_read_b128 v[200:203], v252 offset:1536
    ds_read_b128 v[204:207], v252 offset:7680
    s_waitcnt lgkmcnt(7)
    v_mfma_f32_16x16x32_bf16 v[224:227], v[192:195], v[32:35], v[224:227]
    s_waitcnt lgkmcnt(6)
    s_waitcnt lgkmcnt(5)
    v_mfma_f32_16x16x32_bf16 v[224:227], v[196:199], v[208:211], v[224:227]
    ds_read_b128 v[208:211], v248 offset:12288
    v_mfma_f32_16x16x32_bf16 v[228:231], v[192:195], v[36:39], v[228:231]
    s_waitcnt lgkmcnt(5)
    v_mfma_f32_16x16x32_bf16 v[228:231], v[196:199], v[212:215], v[228:231]
    ds_read_b128 v[212:215], v248 offset:13312
    v_mfma_f32_16x16x32_bf16 v[232:235], v[192:195], v[40:43], v[232:235]
    s_waitcnt lgkmcnt(5)
    v_mfma_f32_16x16x32_bf16 v[232:235], v[196:199], v[216:219], v[232:235]
    ds_read_b128 v[216:219], v248 offset:14336
    v_mfma_f32_16x16x32_bf16 v[236:239], v[192:195], v[44:47], v[236:239]
    s_waitcnt lgkmcnt(5)
    v_mfma_f32_16x16x32_bf16 v[236:239], v[196:199], v[220:223], v[236:239]
    ds_read_b128 v[220:223], v248 offset:15360
    ds_read_b128 v[192:195], v252 offset:2048
    ds_read_b128 v[196:199], v252 offset:8192
    s_waitcnt lgkmcnt(7)
    v_mfma_f32_16x16x32_bf16 v[224:227], v[200:203], v[48:51], v[224:227]
    s_waitcnt lgkmcnt(6)
    s_waitcnt lgkmcnt(5)
    v_mfma_f32_16x16x32_bf16 v[224:227], v[204:207], v[208:211], v[224:227]
    ds_read_b128 v[208:211], v248 offset:16384
    v_mfma_f32_16x16x32_bf16 v[228:231], v[200:203], v[52:55], v[228:231]
    s_waitcnt lgkmcnt(5)
    v_mfma_f32_16x16x32_bf16 v[228:231], v[204:207], v[212:215], v[228:231]
    ds_read_b128 v[212:215], v248 offset:17408
    v_mfma_f32_16x16x32_bf16 v[232:235], v[200:203], v[56:59], v[232:235]
    s_waitcnt lgkmcnt(5)
    v_mfma_f32_16x16x32_bf16 v[232:235], v[204:207], v[216:219], v[232:235]
    ds_read_b128 v[216:219], v248 offset:18432
    v_mfma_f32_16x16x32_bf16 v[236:239], v[200:203], v[60:63], v[236:239]
    s_waitcnt lgkmcnt(5)
    v_mfma_f32_16x16x32_bf16 v[236:239], v[204:207], v[220:223], v[236:239]
    ds_read_b128 v[220:223], v248 offset:19456
    ds_read_b128 v[200:203], v252 offset:2560
    ds_read_b128 v[204:207], v252 offset:8704
    s_waitcnt lgkmcnt(7)
    v_mfma_f32_16x16x32_bf16 v[224:227], v[192:195], v[64:67], v[224:227]
    s_waitcnt lgkmcnt(6)
    s_waitcnt lgkmcnt(5)
    v_mfma_f32_16x16x32_bf16 v[224:227], v[196:199], v[208:211], v[224:227]
    ds_read_b128 v[208:211], v248 offset:20480
    v_mfma_f32_16x16x32_bf16 v[228:231], v[192:195], v[68:71], v[228:231]
    s_waitcnt lgkmcnt(5)
    v_mfma_f32_16x16x32_bf16 v[228:231], v[196:199], v[212:215], v[228:231]
    ds_read_b128 v[212:215], v248 offset:21504
    v_mfma_f32_16x16x32_bf16 v[232:235], v[192:195], v[72:75], v[232:235]
    s_waitcnt lgkmcnt(5)
    v_mfma_f32_16x16x32_bf16 v[232:235], v[196:199], v[216:219], v[232:235]
    ds_read_b128 v[216:219], v248 offset:22528
    v_mfma_f32_16x16x32_bf16 v[236:239], v[192:195], v[76:79], v[236:239]
    s_waitcnt lgkmcnt(5)
    v_mfma_f32_16x16x32_bf16 v[236:239], v[196:199], v[220:223], v[236:239]
    ds_read_b128 v[220:223], v248 offset:23552
    ds_read_b128 v[192:195], v252 offset:3072
    ds_read_b128 v[196:199], v252 offset:9216
    s_waitcnt lgkmcnt(7)
    v_mfma_f32_16x16x32_bf16 v[224:227], v[200:203], v[80:83], v[224:227]
    s_waitcnt lgkmcnt(6)
    s_waitcnt lgkmcnt(5)
    v_mfma_f32_16x16x32_bf16 v[224:227], v[204:207], v[208:211], v[224:227]
    ds_read_b128 v[208:211], v248 offset:24576
    v_mfma_f32_16x16x32_bf16 v[228:231], v[200:203], v[84:87], v[228:231]
    s_waitcnt lgkmcnt(5)
    v_mfma_f32_16x16x32_bf16 v[228:231], v[204:207], v[212:215], v[228:231]
    ds_read_b128 v[212:215], v248 offset:25600
    v_mfma_f32_16x16x32_bf16 v[232:235], v[200:203], v[88:91], v[232:235]
    s_waitcnt lgkmcnt(5)
    v_mfma_f32_16x16x32_bf16 v[232:235], v[204:207], v[216:219], v[232:235]
    ds_read_b128 v[216:219], v248 offset:26624
    v_mfma_f32_16x16x32_bf16 v[236:239], v[200:203], v[92:95], v[236:239]
    s_waitcnt lgkmcnt(5)
    v_mfma_f32_16x16x32_bf16 v[236:239], v[204:207], v[220:223], v[236:239]
    ds_read_b128 v[220:223], v248 offset:27648
    ds_read_b128 v[200:203], v252 offset:3584
    ds_read_b128 v[204:207], v252 offset:9728
    s_waitcnt lgkmcnt(7)
    v_mfma_f32_16x16x32_bf16 v[224:227], v[192:195], v[96:99], v[224:227]
    s_waitcnt lgkmcnt(6)
    s_waitcnt lgkmcnt(5)
    v_mfma_f32_16x16x32_bf16 v[224:227], v[196:199], v[208:211], v[224:227]
    ds_read_b128 v[208:211], v248 offset:28672
    v_mfma_f32_16x16x32_bf16 v[228:231], v[192:195], v[100:103], v[228:231]
    s_waitcnt lgkmcnt(5)
    v_mfma_f32_16x16x32_bf16 v[228:231], v[196:199], v[212:215], v[228:231]
    ds_read_b128 v[212:215], v248 offset:29696
    v_mfma_f32_16x16x32_bf16 v[232:235], v[192:195], v[104:107], v[232:235]
    s_waitcnt lgkmcnt(5)
    v_mfma_f32_16x16x32_bf16 v[232:235], v[196:199], v[216:219], v[232:235]
    ds_read_b128 v[216:219], v248 offset:30720
    v_mfma_f32_16x16x32_bf16 v[236:239], v[192:195], v[108:111], v[236:239]
    s_waitcnt lgkmcnt(5)
    v_mfma_f32_16x16x32_bf16 v[236:239], v[196:199], v[220:223], v[236:239]
    ds_read_b128 v[220:223], v248 offset:31744
    ds_read_b128 v[192:195], v252 offset:4096
    ds_read_b128 v[196:199], v252 offset:4608
    s_waitcnt lgkmcnt(7)
    v_mfma_f32_16x16x32_bf16 v[224:227], v[200:203], v[112:115], v[224:227]
    s_waitcnt lgkmcnt(6)
    s_waitcnt lgkmcnt(5)
    v_mfma_f32_16x16x32_bf16 v[224:227], v[204:207], v[208:211], v[224:227]
    v_mfma_f32_16x16x32_bf16 v[228:231], v[200:203], v[116:119], v[228:231]
    s_waitcnt lgkmcnt(4)
    v_mfma_f32_16x16x32_bf16 v[228:231], v[204:207], v[212:215], v[228:231]
    v_mfma_f32_16x16x32_bf16 v[232:235], v[200:203], v[120:123], v[232:235]
    s_waitcnt lgkmcnt(3)
    v_mfma_f32_16x16x32_bf16 v[232:235], v[204:207], v[216:219], v[232:235]
    v_mfma_f32_16x16x32_bf16 v[236:239], v[200:203], v[124:127], v[236:239]
    s_waitcnt lgkmcnt(2)
    v_mfma_f32_16x16x32_bf16 v[236:239], v[204:207], v[220:223], v[236:239]
    ds_read_b128 v[200:203], v252 offset:5120
    ds_read_b128 v[204:207], v252 offset:5632
    s_waitcnt lgkmcnt(3)
    v_mfma_f32_16x16x32_bf16 v[224:227], v[192:195], v[128:131], v[224:227]
    s_waitcnt lgkmcnt(2)
    v_mfma_f32_16x16x32_bf16 v[224:227], v[196:199], v[144:147], v[224:227]
    s_waitcnt lgkmcnt(1)
    v_mfma_f32_16x16x32_bf16 v[224:227], v[200:203], v[160:163], v[224:227]
    s_waitcnt lgkmcnt(0)
    v_mfma_f32_16x16x32_bf16 v[224:227], v[204:207], v[176:179], v[224:227]
    v_mfma_f32_16x16x32_bf16 v[228:231], v[192:195], v[132:135], v[228:231]
    v_mfma_f32_16x16x32_bf16 v[228:231], v[196:199], v[148:151], v[228:231]
    v_mfma_f32_16x16x32_bf16 v[228:231], v[200:203], v[164:167], v[228:231]
    v_mfma_f32_16x16x32_bf16 v[228:231], v[204:207], v[180:183], v[228:231]
    s_nop 3
    v_cvt_pk_bf16_f32 v208, v224, v225
    v_cvt_pk_bf16_f32 v209, v226, v227
    s_mov_b32 exec_hi, 0
    ds_write_b32 v244, v208 offset:0
    ds_write_b32 v244, v209 offset:256
    s_mov_b32 exec_hi, -1
    v_mfma_f32_16x16x32_bf16 v[232:235], v[192:195], v[136:139], v[232:235]
    v_mfma_f32_16x16x32_bf16 v[232:235], v[196:199], v[152:155], v[232:235]
    v_mfma_f32_16x16x32_bf16 v[232:235], v[200:203], v[168:171], v[232:235]
    v_mfma_f32_16x16x32_bf16 v[232:235], v[204:207], v[184:187], v[232:235]
    s_nop 3
    v_cvt_pk_bf16_f32 v210, v228, v229
    v_cvt_pk_bf16_f32 v211, v230, v231
    s_mov_b32 exec_hi, 0
    ds_write_b32 v244, v210 offset:1024
    ds_write_b32 v244, v211 offset:1280
    s_mov_b32 exec_hi, -1
    v_mfma_f32_16x16x32_bf16 v[236:239], v[192:195], v[140:143], v[236:239]
    v_mfma_f32_16x16x32_bf16 v[236:239], v[196:199], v[156:159], v[236:239]
    v_mfma_f32_16x16x32_bf16 v[236:239], v[200:203], v[172:175], v[236:239]
    v_mfma_f32_16x16x32_bf16 v[236:239], v[204:207], v[188:191], v[236:239]
    s_nop 3
    v_cvt_pk_bf16_f32 v212, v232, v233
    v_cvt_pk_bf16_f32 v213, v234, v235
    s_mov_b32 exec_hi, 0
    ds_write_b32 v244, v212 offset:2048
    ds_write_b32 v244, v213 offset:2304
    s_mov_b32 exec_hi, -1
    s_nop 1
    v_cvt_pk_bf16_f32 v214, v236, v237
    v_cvt_pk_bf16_f32 v215, v238, v239
    s_mov_b32 exec_hi, 0
    ds_write_b32 v244, v214 offset:3072
    ds_write_b32 v244, v215 offset:3328
    s_mov_b32 exec_hi, -1
    s_mov_b32 exec_hi, 0
    s_waitcnt lgkmcnt(0)
    s_barrier
    ds_write_b64 v245, v[208:209] offset:0
    ds_write_b64 v245, v[210:211] offset:128
    ds_write_b64 v245, v[212:213] offset:512
    ds_write_b64 v245, v[214:215] offset:640
    s_mov_b32 exec_hi, -1
    s_waitcnt lgkmcnt(0)
    s_cmp_eq_u32 s27, 63
    s_cbranch_scc1 RECB_endS
    s_sleep 11
RECB_poll_50:
    buffer_load_dwordx4 v[224:227], v246, s[12:15], s30 offen sc1
    s_sub_u32 s46, s46, 1
    s_cbranch_scc1 RECB_pdone_51_x
    s_waitcnt vmcnt(0)
    v_max3_u32 v228, v224, v225, v226
    v_max_u32 v228, v228, v227
    v_cmp_eq_u32 vcc, -1, v228
    s_cbranch_vccnz RECB_poll_50
    s_branch RECB_pdone_51
RECB_pdone_51_x:
    s_mov_b32 s46, 0
    s_waitcnt vmcnt(0)
RECB_pdone_51:
    v_lshlrev_b32 v228, 16, v224
    v_and_b32 v229, 0xffff0000, v224
    v_lshlrev_b32 v232, 16, v226
    v_and_b32 v233, 0xffff0000, v226
    v_lshlrev_b32 v230, 16, v225
    v_and_b32 v231, 0xffff0000, v225
    v_lshlrev_b32 v234, 16, v227
    v_and_b32 v235, 0xffff0000, v227
    v_permlane32_swap_b32 v228, v232
    v_permlane32_swap_b32 v229, v233
    v_permlane32_swap_b32 v230, v234
    v_permlane32_swap_b32 v231, v235
    v_pk_add_f32 v[228:229], v[228:229], v[232:233]
    v_pk_add_f32 v[230:231], v[230:231], v[234:235]
    s_nop 1
    v_permlane16_swap_b32 v228, v230
    v_permlane16_swap_b32 v229, v231
    v_pk_add_f32 v[228:229], v[228:229], v[230:231]
    s_nop 1
    v_add_f32_dpp v228, v228, v228 row_ror:8 row_mask:0xf bank_mask:0xf
    v_add_f32_dpp v229, v229, v229 row_ror:8 row_mask:0xf bank_mask:0xf
    v_cvt_pk_bf16_f32 v224, v228, v229
    v_min_u32 v224, s49, v224
    buffer_store_dword v224, v247, s[12:15], s33 offen sc1
RECB_endS:
    s_add_u32 s57, s27, 2
    s_min_u32 s57, s57, 64
RECB_rlp_52:
    buffer_load_dword v224, v250, s[12:15], s93 offen sc1
    s_sub_u32 s46, s46, 1
    s_cbranch_scc1 RECB_rok_53_x
    s_waitcnt vmcnt(0)
    v_cmp_gt_u32 vcc, s57, v224
    s_cbranch_vccz RECB_rok_53
    s_sleep 2
    s_branch RECB_rlp_52
RECB_rok_53_x:
    s_mov_b32 s46, 0
RECB_rok_53:
    s_add_u32 s27, s27, 1
    s_cmp_lt_u32 s27, 64
    s_cbranch_scc1 RECB_loopS
    s_barrier
    ds_read_b128 v[224:227], v251
    ds_read_b128 v[228:231], v249 offset:30720
    s_waitcnt lgkmcnt(0)
    s_cmp_ge_u32 s20, 10
    s_cbranch_scc1 RECB_fl_54_a
    buffer_store_dwordx4 v[224:227], v249, s[12:15], s38 offen sc1
RECB_fl_54_a:
    s_cmp_lg_u32 s17, 4
    s_cbranch_scc1 RECB_fl_54_b
    buffer_store_dwordx4 v[228:231], v249, s[12:15], s37 offen sc1
RECB_fl_54_b:
    s_add_u32 s38, s38, 327680
    s_add_u32 s37, s37, 98304
    s_cmp_lg_u32 s17, 5
    s_cbranch_scc1 RECB_nofp
    s_cmp_lg_u32 s16, 11
    s_cbranch_scc1 RECB_nofp
    s_mov_b32 s40, 66
    v_mov_b32 v232, s40
    v_mov_b32 v233, s59
    buffer_store_dword v232, v233, s[12:15], s93 offen sc1
RECB_nofp:
    s_waitcnt vmcnt(0)
    s_barrier
    s_cmp_lg_u32 s17, 7
    s_cbranch_scc1 RECB_done
    v_mov_b32 v232, s27
    v_mov_b32 v233, s60
    buffer_store_dword v232, v233, s[12:15], s93 offen sc1
RECB_done:
    s_setprio 0
    s_branch MAIN_post
MAIN_wpost:
    v_mov_b32 v12, 0
    s_mov_b32 s73, 3000000
    s_mov_b32 s93, 0
WINI_55:
    buffer_load_dwordx4 v[8:11], v12, s[68:71], 0 offen sc1
    s_sub_u32 s73, s73, 1
    s_cbranch_scc1 WINI_55_ok
    s_waitcnt vmcnt(0)
    v_readfirstlane_b32 s72, v10
    s_cmp_lt_u32 s72, 64
    s_cbranch_scc1 WINI_55_sl
    v_readfirstlane_b32 s93, v11
    s_cmp_lg_u32 s93, 0
    s_cbranch_scc1 WINI_55_ok
WINI_55_sl:
    s_sleep 8
    s_branch WINI_55
WINI_55_ok:
    s_waitcnt vmcnt(0)
    s_and_b32 s93, s93, 8192
    s_branch MAIN_post
MAIN_gemm:
    s_cmp_ge_u32 s16, 124
    s_cbranch_scc1 MAIN_wpost
    s_cmp_ge_u32 s74, 64
    s_cbranch_scc1 MAIN_go
MAIN_late:
    s_mov_b32 s46, 2000000
    s_and_b32 s40, s16, 15
    s_lshl_b32 s40, s40, 6
    s_add_u32 s40, s40, 3640320
    v_mov_b32 v1, s40
    s_cmp_lg_u32 s17, 0
    s_cbranch_scc1 MAIN_late2
    v_mov_b32 v12, 0
    s_mov_b32 s73, 3000000
    s_mov_b32 s93, 0
WINI_56:
    buffer_load_dwordx4 v[8:11], v12, s[68:71], 0 offen sc1
    s_sub_u32 s73, s73, 1
    s_cbranch_scc1 WINI_56_ok
    s_waitcnt vmcnt(0)
    v_readfirstlane_b32 s72, v10
    s_cmp_lt_u32 s72, 64
    s_cbranch_scc1 WINI_56_sl
    v_readfirstlane_b32 s93, v11
    s_cmp_lg_u32 s93, 0
    s_cbranch_scc1 WINI_56_ok
WINI_56_sl:
    s_sleep 8
    s_branch WINI_56
WINI_56_ok:
    s_waitcnt vmcnt(0)
    s_and_b32 s93, s93, 8192
MAIN_latep:
    buffer_load_dword v2, v1, s[12:15], s93 offen sc1
    s_sub_u32 s46, s46, 1
    s_cbranch_scc1 MAIN_late2
    s_waitcnt vmcnt(0)
    v_cmp_eq_u32 vcc, 0, v2
    s_cbranch_vccz MAIN_late2
    s_sleep 32
    s_branch MAIN_latep
MAIN_late2:
    s_waitcnt vmcnt(0)
    s_barrier
MAIN_go:
    s_cmp_ge_u32 s16, 84
    s_cbranch_scc1 MAIN_small
    s_load_dwordx2 s[4:5], s[0:1], 112
    s_load_dwordx2 s[24:25], s[0:1], 72
    s_cmp_ge_u32 s16, 72
    s_cbranch_scc1 BIG_rw1
    s_mul_i32 s26, s16, 2731
    s_lshr_b32 s26, s26, 16
    s_mul_i32 s27, s26, 24
    s_sub_u32 s27, s16, s27
    s_lshl_b32 s28, s26, 3
    s_add_u32 s28, s28, 16
    s_load_dwordx2 s[6:7], s[0:1], s28
    s_mov_b32 s18, 12288
    s_mov_b32 s10, 7864320
    s_mov_b32 s20, 4194304
    s_mul_i32 s21, s26, 25165824
    s_add_u32 s21, s21, 9437184
    s_mov_b32 s22, 393216
    s_mul_i32 s45, s26, 192
    s_branch BIG_rdone
BIG_rw1:
    s_sub_u32 s27, s16, 72
    s_load_dwordx2 s[6:7], s[0:1], 64
    s_mov_b32 s18, 3072
    s_mov_b32 s10, 1966080
    s_mov_b32 s20, 6815744
    s_mov_b32 s21, 84934656
    s_mov_b32 s22, 98304
    s_mov_b32 s45, 576
BIG_rdone:
    s_cmp_ge_u32 s16, 72
    s_cselect_b32 s30, 8, 9
    s_cselect_b32 s29, 2, 3
    s_lshl_b32 s19, s27, s30
    s_lshl_b32 s28, s27, s29
    s_add_u32 s28, s28, s17
    s_lshl_b32 s29, s28, 11
    s_add_u32 s21, s21, s29
    s_lshl_b32 s45, s16, 6
    s_add_u32 s45, s45, 3637248
    s_waitcnt lgkmcnt(0)
    s_mov_b32 s8, s6
    s_mov_b32 s9, s7
    s_mov_b32 s11, 0x00020000
    s_mov_b32 s12, s4
    s_mov_b32 s13, s5
    s_mov_b32 s14, 268435456
    s_mov_b32 s15, 0x00020000
    v_lshrrev_b32 v232, 5, v255
    s_lshl_b32 s30, s17, 1
    v_add_u32 v232, s30, v232
    v_and_b32 v233, 3, v232
    v_lshlrev_b32 v233, 2, v233
    v_and_b32 v234, 31, v255
    v_xor_b32 v234, v234, v233
    v_lshlrev_b32 v234, 4, v234
    v_mul_lo_u32 v232, v232, s18
    v_add_u32 v232, v232, v234
    v_lshrrev_b32 v233, 5, v255
    v_lshlrev_b32 v233, 3, v233
    v_bfe_u32 v234, v255, 2, 2
    v_add_u32 v233, v233, v234
    v_lshlrev_b32 v233, 9, v233
    v_xor_b32 v234, s17, v234
    v_lshl_add_u32 v233, v234, 6, v233
    v_bfe_u32 v234, v255, 4, 1
    v_lshl_add_u32 v233, v234, 5, v233
    v_and_b32 v234, 3, v255
    v_lshl_add_u32 v233, v234, 3, v233
    s_lshl_b32 s31, s18, 4
    s_mul_i32 s32, s18, 80
    s_mul_i32 s33, s32, 0
    s_add_u32 s33, s33, s19
    s_lshl_b32 s34, s17, 10
    s_add_u32 s34, s34, 0
    s_mov_b32 m0, s34
    s_nop 0
    buffer_load_dwordx4 v232, s[8:11], s33 offen lds
    s_add_u32 s33, s33, s31
    s_lshl_b32 s34, s17, 10
    s_add_u32 s34, s34, 8192
    s_mov_b32 m0, s34
    s_nop 0
    buffer_load_dwordx4 v232, s[8:11], s33 offen lds
    s_add_u32 s33, s33, s31
    s_lshl_b32 s34, s17, 10
    s_add_u32 s34, s34, 16384
    s_mov_b32 m0, s34
    s_nop 0
    buffer_load_dwordx4 v232, s[8:11], s33 offen lds
    s_add_u32 s33, s33, s31
    s_lshl_b32 s34, s17, 10
    s_add_u32 s34, s34, 24576
    s_mov_b32 m0, s34
    s_nop 0
    buffer_load_dwordx4 v232, s[8:11], s33 offen lds
    s_add_u32 s33, s33, s31
    s_lshl_b32 s34, s17, 10
    s_add_u32 s34, s34, 32768
    s_mov_b32 m0, s34
    s_nop 0
    buffer_load_dwordx4 v232, s[8:11], s33 offen lds
    s_mul_i32 s33, s32, 1
    s_add_u32 s33, s33, s19
    s_lshl_b32 s34, s17, 10
    s_add_u32 s34, s34, 40960
    s_mov_b32 m0, s34
    s_nop 0
    buffer_load_dwordx4 v232, s[8:11], s33 offen lds
    s_add_u32 s33, s33, s31
    s_lshl_b32 s34, s17, 10
    s_add_u32 s34, s34, 49152
    s_mov_b32 m0, s34
    s_nop 0
    buffer_load_dwordx4 v232, s[8:11], s33 offen lds
    s_add_u32 s33, s33, s31
    s_lshl_b32 s34, s17, 10
    s_add_u32 s34, s34, 57344
    s_mov_b32 m0, s34
    s_nop 0
    buffer_load_dwordx4 v232, s[8:11], s33 offen lds
    s_add_u32 s33, s33, s31
    s_lshl_b32 s34, s17, 10
    s_add_u32 s34, s34, 65536
    s_mov_b32 m0, s34
    s_nop 0
    buffer_load_dwordx4 v232, s[8:11], s33 offen lds
    s_add_u32 s33, s33, s31
    s_lshl_b32 s34, s17, 10
    s_add_u32 s34, s34, 73728
    s_mov_b32 m0, s34
    s_nop 0
    buffer_load_dwordx4 v232, s[8:11], s33 offen lds
    s_mul_i32 s33, s32, 2
    s_add_u32 s33, s33, s19
    s_lshl_b32 s34, s17, 10
    s_add_u32 s34, s34, 81920
    s_mov_b32 m0, s34
    s_nop 0
    buffer_load_dwordx4 v232, s[8:11], s33 offen lds
    s_add_u32 s33, s33, s31
    s_lshl_b32 s34, s17, 10
    s_add_u32 s34, s34, 90112
    s_mov_b32 m0, s34
    s_nop 0
    buffer_load_dwordx4 v232, s[8:11], s33 offen lds
    s_add_u32 s33, s33, s31
    s_lshl_b32 s34, s17, 10
    s_add_u32 s34, s34, 98304
    s_mov_b32 m0, s34
    s_nop 0
    buffer_load_dwordx4 v232, s[8:11], s33 offen lds
    s_add_u32 s33, s33, s31
    s_lshl_b32 s34, s17, 10
    s_add_u32 s34, s34, 106496
    s_mov_b32 m0, s34
    s_nop 0
    buffer_load_dwordx4 v232, s[8:11], s33 offen lds
    s_add_u32 s33, s33, s31
    s_lshl_b32 s34, s17, 10
    s_add_u32 s34, s34, 114688
    s_mov_b32 m0, s34
    s_nop 0
    buffer_load_dwordx4 v232, s[8:11], s33 offen lds
    s_mul_i32 s33, s32, 3
    s_add_u32 s33, s33, s19
    s_lshl_b32 s34, s17, 10
    s_add_u32 s34, s34, 122880
    s_mov_b32 m0, s34
    s_nop 0
    buffer_load_dwordx4 v232, s[8:11], s33 offen lds
    s_add_u32 s33, s33, s31
    s_lshl_b32 s34, s17, 10
    s_add_u32 s34, s34, 131072
    s_mov_b32 m0, s34
    s_nop 0
    buffer_load_dwordx4 v232, s[8:11], s33 offen lds
    s_add_u32 s33, s33, s31
    s_lshl_b32 s34, s17, 10
    s_add_u32 s34, s34, 139264
    s_mov_b32 m0, s34
    s_nop 0
    buffer_load_dwordx4 v232, s[8:11], s33 offen lds
    s_add_u32 s33, s33, s31
    s_lshl_b32 s34, s17, 10
    s_add_u32 s34, s34, 147456
    s_mov_b32 m0, s34
    s_nop 0
    buffer_load_dwordx4 v232, s[8:11], s33 offen lds
    s_add_u32 s33, s33, s31
    s_lshl_b32 s34, s17, 10
    s_add_u32 s34, s34, 155648
    s_mov_b32 m0, s34
    s_nop 0
    buffer_load_dwordx4 v232, s[8:11], s33 offen lds
    s_waitcnt vmcnt(15)
    s_barrier
    v_add_u32 v234, 0, v233
    ds_read_b64_tr_b16 v[0:1], v234 offset:0
    ds_read_b64_tr_b16 v[2:3], v234 offset:2048
    ds_read_b64_tr_b16 v[4:5], v234 offset:8192
    ds_read_b64_tr_b16 v[6:7], v234 offset:10240
    ds_read_b64_tr_b16 v[8:9], v234 offset:16384
    ds_read_b64_tr_b16 v[10:11], v234 offset:18432
    ds_read_b64_tr_b16 v[12:13], v234 offset:24576
    ds_read_b64_tr_b16 v[14:15], v234 offset:26624
    ds_read_b64_tr_b16 v[16:17], v234 offset:32768
    ds_read_b64_tr_b16 v[18:19], v234 offset:34816
    s_waitcnt lgkmcnt(0)
    s_barrier
    s_mul_i32 s33, s32, 4
    s_add_u32 s33, s33, s19
    s_lshl_b32 s34, s17, 10
    s_add_u32 s34, s34, 0
    s_mov_b32 m0, s34
    s_nop 0
    buffer_load_dwordx4 v232, s[8:11], s33 offen lds
    s_add_u32 s33, s33, s31
    s_lshl_b32 s34, s17, 10
    s_add_u32 s34, s34, 8192
    s_mov_b32 m0, s34
    s_nop 0
    buffer_load_dwordx4 v232, s[8:11], s33 offen lds
    s_add_u32 s33, s33, s31
    s_lshl_b32 s34, s17, 10
    s_add_u32 s34, s34, 16384
    s_mov_b32 m0, s34
    s_nop 0
    buffer_load_dwordx4 v232, s[8:11], s33 offen lds
    s_add_u32 s33, s33, s31
    s_lshl_b32 s34, s17, 10
    s_add_u32 s34, s34, 24576
    s_mov_b32 m0, s34
    s_nop 0
    buffer_load_dwordx4 v232, s[8:11], s33 offen lds
    s_add_u32 s33, s33, s31
    s_lshl_b32 s34, s17, 10
    s_add_u32 s34, s34, 32768
    s_mov_b32 m0, s34
    s_nop 0
    buffer_load_dwordx4 v232, s[8:11], s33 offen lds
    s_waitcnt vmcnt(15)
    s_barrier
    v_add_u32 v234, 40960, v233
    ds_read_b64_tr_b16 v[20:21], v234 offset:0
    ds_read_b64_tr_b16 v[22:23], v234 offset:2048
    ds_read_b64_tr_b16 v[24:25], v234 offset:8192
    ds_read_b64_tr_b16 v[26:27], v234 offset:10240
    ds_read_b64_tr_b16 v[28:29], v234 offset:16384
    ds_read_b64_tr_b16 v[30:31], v234 offset:18432
    ds_read_b64_tr_b16 v[32:33], v234 offset:24576
    ds_read_b64_tr_b16 v[34:35], v234 offset:26624
    ds_read_b64_tr_b16 v[36:37], v234 offset:32768
    ds_read_b64_tr_b16 v[38:39], v234 offset:34816
    s_waitcnt lgkmcnt(0)
    s_barrier
    s_mul_i32 s33, s32, 5
    s_add_u32 s33, s33, s19
    s_lshl_b32 s34, s17, 10
    s_add_u32 s34, s34, 40960
    s_mov_b32 m0, s34
    s_nop 0
    buffer_load_dwordx4 v232, s[8:11], s33 offen lds
    s_add_u32 s33, s33, s31
    s_lshl_b32 s34, s17, 10
    s_add_u32 s34, s34, 49152
    s_mov_b32 m0, s34
    s_nop 0
    buffer_load_dwordx4 v232, s[8:11], s33 offen lds
    s_add_u32 s33, s33, s31
    s_lshl_b32 s34, s17, 10
    s_add_u32 s34, s34, 57344
    s_mov_b32 m0, s34
    s_nop 0
    buffer_load_dwordx4 v232, s[8:11], s33 offen lds
    s_add_u32 s33, s33, s31
    s_lshl_b32 s34, s17, 10
    s_add_u32 s34, s34, 65536
    s_mov_b32 m0, s34
    s_nop 0
    buffer_load_dwordx4 v232, s[8:11], s33 offen lds
    s_add_u32 s33, s33, s31
    s_lshl_b32 s34, s17, 10
    s_add_u32 s34, s34, 73728
    s_mov_b32 m0, s34
    s_nop 0
    buffer_load_dwordx4 v232, s[8:11], s33 offen lds
    s_waitcnt vmcnt(15)
    s_barrier
    v_add_u32 v234, 81920, v233
    ds_read_b64_tr_b16 v[40:41], v234 offset:0
    ds_read_b64_tr_b16 v[42:43], v234 offset:2048
    ds_read_b64_tr_b16 v[44:45], v234 offset:8192
    ds_read_b64_tr_b16 v[46:47], v234 offset:10240
    ds_read_b64_tr_b16 v[48:49], v234 offset:16384
    ds_read_b64_tr_b16 v[50:51], v234 offset:18432
    ds_read_b64_tr_b16 v[52:53], v234 offset:24576
    ds_read_b64_tr_b16 v[54:55], v234 offset:26624
    ds_read_b64_tr_b16 v[56:57], v234 offset:32768
    ds_read_b64_tr_b16 v[58:59], v234 offset:34816
    s_waitcnt lgkmcnt(0)
    s_barrier
    s_mul_i32 s33, s32, 6
    s_add_u32 s33, s33, s19
    s_lshl_b32 s34, s17, 10
    s_add_u32 s34, s34, 81920
    s_mov_b32 m0, s34
    s_nop 0
    buffer_load_dwordx4 v232, s[8:11], s33 offen lds
    s_add_u32 s33, s33, s31
    s_lshl_b32 s34, s17, 10
    s_add_u32 s34, s34, 90112
    s_mov_b32 m0, s34
    s_nop 0
    buffer_load_dwordx4 v232, s[8:11], s33 offen lds
    s_add_u32 s33, s33, s31
    s_lshl_b32 s34, s17, 10
    s_add_u32 s34, s34, 98304
    s_mov_b32 m0, s34
    s_nop 0
    buffer_load_dwordx4 v232, s[8:11], s33 offen lds
    s_add_u32 s33, s33, s31
    s_lshl_b32 s34, s17, 10
    s_add_u32 s34, s34, 106496
    s_mov_b32 m0, s34
    s_nop 0
    buffer_load_dwordx4 v232, s[8:11], s33 offen lds
    s_add_u32 s33, s33, s31
    s_lshl_b32 s34, s17, 10
    s_add_u32 s34, s34, 114688
    s_mov_b32 m0, s34
    s_nop 0
    buffer_load_dwordx4 v232, s[8:11], s33 offen lds
    s_waitcnt vmcnt(15)
    s_barrier
    v_add_u32 v234, 122880, v233
    ds_read_b64_tr_b16 v[60:61], v234 offset:0
    ds_read_b64_tr_b16 v[62:63], v234 offset:2048
    ds_read_b64_tr_b16 v[64:65], v234 offset:8192
    ds_read_b64_tr_b16 v[66:67], v234 offset:10240
    ds_read_b64_tr_b16 v[68:69], v234 offset:16384
    ds_read_b64_tr_b16 v[70:71], v234 offset:18432
    ds_read_b64_tr_b16 v[72:73], v234 offset:24576
    ds_read_b64_tr_b16 v[74:75], v234 offset:26624
    ds_read_b64_tr_b16 v[76:77], v234 offset:32768
    ds_read_b64_tr_b16 v[78:79], v234 offset:34816
    s_waitcnt lgkmcnt(0)
    s_barrier
    s_mul_i32 s33, s32, 7
    s_add_u32 s33, s33, s19
    s_lshl_b32 s34, s17, 10
    s_add_u32 s34, s34, 122880
    s_mov_b32 m0, s34
    s_nop 0
    buffer_load_dwordx4 v232, s[8:11], s33 offen lds
    s_add_u32 s33, s33, s31
    s_lshl_b32 s34, s17, 10
    s_add_u32 s34, s34, 131072
    s_mov_b32 m0, s34
    s_nop 0
    buffer_load_dwordx4 v232, s[8:11], s33 offen lds
    s_add_u32 s33, s33, s31
    s_lshl_b32 s34, s17, 10
    s_add_u32 s34, s34, 139264
    s_mov_b32 m0, s34
    s_nop 0
    buffer_load_dwordx4 v232, s[8:11], s33 offen lds
    s_add_u32 s33, s33, s31
    s_lshl_b32 s34, s17, 10
    s_add_u32 s34, s34, 147456
    s_mov_b32 m0, s34
    s_nop 0
    buffer_load_dwordx4 v232, s[8:11], s33 offen lds
    s_add_u32 s33, s33, s31
    s_lshl_b32 s34, s17, 10
    s_add_u32 s34, s34, 155648
    s_mov_b32 m0, s34
    s_nop 0
    buffer_load_dwordx4 v232, s[8:11], s33 offen lds
    s_waitcnt vmcnt(15)
    s_barrier
    v_add_u32 v234, 0, v233
    ds_read_b64_tr_b16 v[80:81], v234 offset:0
    ds_read_b64_tr_b16 v[82:83], v234 offset:2048
    ds_read_b64_tr_b16 v[84:85], v234 offset:8192
    ds_read_b64_tr_b16 v[86:87], v234 offset:10240
    ds_read_b64_tr_b16 v[88:89], v234 offset:16384
    ds_read_b64_tr_b16 v[90:91], v234 offset:18432
    ds_read_b64_tr_b16 v[92:93], v234 offset:24576
    ds_read_b64_tr_b16 v[94:95], v234 offset:26624
    ds_read_b64_tr_b16 v[96:97], v234 offset:32768
    ds_read_b64_tr_b16 v[98:99], v234 offset:34816
    s_waitcnt lgkmcnt(0)
    s_barrier
    s_waitcnt vmcnt(10)
    s_barrier
    v_add_u32 v234, 40960, v233
    ds_read_b64_tr_b16 v[100:101], v234 offset:0
    ds_read_b64_tr_b16 v[102:103], v234 offset:2048
    ds_read_b64_tr_b16 v[104:105], v234 offset:8192
    ds_read_b64_tr_b16 v[106:107], v234 offset:10240
    ds_read_b64_tr_b16 v[108:109], v234 offset:16384
    ds_read_b64_tr_b16 v[110:111], v234 offset:18432
    ds_read_b64_tr_b16 v[112:113], v234 offset:24576
    ds_read_b64_tr_b16 v[114:115], v234 offset:26624
    ds_read_b64_tr_b16 v[116:117], v234 offset:32768
    ds_read_b64_tr_b16 v[118:119], v234 offset:34816
    s_waitcnt lgkmcnt(0)
    s_barrier
    s_waitcnt vmcnt(5)
    s_barrier
    v_add_u32 v234, 81920, v233
    ds_read_b64_tr_b16 v[120:121], v234 offset:0
    ds_read_b64_tr_b16 v[122:123], v234 offset:2048
    ds_read_b64_tr_b16 v[124:125], v234 offset:8192
    ds_read_b64_tr_b16 v[126:127], v234 offset:10240
    ds_read_b64_tr_b16 v[128:129], v234 offset:16384
    ds_read_b64_tr_b16 v[130:131], v234 offset:18432
    ds_read_b64_tr_b16 v[132:133], v234 offset:24576
    ds_read_b64_tr_b16 v[134:135], v234 offset:26624
    ds_read_b64_tr_b16 v[136:137], v234 offset:32768
    ds_read_b64_tr_b16 v[138:139], v234 offset:34816
    s_waitcnt lgkmcnt(0)
    s_barrier
    s_waitcnt vmcnt(0)
    s_barrier
    v_add_u32 v234, 122880, v233
    ds_read_b64_tr_b16 v[140:141], v234 offset:0
    ds_read_b64_tr_b16 v[142:143], v234 offset:2048
    ds_read_b64_tr_b16 v[144:145], v234 offset:8192
    ds_read_b64_tr_b16 v[146:147], v234 offset:10240
    ds_read_b64_tr_b16 v[148:149], v234 offset:16384
    ds_read_b64_tr_b16 v[150:151], v234 offset:18432
    ds_read_b64_tr_b16 v[152:153], v234 offset:24576
    ds_read_b64_tr_b16 v[154:155], v234 offset:26624
    ds_read_b64_tr_b16 v[156:157], v234 offset:32768
    ds_read_b64_tr_b16 v[158:159], v234 offset:34816
    s_waitcnt lgkmcnt(0)
    s_barrier
    v_mov_b32 v246, s45
    v_lshlrev_b32 v242, 4, v255
    s_mul_i32 s30, s17, 5120
    v_add_u32 v240, s30, v242
    s_cmp_lt_u32 s16, 72
    s_cbranch_scc1 BIG_nobias
    s_mov_b32 s36, s24
    s_mov_b32 s37, s25
    s_mov_b32 s38, 3072
    s_mov_b32 s39, 0x00020000
    v_lshrrev_b32 v232, 5, v255
    v_lshlrev_b32 v232, 3, v232
    s_lshl_b32 s30, s28, 6
    v_add_u32 v232, s30, v232
    buffer_load_dwordx2 v[192:193], v232, s[36:39], 0 offen offset:0
    buffer_load_dwordx2 v[194:195], v232, s[36:39], 0 offen offset:16
    buffer_load_dwordx2 v[196:197], v232, s[36:39], 0 offen offset:32
    buffer_load_dwordx2 v[198:199], v232, s[36:39], 0 offen offset:48
    s_waitcnt vmcnt(0)
    v_lshlrev_b32 v216, 16, v192
    v_and_b32 v217, 0xffff0000, v192
    v_lshlrev_b32 v218, 16, v193
    v_and_b32 v219, 0xffff0000, v193
    v_lshlrev_b32 v220, 16, v194
    v_and_b32 v221, 0xffff0000, v194
    v_lshlrev_b32 v222, 16, v195
    v_and_b32 v223, 0xffff0000, v195
    v_lshlrev_b32 v224, 16, v196
    v_and_b32 v225, 0xffff0000, v196
    v_lshlrev_b32 v226, 16, v197
    v_and_b32 v227, 0xffff0000, v197
    v_lshlrev_b32 v228, 16, v198
    v_and_b32 v229, 0xffff0000, v198
    v_lshlrev_b32 v230, 16, v199
    v_and_b32 v231, 0xffff0000, v199
    s_mov_b32 s40, 0xc0135761
    s_mov_b32 s41, 0xbdd2d3e8
BIG_nobias:
    v_mov_b32 v196, 0
    s_mov_b32 s73, 3000000
    s_mov_b32 s93, 0
WINI_57:
    buffer_load_dwordx4 v[192:195], v196, s[68:71], 0 offen sc1
    s_sub_u32 s73, s73, 1
    s_cbranch_scc1 WINI_57_ok
    s_waitcnt vmcnt(0)
    v_readfirstlane_b32 s72, v194
    v_readfirstlane_b32 s75, v193
    s_cmp_ge_u32 s16, 72
    s_cselect_b32 s72, s75, s72
    s_cmp_lt_u32 s72, 64
    s_cbranch_scc1 WINI_57_sl
    v_readfirstlane_b32 s93, v195
    s_cmp_lg_u32 s93, 0
    s_cbranch_scc1 WINI_57_ok
WINI_57_sl:
    s_sleep 8
    s_branch WINI_57
WINI_57_ok:
    s_waitcnt vmcnt(0)
    s_and_b32 s93, s93, 8192
    s_mov_b32 s43, s20
    s_mov_b32 s35, 0
    s_mul_i32 s34, s17, 5120
    s_add_u32 s34, s34, s35
    s_mov_b32 m0, s34
    s_nop 0
    buffer_load_dwordx4 v240, s[12:15], s43 offen offset:0 sc1 lds
    buffer_load_dwordx4 v240, s[12:15], s43 offen offset:1024 sc1 lds
    buffer_load_dwordx4 v240, s[12:15], s43 offen offset:2048 sc1 lds
    buffer_load_dwordx4 v240, s[12:15], s43 offen offset:3072 sc1 lds
    s_add_u32 s34, s34, 4096
    s_mov_b32 m0, s34
    s_add_u32 s33, s43, 4096
    buffer_load_dwordx4 v240, s[12:15], s33 offen sc1 lds
    s_add_u32 s43, s43, 40960
    s_mov_b32 s35, 40960
    s_mul_i32 s34, s17, 5120
    s_add_u32 s34, s34, s35
    s_mov_b32 m0, s34
    s_nop 0
    buffer_load_dwordx4 v240, s[12:15], s43 offen offset:0 sc1 lds
    buffer_load_dwordx4 v240, s[12:15], s43 offen offset:1024 sc1 lds
    buffer_load_dwordx4 v240, s[12:15], s43 offen offset:2048 sc1 lds
    buffer_load_dwordx4 v240, s[12:15], s43 offen offset:3072 sc1 lds
    s_add_u32 s34, s34, 4096
    s_mov_b32 m0, s34
    s_add_u32 s33, s43, 4096
    buffer_load_dwordx4 v240, s[12:15], s33 offen sc1 lds
    s_add_u32 s43, s43, 40960
    s_mov_b32 s35, 81920
    s_mul_i32 s34, s17, 5120
    s_add_u32 s34, s34, s35
    s_mov_b32 m0, s34
    s_nop 0
    buffer_load_dwordx4 v240, s[12:15], s43 offen offset:0 sc1 lds
    buffer_load_dwordx4 v240, s[12:15], s43 offen offset:1024 sc1 lds
    buffer_load_dwordx4 v240, s[12:15], s43 offen offset:2048 sc1 lds
    buffer_load_dwordx4 v240, s[12:15], s43 offen offset:3072 sc1 lds
    s_add_u32 s34, s34, 4096
    s_mov_b32 m0, s34
    s_add_u32 s33, s43, 4096
    buffer_load_dwordx4 v240, s[12:15], s33 offen sc1 lds
    s_add_u32 s43, s43, 40960
    s_mov_b32 s42, 0
    s_sub_u32 s44, s21, s22
    s_waitcnt vmcnt(0)
    s_barrier
    v_mov_b32 v241, v242
    s_cmp_ge_u32 s16, 72
    s_cbranch_scc1 BIG_gelu_path
    ds_read_b128 v[192:195], v241 offset:0
    ds_read_b128 v[196:199], v241 offset:1024
    ds_read_b128 v[200:203], v241 offset:2048
    ds_read_b128 v[204:207], v241 offset:3072
    s_add_u32 s35, s42, 1
    s_and_b32 s35, s35, 3
    s_mul_i32 s35, s35, 40960
    v_add_u32 v248, s35, v242
    s_waitcnt lgkmcnt(3)
    v_mfma_f32_32x32x16_bf16 v[160:175], v[0:3], v[192:195], 0
    ds_read_b128 v[208:211], v241 offset:4096
    s_waitcnt lgkmcnt(3)
    v_mfma_f32_32x32x16_bf16 v[160:175], v[4:7], v[196:199], v[160:175]
    ds_read_b128 v[192:195], v241 offset:5120
    s_waitcnt lgkmcnt(3)
    v_mfma_f32_32x32x16_bf16 v[160:175], v[8:11], v[200:203], v[160:175]
    ds_read_b128 v[196:199], v241 offset:6144
    s_waitcnt lgkmcnt(3)
    v_mfma_f32_32x32x16_bf16 v[160:175], v[12:15], v[204:207], v[160:175]
    ds_read_b128 v[200:203], v241 offset:7168
    s_waitcnt lgkmcnt(3)
    v_mfma_f32_32x32x16_bf16 v[160:175], v[16:19], v[208:211], v[160:175]
    ds_read_b128 v[204:207], v241 offset:8192
    s_waitcnt lgkmcnt(3)
    v_mfma_f32_32x32x16_bf16 v[160:175], v[20:23], v[192:195], v[160:175]
    ds_read_b128 v[208:211], v241 offset:9216
    s_waitcnt lgkmcnt(3)
    v_mfma_f32_32x32x16_bf16 v[160:175], v[24:27], v[196:199], v[160:175]
    ds_read_b128 v[192:195], v241 offset:10240
    s_waitcnt lgkmcnt(3)
    v_mfma_f32_32x32x16_bf16 v[160:175], v[28:31], v[200:203], v[160:175]
    ds_read_b128 v[196:199], v241 offset:11264
    s_waitcnt lgkmcnt(3)
    v_mfma_f32_32x32x16_bf16 v[160:175], v[32:35], v[204:207], v[160:175]
    ds_read_b128 v[200:203], v241 offset:12288
    s_waitcnt lgkmcnt(3)
    v_mfma_f32_32x32x16_bf16 v[160:175], v[36:39], v[208:211], v[160:175]
    ds_read_b128 v[204:207], v241 offset:13312
    s_waitcnt lgkmcnt(3)
    v_mfma_f32_32x32x16_bf16 v[160:175], v[40:43], v[192:195], v[160:175]
    ds_read_b128 v[208:211], v241 offset:14336
    s_waitcnt lgkmcnt(3)
    v_mfma_f32_32x32x16_bf16 v[160:175], v[44:47], v[196:199], v[160:175]
    ds_read_b128 v[192:195], v241 offset:15360
    s_waitcnt lgkmcnt(3)
    v_mfma_f32_32x32x16_bf16 v[160:175], v[48:51], v[200:203], v[160:175]
    ds_read_b128 v[196:199], v241 offset:16384
    s_waitcnt lgkmcnt(3)
    v_mfma_f32_32x32x16_bf16 v[160:175], v[52:55], v[204:207], v[160:175]
    ds_read_b128 v[200:203], v241 offset:17408
    s_waitcnt lgkmcnt(3)
    v_mfma_f32_32x32x16_bf16 v[160:175], v[56:59], v[208:211], v[160:175]
    ds_read_b128 v[204:207], v241 offset:18432
    s_waitcnt lgkmcnt(3)
    v_mfma_f32_32x32x16_bf16 v[160:175], v[60:63], v[192:195], v[160:175]
    ds_read_b128 v[208:211], v241 offset:19456
    s_waitcnt lgkmcnt(3)
    v_mfma_f32_32x32x16_bf16 v[160:175], v[64:67], v[196:199], v[160:175]
    ds_read_b128 v[192:195], v241 offset:20480
    s_waitcnt lgkmcnt(3)
    v_mfma_f32_32x32x16_bf16 v[160:175], v[68:71], v[200:203], v[160:175]
    ds_read_b128 v[196:199], v241 offset:21504
    s_waitcnt lgkmcnt(3)
    v_mfma_f32_32x32x16_bf16 v[160:175], v[72:75], v[204:207], v[160:175]
    ds_read_b128 v[200:203], v241 offset:22528
    s_waitcnt lgkmcnt(3)
    v_mfma_f32_32x32x16_bf16 v[160:175], v[76:79], v[208:211], v[160:175]
    ds_read_b128 v[204:207], v241 offset:23552
    s_waitcnt lgkmcnt(3)
    v_mfma_f32_32x32x16_bf16 v[160:175], v[80:83], v[192:195], v[160:175]
    ds_read_b128 v[208:211], v241 offset:24576
    s_waitcnt lgkmcnt(3)
    v_mfma_f32_32x32x16_bf16 v[160:175], v[84:87], v[196:199], v[160:175]
    ds_read_b128 v[192:195], v241 offset:25600
    s_waitcnt lgkmcnt(3)
    v_mfma_f32_32x32x16_bf16 v[160:175], v[88:91], v[200:203], v[160:175]
    ds_read_b128 v[196:199], v241 offset:26624
    s_waitcnt lgkmcnt(3)
    v_mfma_f32_32x32x16_bf16 v[160:175], v[92:95], v[204:207], v[160:175]
    ds_read_b128 v[200:203], v241 offset:27648
    s_waitcnt lgkmcnt(3)
    v_mfma_f32_32x32x16_bf16 v[160:175], v[96:99], v[208:211], v[160:175]
    ds_read_b128 v[204:207], v241 offset:28672
    s_waitcnt lgkmcnt(3)
    v_mfma_f32_32x32x16_bf16 v[160:175], v[100:103], v[192:195], v[160:175]
    ds_read_b128 v[208:211], v241 offset:29696
    s_waitcnt lgkmcnt(3)
    v_mfma_f32_32x32x16_bf16 v[160:175], v[104:107], v[196:199], v[160:175]
    ds_read_b128 v[192:195], v241 offset:30720
    s_waitcnt vmcnt(0)
    s_barrier
    s_add_u32 s35, s42, 3
    s_cmp_ge_u32 s35, 64
    s_cbranch_scc1 BIG_nopf_58
    s_and_b32 s35, s35, 3
    s_mul_i32 s35, s35, 40960
    s_mul_i32 s34, s17, 5120
    s_add_u32 s34, s34, s35
    s_mov_b32 m0, s34
    s_nop 0
    buffer_load_dwordx4 v240, s[12:15], s43 offen offset:0 sc1 lds
    buffer_load_dwordx4 v240, s[12:15], s43 offen offset:1024 sc1 lds
    buffer_load_dwordx4 v240, s[12:15], s43 offen offset:2048 sc1 lds
    buffer_load_dwordx4 v240, s[12:15], s43 offen offset:3072 sc1 lds
    s_add_u32 s34, s34, 4096
    s_mov_b32 m0, s34
    s_add_u32 s33, s43, 4096
    buffer_load_dwordx4 v240, s[12:15], s33 offen sc1 lds
    s_add_u32 s43, s43, 40960
BIG_nopf_58:
    s_waitcnt lgkmcnt(3)
    v_mfma_f32_32x32x16_bf16 v[160:175], v[108:111], v[200:203], v[160:175]
    ds_read_b128 v[196:199], v241 offset:31744
    s_waitcnt lgkmcnt(3)
    v_mfma_f32_32x32x16_bf16 v[160:175], v[112:115], v[204:207], v[160:175]
    ds_read_b128 v[200:203], v241 offset:32768
    s_waitcnt lgkmcnt(3)
    v_mfma_f32_32x32x16_bf16 v[160:175], v[116:119], v[208:211], v[160:175]
    ds_read_b128 v[204:207], v241 offset:33792
    s_waitcnt lgkmcnt(3)
    v_mfma_f32_32x32x16_bf16 v[160:175], v[120:123], v[192:195], v[160:175]
    ds_read_b128 v[208:211], v241 offset:34816
    s_waitcnt lgkmcnt(3)
    v_mfma_f32_32x32x16_bf16 v[160:175], v[124:127], v[196:199], v[160:175]
    ds_read_b128 v[192:195], v241 offset:35840
    s_waitcnt lgkmcnt(3)
    v_mfma_f32_32x32x16_bf16 v[160:175], v[128:131], v[200:203], v[160:175]
    ds_read_b128 v[196:199], v241 offset:36864
    s_waitcnt lgkmcnt(3)
    v_mfma_f32_32x32x16_bf16 v[160:175], v[132:135], v[204:207], v[160:175]
    ds_read_b128 v[200:203], v241 offset:37888
    s_waitcnt lgkmcnt(3)
    v_mfma_f32_32x32x16_bf16 v[160:175], v[136:139], v[208:211], v[160:175]
    ds_read_b128 v[204:207], v241 offset:38912
    s_waitcnt lgkmcnt(3)
    v_mfma_f32_32x32x16_bf16 v[160:175], v[140:143], v[192:195], v[160:175]
    ds_read_b128 v[208:211], v241 offset:39936
    s_waitcnt lgkmcnt(3)
    v_mfma_f32_32x32x16_bf16 v[160:175], v[144:147], v[196:199], v[160:175]
    ds_read_b128 v[192:195], v248 offset:0
    s_waitcnt lgkmcnt(3)
    v_mfma_f32_32x32x16_bf16 v[160:175], v[148:151], v[200:203], v[160:175]
    ds_read_b128 v[196:199], v248 offset:1024
    s_waitcnt lgkmcnt(3)
    v_mfma_f32_32x32x16_bf16 v[160:175], v[152:155], v[204:207], v[160:175]
    ds_read_b128 v[200:203], v248 offset:2048
    s_waitcnt lgkmcnt(3)
    v_mfma_f32_32x32x16_bf16 v[160:175], v[156:159], v[208:211], v[160:175]
    ds_read_b128 v[204:207], v248 offset:3072
    s_add_u32 s42, s42, 1
    s_add_u32 s44, s44, s22
BIG_loop0:
    s_add_u32 s35, s42, 1
    s_and_b32 s35, s35, 3
    s_mul_i32 s35, s35, 40960
    v_add_u32 v241, s35, v242
    s_waitcnt lgkmcnt(3)
    v_mfma_f32_32x32x16_bf16 v[176:191], v[0:3], v[192:195], 0
    ds_read_b128 v[208:211], v248 offset:4096
    s_waitcnt lgkmcnt(3)
    v_mfma_f32_32x32x16_bf16 v[176:191], v[4:7], v[196:199], v[176:191]
    ds_read_b128 v[192:195], v248 offset:5120
    s_waitcnt lgkmcnt(3)
    v_mfma_f32_32x32x16_bf16 v[176:191], v[8:11], v[200:203], v[176:191]
    ds_read_b128 v[196:199], v248 offset:6144
    s_waitcnt lgkmcnt(3)
    v_mfma_f32_32x32x16_bf16 v[176:191], v[12:15], v[204:207], v[176:191]
    ds_read_b128 v[200:203], v248 offset:7168
    s_waitcnt lgkmcnt(3)
    v_mfma_f32_32x32x16_bf16 v[176:191], v[16:19], v[208:211], v[176:191]
    ds_read_b128 v[204:207], v248 offset:8192
    v_cvt_pk_bf16_f32 v232, v160, v161
    v_cvt_pk_bf16_f32 v233, v162, v163
    s_waitcnt lgkmcnt(3)
    v_mfma_f32_32x32x16_bf16 v[176:191], v[20:23], v[192:195], v[176:191]
    ds_read_b128 v[208:211], v248 offset:9216
    v_cvt_pk_bf16_f32 v234, v164, v165
    v_cvt_pk_bf16_f32 v235, v166, v167
    s_waitcnt lgkmcnt(3)
    v_mfma_f32_32x32x16_bf16 v[176:191], v[24:27], v[196:199], v[176:191]
    ds_read_b128 v[192:195], v248 offset:10240
    v_cvt_pk_bf16_f32 v236, v168, v169
    v_cvt_pk_bf16_f32 v237, v170, v171
    s_waitcnt lgkmcnt(3)
    v_mfma_f32_32x32x16_bf16 v[176:191], v[28:31], v[200:203], v[176:191]
    ds_read_b128 v[196:199], v248 offset:11264
    v_cvt_pk_bf16_f32 v238, v172, v173
    v_cvt_pk_bf16_f32 v239, v174, v175
    s_waitcnt lgkmcnt(3)
    v_mfma_f32_32x32x16_bf16 v[176:191], v[32:35], v[204:207], v[176:191]
    ds_read_b128 v[200:203], v248 offset:12288
    buffer_store_dwordx4 v[232:235], v242, s[12:15], s44 offen sc1
    buffer_store_dwordx4 v[236:239], v242, s[12:15], s44 offen offset:1024 sc1
    s_waitcnt lgkmcnt(3)
    v_mfma_f32_32x32x16_bf16 v[176:191], v[36:39], v[208:211], v[176:191]
    ds_read_b128 v[204:207], v248 offset:13312
    s_waitcnt lgkmcnt(3)
    v_mfma_f32_32x32x16_bf16 v[176:191], v[40:43], v[192:195], v[176:191]
    ds_read_b128 v[208:211], v248 offset:14336
    s_waitcnt lgkmcnt(3)
    v_mfma_f32_32x32x16_bf16 v[176:191], v[44:47], v[196:199], v[176:191]
    ds_read_b128 v[192:195], v248 offset:15360
    s_waitcnt lgkmcnt(3)
    v_mfma_f32_32x32x16_bf16 v[176:191], v[48:51], v[200:203], v[176:191]
    ds_read_b128 v[196:199], v248 offset:16384
    s_waitcnt lgkmcnt(3)
    v_mfma_f32_32x32x16_bf16 v[176:191], v[52:55], v[204:207], v[176:191]
    ds_read_b128 v[200:203], v248 offset:17408
    s_waitcnt lgkmcnt(3)
    v_mfma_f32_32x32x16_bf16 v[176:191], v[56:59], v[208:211], v[176:191]
    ds_read_b128 v[204:207], v248 offset:18432
    s_waitcnt lgkmcnt(3)
    v_mfma_f32_32x32x16_bf16 v[176:191], v[60:63], v[192:195], v[176:191]
    ds_read_b128 v[208:211], v248 offset:19456
    s_waitcnt lgkmcnt(3)
    v_mfma_f32_32x32x16_bf16 v[176:191], v[64:67], v[196:199], v[176:191]
    ds_read_b128 v[192:195], v248 offset:20480
    s_waitcnt lgkmcnt(3)
    v_mfma_f32_32x32x16_bf16 v[176:191], v[68:71], v[200:203], v[176:191]
    ds_read_b128 v[196:199], v248 offset:21504
    s_waitcnt lgkmcnt(3)
    v_mfma_f32_32x32x16_bf16 v[176:191], v[72:75], v[204:207], v[176:191]
    ds_read_b128 v[200:203], v248 offset:22528
    s_waitcnt lgkmcnt(3)
    v_mfma_f32_32x32x16_bf16 v[176:191], v[76:79], v[208:211], v[176:191]
    ds_read_b128 v[204:207], v248 offset:23552
    s_waitcnt lgkmcnt(3)
    v_mfma_f32_32x32x16_bf16 v[176:191], v[80:83], v[192:195], v[176:191]
    ds_read_b128 v[208:211], v248 offset:24576
    s_waitcnt lgkmcnt(3)
    v_mfma_f32_32x32x16_bf16 v[176:191], v[84:87], v[196:199], v[176:191]
    ds_read_b128 v[192:195], v248 offset:25600
    s_waitcnt lgkmcnt(3)
    v_mfma_f32_32x32x16_bf16 v[176:191], v[88:91], v[200:203], v[176:191]
    ds_read_b128 v[196:199], v248 offset:26624
    s_waitcnt lgkmcnt(3)
    v_mfma_f32_32x32x16_bf16 v[176:191], v[92:95], v[204:207], v[176:191]
    ds_read_b128 v[200:203], v248 offset:27648
    s_waitcnt lgkmcnt(3)
    v_mfma_f32_32x32x16_bf16 v[176:191], v[96:99], v[208:211], v[176:191]
    ds_read_b128 v[204:207], v248 offset:28672
    s_waitcnt lgkmcnt(3)
    v_mfma_f32_32x32x16_bf16 v[176:191], v[100:103], v[192:195], v[176:191]
    ds_read_b128 v[208:211], v248 offset:29696
    s_waitcnt lgkmcnt(3)
    v_mfma_f32_32x32x16_bf16 v[176:191], v[104:107], v[196:199], v[176:191]
    ds_read_b128 v[192:195], v248 offset:30720
    s_waitcnt vmcnt(0)
    s_barrier
    s_cmp_lg_u32 s17, 0
    s_cbranch_scc1 BIG_np_59
    s_add_u32 s33, s42, 0
    v_mov_b32 v247, s33
    buffer_store_dword v247, v246, s[12:15], s93 offen sc1
BIG_np_59:
    s_add_u32 s35, s42, 3
    s_cmp_ge_u32 s35, 64
    s_cbranch_scc1 BIG_nopf_60
    s_and_b32 s35, s35, 3
    s_mul_i32 s35, s35, 40960
    s_mul_i32 s34, s17, 5120
    s_add_u32 s34, s34, s35
    s_mov_b32 m0, s34
    s_nop 0
    buffer_load_dwordx4 v240, s[12:15], s43 offen offset:0 sc1 lds
    buffer_load_dwordx4 v240, s[12:15], s43 offen offset:1024 sc1 lds
    buffer_load_dwordx4 v240, s[12:15], s43 offen offset:2048 sc1 lds
    buffer_load_dwordx4 v240, s[12:15], s43 offen offset:3072 sc1 lds
    s_add_u32 s34, s34, 4096
    s_mov_b32 m0, s34
    s_add_u32 s33, s43, 4096
    buffer_load_dwordx4 v240, s[12:15], s33 offen sc1 lds
    s_add_u32 s43, s43, 40960
BIG_nopf_60:
    s_waitcnt lgkmcnt(3)
    v_mfma_f32_32x32x16_bf16 v[176:191], v[108:111], v[200:203], v[176:191]
    ds_read_b128 v[196:199], v248 offset:31744
    s_waitcnt lgkmcnt(3)
    v_mfma_f32_32x32x16_bf16 v[176:191], v[112:115], v[204:207], v[176:191]
    ds_read_b128 v[200:203], v248 offset:32768
    s_waitcnt lgkmcnt(3)
    v_mfma_f32_32x32x16_bf16 v[176:191], v[116:119], v[208:211], v[176:191]
    ds_read_b128 v[204:207], v248 offset:33792
    s_waitcnt lgkmcnt(3)
    v_mfma_f32_32x32x16_bf16 v[176:191], v[120:123], v[192:195], v[176:191]
    ds_read_b128 v[208:211], v248 offset:34816
    s_waitcnt lgkmcnt(3)
    v_mfma_f32_32x32x16_bf16 v[176:191], v[124:127], v[196:199], v[176:191]
    ds_read_b128 v[192:195], v248 offset:35840
    s_waitcnt lgkmcnt(3)
    v_mfma_f32_32x32x16_bf16 v[176:191], v[128:131], v[200:203], v[176:191]
    ds_read_b128 v[196:199], v248 offset:36864
    s_waitcnt lgkmcnt(3)
    v_mfma_f32_32x32x16_bf16 v[176:191], v[132:135], v[204:207], v[176:191]
    ds_read_b128 v[200:203], v248 offset:37888
    s_waitcnt lgkmcnt(3)
    v_mfma_f32_32x32x16_bf16 v[176:191], v[136:139], v[208:211], v[176:191]
    ds_read_b128 v[204:207], v248 offset:38912
    s_waitcnt lgkmcnt(3)
    v_mfma_f32_32x32x16_bf16 v[176:191], v[140:143], v[192:195], v[176:191]
    ds_read_b128 v[208:211], v248 offset:39936
    s_waitcnt lgkmcnt(3)
    v_mfma_f32_32x32x16_bf16 v[176:191], v[144:147], v[196:199], v[176:191]
    ds_read_b128 v[192:195], v241 offset:0
    s_waitcnt lgkmcnt(3)
    v_mfma_f32_32x32x16_bf16 v[176:191], v[148:151], v[200:203], v[176:191]
    ds_read_b128 v[196:199], v241 offset:1024
    s_waitcnt lgkmcnt(3)
    v_mfma_f32_32x32x16_bf16 v[176:191], v[152:155], v[204:207], v[176:191]
    ds_read_b128 v[200:203], v241 offset:2048
    s_waitcnt lgkmcnt(3)
    v_mfma_f32_32x32x16_bf16 v[176:191], v[156:159], v[208:211], v[176:191]
    ds_read_b128 v[204:207], v241 offset:3072
    s_add_u32 s42, s42, 1
    s_add_u32 s44, s44, s22
    s_cmp_ge_u32 s42, 64
    s_cbranch_scc1 BIG_fin0
    s_add_u32 s35, s42, 1
    s_and_b32 s35, s35, 3
    s_mul_i32 s35, s35, 40960
    v_add_u32 v248, s35, v242
    s_waitcnt lgkmcnt(3)
    v_mfma_f32_32x32x16_bf16 v[160:175], v[0:3], v[192:195], 0
    ds_read_b128 v[208:211], v241 offset:4096
    s_waitcnt lgkmcnt(3)
    v_mfma_f32_32x32x16_bf16 v[160:175], v[4:7], v[196:199], v[160:175]
    ds_read_b128 v[192:195], v241 offset:5120
    s_waitcnt lgkmcnt(3)
    v_mfma_f32_32x32x16_bf16 v[160:175], v[8:11], v[200:203], v[160:175]
    ds_read_b128 v[196:199], v241 offset:6144
    s_waitcnt lgkmcnt(3)
    v_mfma_f32_32x32x16_bf16 v[160:175], v[12:15], v[204:207], v[160:175]
    ds_read_b128 v[200:203], v241 offset:7168
    s_waitcnt lgkmcnt(3)
    v_mfma_f32_32x32x16_bf16 v[160:175], v[16:19], v[208:211], v[160:175]
    ds_read_b128 v[204:207], v241 offset:8192
    v_cvt_pk_bf16_f32 v232, v176, v177
    v_cvt_pk_bf16_f32 v233, v178, v179
    s_waitcnt lgkmcnt(3)
    v_mfma_f32_32x32x16_bf16 v[160:175], v[20:23], v[192:195], v[160:175]
    ds_read_b128 v[208:211], v241 offset:9216
    v_cvt_pk_bf16_f32 v234, v180, v181
    v_cvt_pk_bf16_f32 v235, v182, v183
    s_waitcnt lgkmcnt(3)
    v_mfma_f32_32x32x16_bf16 v[160:175], v[24:27], v[196:199], v[160:175]
    ds_read_b128 v[192:195], v241 offset:10240
    v_cvt_pk_bf16_f32 v236, v184, v185
    v_cvt_pk_bf16_f32 v237, v186, v187
    s_waitcnt lgkmcnt(3)
    v_mfma_f32_32x32x16_bf16 v[160:175], v[28:31], v[200:203], v[160:175]
    ds_read_b128 v[196:199], v241 offset:11264
    v_cvt_pk_bf16_f32 v238, v188, v189
    v_cvt_pk_bf16_f32 v239, v190, v191
    s_waitcnt lgkmcnt(3)
    v_mfma_f32_32x32x16_bf16 v[160:175], v[32:35], v[204:207], v[160:175]
    ds_read_b128 v[200:203], v241 offset:12288
    buffer_store_dwordx4 v[232:235], v242, s[12:15], s44 offen sc1
    buffer_store_dwordx4 v[236:239], v242, s[12:15], s44 offen offset:1024 sc1
    s_waitcnt lgkmcnt(3)
    v_mfma_f32_32x32x16_bf16 v[160:175], v[36:39], v[208:211], v[160:175]
    ds_read_b128 v[204:207], v241 offset:13312
    s_waitcnt lgkmcnt(3)
    v_mfma_f32_32x32x16_bf16 v[160:175], v[40:43], v[192:195], v[160:175]
    ds_read_b128 v[208:211], v241 offset:14336
    s_waitcnt lgkmcnt(3)
    v_mfma_f32_32x32x16_bf16 v[160:175], v[44:47], v[196:199], v[160:175]
    ds_read_b128 v[192:195], v241 offset:15360
    s_waitcnt lgkmcnt(3)
    v_mfma_f32_32x32x16_bf16 v[160:175], v[48:51], v[200:203], v[160:175]
    ds_read_b128 v[196:199], v241 offset:16384
    s_waitcnt lgkmcnt(3)
    v_mfma_f32_32x32x16_bf16 v[160:175], v[52:55], v[204:207], v[160:175]
    ds_read_b128 v[200:203], v241 offset:17408
    s_waitcnt lgkmcnt(3)
    v_mfma_f32_32x32x16_bf16 v[160:175], v[56:59], v[208:211], v[160:175]
    ds_read_b128 v[204:207], v241 offset:18432
    s_waitcnt lgkmcnt(3)
    v_mfma_f32_32x32x16_bf16 v[160:175], v[60:63], v[192:195], v[160:175]
    ds_read_b128 v[208:211], v241 offset:19456
    s_waitcnt lgkmcnt(3)
    v_mfma_f32_32x32x16_bf16 v[160:175], v[64:67], v[196:199], v[160:175]
    ds_read_b128 v[192:195], v241 offset:20480
    s_waitcnt lgkmcnt(3)
    v_mfma_f32_32x32x16_bf16 v[160:175], v[68:71], v[200:203], v[160:175]
    ds_read_b128 v[196:199], v241 offset:21504
    s_waitcnt lgkmcnt(3)
    v_mfma_f32_32x32x16_bf16 v[160:175], v[72:75], v[204:207], v[160:175]
    ds_read_b128 v[200:203], v241 offset:22528
    s_waitcnt lgkmcnt(3)
    v_mfma_f32_32x32x16_bf16 v[160:175], v[76:79], v[208:211], v[160:175]
    ds_read_b128 v[204:207], v241 offset:23552
    s_waitcnt lgkmcnt(3)
    v_mfma_f32_32x32x16_bf16 v[160:175], v[80:83], v[192:195], v[160:175]
    ds_read_b128 v[208:211], v241 offset:24576
    s_waitcnt lgkmcnt(3)
    v_mfma_f32_32x32x16_bf16 v[160:175], v[84:87], v[196:199], v[160:175]
    ds_read_b128 v[192:195], v241 offset:25600
    s_waitcnt lgkmcnt(3)
    v_mfma_f32_32x32x16_bf16 v[160:175], v[88:91], v[200:203], v[160:175]
    ds_read_b128 v[196:199], v241 offset:26624
    s_waitcnt lgkmcnt(3)
    v_mfma_f32_32x32x16_bf16 v[160:175], v[92:95], v[204:207], v[160:175]
    ds_read_b128 v[200:203], v241 offset:27648
    s_waitcnt lgkmcnt(3)
    v_mfma_f32_32x32x16_bf16 v[160:175], v[96:99], v[208:211], v[160:175]
    ds_read_b128 v[204:207], v241 offset:28672
    s_waitcnt lgkmcnt(3)
    v_mfma_f32_32x32x16_bf16 v[160:175], v[100:103], v[192:195], v[160:175]
    ds_read_b128 v[208:211], v241 offset:29696
    s_waitcnt lgkmcnt(3)
    v_mfma_f32_32x32x16_bf16 v[160:175], v[104:107], v[196:199], v[160:175]
    ds_read_b128 v[192:195], v241 offset:30720
    s_waitcnt vmcnt(0)
    s_barrier
    s_cmp_lg_u32 s17, 0
    s_cbranch_scc1 BIG_np_61
    s_add_u32 s33, s42, 0
    v_mov_b32 v247, s33
    buffer_store_dword v247, v246, s[12:15], s93 offen sc1
BIG_np_61:
    s_add_u32 s35, s42, 3
    s_cmp_ge_u32 s35, 64
    s_cbranch_scc1 BIG_nopf_62
    s_and_b32 s35, s35, 3
    s_mul_i32 s35, s35, 40960
    s_mul_i32 s34, s17, 5120
    s_add_u32 s34, s34, s35
    s_mov_b32 m0, s34
    s_nop 0
    buffer_load_dwordx4 v240, s[12:15], s43 offen offset:0 sc1 lds
    buffer_load_dwordx4 v240, s[12:15], s43 offen offset:1024 sc1 lds
    buffer_load_dwordx4 v240, s[12:15], s43 offen offset:2048 sc1 lds
    buffer_load_dwordx4 v240, s[12:15], s43 offen offset:3072 sc1 lds
    s_add_u32 s34, s34, 4096
    s_mov_b32 m0, s34
    s_add_u32 s33, s43, 4096
    buffer_load_dwordx4 v240, s[12:15], s33 offen sc1 lds
    s_add_u32 s43, s43, 40960
BIG_nopf_62:
    s_waitcnt lgkmcnt(3)
    v_mfma_f32_32x32x16_bf16 v[160:175], v[108:111], v[200:203], v[160:175]
    ds_read_b128 v[196:199], v241 offset:31744
    s_waitcnt lgkmcnt(3)
    v_mfma_f32_32x32x16_bf16 v[160:175], v[112:115], v[204:207], v[160:175]
    ds_read_b128 v[200:203], v241 offset:32768
    s_waitcnt lgkmcnt(3)
    v_mfma_f32_32x32x16_bf16 v[160:175], v[116:119], v[208:211], v[160:175]
    ds_read_b128 v[204:207], v241 offset:33792
    s_waitcnt lgkmcnt(3)
    v_mfma_f32_32x32x16_bf16 v[160:175], v[120:123], v[192:195], v[160:175]
    ds_read_b128 v[208:211], v241 offset:34816
    s_waitcnt lgkmcnt(3)
    v_mfma_f32_32x32x16_bf16 v[160:175], v[124:127], v[196:199], v[160:175]
    ds_read_b128 v[192:195], v241 offset:35840
    s_waitcnt lgkmcnt(3)
    v_mfma_f32_32x32x16_bf16 v[160:175], v[128:131], v[200:203], v[160:175]
    ds_read_b128 v[196:199], v241 offset:36864
    s_waitcnt lgkmcnt(3)
    v_mfma_f32_32x32x16_bf16 v[160:175], v[132:135], v[204:207], v[160:175]
    ds_read_b128 v[200:203], v241 offset:37888
    s_waitcnt lgkmcnt(3)
    v_mfma_f32_32x32x16_bf16 v[160:175], v[136:139], v[208:211], v[160:175]
    ds_read_b128 v[204:207], v241 offset:38912
    s_waitcnt lgkmcnt(3)
    v_mfma_f32_32x32x16_bf16 v[160:175], v[140:143], v[192:195], v[160:175]
    ds_read_b128 v[208:211], v241 offset:39936
    s_waitcnt lgkmcnt(3)
    v_mfma_f32_32x32x16_bf16 v[160:175], v[144:147], v[196:199], v[160:175]
    ds_read_b128 v[192:195], v248 offset:0
    s_waitcnt lgkmcnt(3)
    v_mfma_f32_32x32x16_bf16 v[160:175], v[148:151], v[200:203], v[160:175]
    ds_read_b128 v[196:199], v248 offset:1024
    s_waitcnt lgkmcnt(3)
    v_mfma_f32_32x32x16_bf16 v[160:175], v[152:155], v[204:207], v[160:175]
    ds_read_b128 v[200:203], v248 offset:2048
    s_waitcnt lgkmcnt(3)
    v_mfma_f32_32x32x16_bf16 v[160:175], v[156:159], v[208:211], v[160:175]
    ds_read_b128 v[204:207], v248 offset:3072
    s_add_u32 s42, s42, 1
    s_add_u32 s44, s44, s22
    s_branch BIG_loop0
BIG_fin0:
    s_nop 15
    s_waitcnt lgkmcnt(0)
    v_cvt_pk_bf16_f32 v232, v176, v177
    v_cvt_pk_bf16_f32 v233, v178, v179
    v_cvt_pk_bf16_f32 v234, v180, v181
    v_cvt_pk_bf16_f32 v235, v182, v183
    v_cvt_pk_bf16_f32 v236, v184, v185
    v_cvt_pk_bf16_f32 v237, v186, v187
    v_cvt_pk_bf16_f32 v238, v188, v189
    v_cvt_pk_bf16_f32 v239, v190, v191
    buffer_store_dwordx4 v[232:235], v242, s[12:15], s44 offen sc1
    buffer_store_dwordx4 v[236:239], v242, s[12:15], s44 offen offset:1024 sc1
    s_waitcnt vmcnt(0)
    s_barrier
    s_cmp_lg_u32 s17, 0
    s_cbranch_scc1 BIG_np_63
    s_add_u32 s33, s42, 0
    v_mov_b32 v247, s33
    buffer_store_dword v247, v246, s[12:15], s93 offen sc1
BIG_np_63:
    s_branch BIG_done
BIG_gelu_path:
    s_cmp_ge_u32 s17, 4
    s_cbranch_scc1 BIG_idle
    ds_read_b128 v[192:195], v241 offset:0
    ds_read_b128 v[196:199], v241 offset:1024
    ds_read_b128 v[200:203], v241 offset:2048
    ds_read_b128 v[204:207], v241 offset:3072
    s_add_u32 s35, s42, 1
    s_and_b32 s35, s35, 3
    s_mul_i32 s35, s35, 40960
    v_add_u32 v248, s35, v242
    s_waitcnt lgkmcnt(3)
    v_mfma_f32_32x32x16_bf16 v[160:175], v[0:3], v[192:195], 0
    ds_read_b128 v[208:211], v241 offset:4096
    s_waitcnt lgkmcnt(3)
    v_mfma_f32_32x32x16_bf16 v[160:175], v[4:7], v[196:199], v[160:175]
    ds_read_b128 v[192:195], v241 offset:5120
    s_waitcnt lgkmcnt(3)
    v_mfma_f32_32x32x16_bf16 v[160:175], v[8:11], v[200:203], v[160:175]
    ds_read_b128 v[196:199], v241 offset:6144
    s_waitcnt lgkmcnt(3)
    v_mfma_f32_32x32x16_bf16 v[160:175], v[12:15], v[204:207], v[160:175]
    ds_read_b128 v[200:203], v241 offset:7168
    s_waitcnt lgkmcnt(3)
    v_mfma_f32_32x32x16_bf16 v[160:175], v[16:19], v[208:211], v[160:175]
    ds_read_b128 v[204:207], v241 offset:8192
    s_waitcnt lgkmcnt(3)
    v_mfma_f32_32x32x16_bf16 v[160:175], v[20:23], v[192:195], v[160:175]
    ds_read_b128 v[208:211], v241 offset:9216
    s_waitcnt lgkmcnt(3)
    v_mfma_f32_32x32x16_bf16 v[160:175], v[24:27], v[196:199], v[160:175]
    ds_read_b128 v[192:195], v241 offset:10240
    s_waitcnt lgkmcnt(3)
    v_mfma_f32_32x32x16_bf16 v[160:175], v[28:31], v[200:203], v[160:175]
    ds_read_b128 v[196:199], v241 offset:11264
    s_waitcnt lgkmcnt(3)
    v_mfma_f32_32x32x16_bf16 v[160:175], v[32:35], v[204:207], v[160:175]
    ds_read_b128 v[200:203], v241 offset:12288
    s_waitcnt lgkmcnt(3)
    v_mfma_f32_32x32x16_bf16 v[160:175], v[36:39], v[208:211], v[160:175]
    ds_read_b128 v[204:207], v241 offset:13312
    s_waitcnt lgkmcnt(3)
    v_mfma_f32_32x32x16_bf16 v[160:175], v[40:43], v[192:195], v[160:175]
    ds_read_b128 v[208:211], v241 offset:14336
    s_waitcnt lgkmcnt(3)
    v_mfma_f32_32x32x16_bf16 v[160:175], v[44:47], v[196:199], v[160:175]
    ds_read_b128 v[192:195], v241 offset:15360
    s_waitcnt lgkmcnt(3)
    v_mfma_f32_32x32x16_bf16 v[160:175], v[48:51], v[200:203], v[160:175]
    ds_read_b128 v[196:199], v241 offset:16384
    s_waitcnt lgkmcnt(3)
    v_mfma_f32_32x32x16_bf16 v[160:175], v[52:55], v[204:207], v[160:175]
    ds_read_b128 v[200:203], v241 offset:17408
    s_waitcnt lgkmcnt(3)
    v_mfma_f32_32x32x16_bf16 v[160:175], v[56:59], v[208:211], v[160:175]
    ds_read_b128 v[204:207], v241 offset:18432
    s_waitcnt lgkmcnt(3)
    v_mfma_f32_32x32x16_bf16 v[160:175], v[60:63], v[192:195], v[160:175]
    ds_read_b128 v[208:211], v241 offset:19456
    s_waitcnt lgkmcnt(3)
    v_mfma_f32_32x32x16_bf16 v[160:175], v[64:67], v[196:199], v[160:175]
    ds_read_b128 v[192:195], v241 offset:20480
    s_waitcnt lgkmcnt(3)
    v_mfma_f32_32x32x16_bf16 v[160:175], v[68:71], v[200:203], v[160:175]
    ds_read_b128 v[196:199], v241 offset:21504
    s_waitcnt lgkmcnt(3)
    v_mfma_f32_32x32x16_bf16 v[160:175], v[72:75], v[204:207], v[160:175]
    ds_read_b128 v[200:203], v241 offset:22528
    s_waitcnt lgkmcnt(3)
    v_mfma_f32_32x32x16_bf16 v[160:175], v[76:79], v[208:211], v[160:175]
    ds_read_b128 v[204:207], v241 offset:23552
    s_waitcnt lgkmcnt(3)
    v_mfma_f32_32x32x16_bf16 v[160:175], v[80:83], v[192:195], v[160:175]
    ds_read_b128 v[208:211], v241 offset:24576
    s_waitcnt lgkmcnt(3)
    v_mfma_f32_32x32x16_bf16 v[160:175], v[84:87], v[196:199], v[160:175]
    ds_read_b128 v[192:195], v241 offset:25600
    s_waitcnt lgkmcnt(3)
    v_mfma_f32_32x32x16_bf16 v[160:175], v[88:91], v[200:203], v[160:175]
    ds_read_b128 v[196:199], v241 offset:26624
    s_waitcnt lgkmcnt(3)
    v_mfma_f32_32x32x16_bf16 v[160:175], v[92:95], v[204:207], v[160:175]
    ds_read_b128 v[200:203], v241 offset:27648
    s_waitcnt lgkmcnt(3)
    v_mfma_f32_32x32x16_bf16 v[160:175], v[96:99], v[208:211], v[160:175]
    ds_read_b128 v[204:207], v241 offset:28672
    s_waitcnt lgkmcnt(3)
    v_mfma_f32_32x32x16_bf16 v[160:175], v[100:103], v[192:195], v[160:175]
    ds_read_b128 v[208:211], v241 offset:29696
    s_waitcnt lgkmcnt(3)
    v_mfma_f32_32x32x16_bf16 v[160:175], v[104:107], v[196:199], v[160:175]
    ds_read_b128 v[192:195], v241 offset:30720
    s_waitcnt vmcnt(0)
    s_barrier
    s_add_u32 s35, s42, 3
    s_cmp_ge_u32 s35, 64
    s_cbranch_scc1 BIG_nopf_64
    s_and_b32 s35, s35, 3
    s_mul_i32 s35, s35, 40960
    s_mul_i32 s34, s17, 5120
    s_add_u32 s34, s34, s35
    s_mov_b32 m0, s34
    s_nop 0
    buffer_load_dwordx4 v240, s[12:15], s43 offen offset:0 sc1 lds
    buffer_load_dwordx4 v240, s[12:15], s43 offen offset:1024 sc1 lds
    buffer_load_dwordx4 v240, s[12:15], s43 offen offset:2048 sc1 lds
    buffer_load_dwordx4 v240, s[12:15], s43 offen offset:3072 sc1 lds
    s_add_u32 s34, s34, 4096
    s_mov_b32 m0, s34
    s_add_u32 s33, s43, 4096
    buffer_load_dwordx4 v240, s[12:15], s33 offen sc1 lds
    s_add_u32 s43, s43, 40960
BIG_nopf_64:
    s_waitcnt lgkmcnt(3)
    v_mfma_f32_32x32x16_bf16 v[160:175], v[108:111], v[200:203], v[160:175]
    ds_read_b128 v[196:199], v241 offset:31744
    s_waitcnt lgkmcnt(3)
    v_mfma_f32_32x32x16_bf16 v[160:175], v[112:115], v[204:207], v[160:175]
    ds_read_b128 v[200:203], v241 offset:32768
    s_waitcnt lgkmcnt(3)
    v_mfma_f32_32x32x16_bf16 v[160:175], v[116:119], v[208:211], v[160:175]
    ds_read_b128 v[204:207], v241 offset:33792
    s_waitcnt lgkmcnt(3)
    v_mfma_f32_32x32x16_bf16 v[160:175], v[120:123], v[192:195], v[160:175]
    ds_read_b128 v[208:211], v241 offset:34816
    s_waitcnt lgkmcnt(3)
    v_mfma_f32_32x32x16_bf16 v[160:175], v[124:127], v[196:199], v[160:175]
    ds_read_b128 v[192:195], v241 offset:35840
    s_waitcnt lgkmcnt(3)
    v_mfma_f32_32x32x16_bf16 v[160:175], v[128:131], v[200:203], v[160:175]
    ds_read_b128 v[196:199], v241 offset:36864
    s_waitcnt lgkmcnt(3)
    v_mfma_f32_32x32x16_bf16 v[160:175], v[132:135], v[204:207], v[160:175]
    ds_read_b128 v[200:203], v241 offset:37888
    s_waitcnt lgkmcnt(3)
    v_mfma_f32_32x32x16_bf16 v[160:175], v[136:139], v[208:211], v[160:175]
    ds_read_b128 v[204:207], v241 offset:38912
    s_waitcnt lgkmcnt(3)
    v_mfma_f32_32x32x16_bf16 v[160:175], v[140:143], v[192:195], v[160:175]
    ds_read_b128 v[208:211], v241 offset:39936
    s_waitcnt lgkmcnt(3)
    v_mfma_f32_32x32x16_bf16 v[160:175], v[144:147], v[196:199], v[160:175]
    ds_read_b128 v[192:195], v248 offset:0
    s_waitcnt lgkmcnt(3)
    v_mfma_f32_32x32x16_bf16 v[160:175], v[148:151], v[200:203], v[160:175]
    ds_read_b128 v[196:199], v248 offset:1024
    s_waitcnt lgkmcnt(3)
    v_mfma_f32_32x32x16_bf16 v[160:175], v[152:155], v[204:207], v[160:175]
    ds_read_b128 v[200:203], v248 offset:2048
    s_waitcnt lgkmcnt(3)
    v_mfma_f32_32x32x16_bf16 v[160:175], v[156:159], v[208:211], v[160:175]
    ds_read_b128 v[204:207], v248 offset:3072
    s_add_u32 s42, s42, 1
    s_add_u32 s44, s44, s22
BIG_loop1:
    s_add_u32 s35, s42, 1
    s_and_b32 s35, s35, 3
    s_mul_i32 s35, s35, 40960
    v_add_u32 v241, s35, v242
    s_waitcnt lgkmcnt(3)
    v_mfma_f32_32x32x16_bf16 v[176:191], v[0:3], v[192:195], 0
    ds_read_b128 v[208:211], v248 offset:4096
    s_waitcnt lgkmcnt(3)
    v_mfma_f32_32x32x16_bf16 v[176:191], v[4:7], v[196:199], v[176:191]
    ds_read_b128 v[192:195], v248 offset:5120
    s_waitcnt lgkmcnt(3)
    v_mfma_f32_32x32x16_bf16 v[176:191], v[8:11], v[200:203], v[176:191]
    ds_read_b128 v[196:199], v248 offset:6144
    s_waitcnt lgkmcnt(3)
    v_mfma_f32_32x32x16_bf16 v[176:191], v[12:15], v[204:207], v[176:191]
    ds_read_b128 v[200:203], v248 offset:7168
    s_waitcnt lgkmcnt(3)
    v_mfma_f32_32x32x16_bf16 v[176:191], v[16:19], v[208:211], v[176:191]
    ds_read_b128 v[204:207], v248 offset:8192
    v_cvt_pk_bf16_f32 v243, v160, v161
    v_lshlrev_b32 v160, 16, v243
    v_and_b32 v161, 0xffff0000, v243
    v_add_f32 v160, v160, v216
    v_add_f32 v161, v161, v217
    v_cvt_pk_bf16_f32 v243, v160, v161
    v_lshlrev_b32 v160, 16, v243
    s_waitcnt lgkmcnt(3)
    v_mfma_f32_32x32x16_bf16 v[176:191], v[20:23], v[192:195], v[176:191]
    ds_read_b128 v[208:211], v248 offset:9216
    v_and_b32 v161, 0xffff0000, v243
    v_mul_f32 v244, v160, v160
    v_mul_f32 v244, s41, v244
    v_add_f32 v244, s40, v244
    v_mul_f32 v244, v244, v160
    v_exp_f32 v244, v244
    v_mul_f32 v245, v161, v161
    s_waitcnt lgkmcnt(3)
    v_mfma_f32_32x32x16_bf16 v[176:191], v[24:27], v[196:199], v[176:191]
    ds_read_b128 v[192:195], v248 offset:10240
    v_mul_f32 v245, s41, v245
    v_add_f32 v245, s40, v245
    v_mul_f32 v245, v245, v161
    v_exp_f32 v245, v245
    v_add_f32 v244, 1.0, v244
    v_rcp_f32 v244, v244
    v_add_f32 v245, 1.0, v245
    s_waitcnt lgkmcnt(3)
    v_mfma_f32_32x32x16_bf16 v[176:191], v[28:31], v[200:203], v[176:191]
    ds_read_b128 v[196:199], v248 offset:11264
    v_rcp_f32 v245, v245
    v_mul_f32 v160, v160, v244
    v_mul_f32 v161, v161, v245
    v_cvt_pk_bf16_f32 v232, v160, v161
    v_cvt_pk_bf16_f32 v243, v162, v163
    v_lshlrev_b32 v162, 16, v243
    v_and_b32 v163, 0xffff0000, v243
    s_waitcnt lgkmcnt(3)
    v_mfma_f32_32x32x16_bf16 v[176:191], v[32:35], v[204:207], v[176:191]
    ds_read_b128 v[200:203], v248 offset:12288
    v_add_f32 v162, v162, v218
    v_add_f32 v163, v163, v219
    v_cvt_pk_bf16_f32 v243, v162, v163
    v_lshlrev_b32 v162, 16, v243
    v_and_b32 v163, 0xffff0000, v243
    v_mul_f32 v244, v162, v162
    v_mul_f32 v244, s41, v244
    s_waitcnt lgkmcnt(3)
    v_mfma_f32_32x32x16_bf16 v[176:191], v[36:39], v[208:211], v[176:191]
    ds_read_b128 v[204:207], v248 offset:13312
    v_add_f32 v244, s40, v244
    v_mul_f32 v244, v244, v162
    v_exp_f32 v244, v244
    v_mul_f32 v245, v163, v163
    v_mul_f32 v245, s41, v245
    v_add_f32 v245, s40, v245
    v_mul_f32 v245, v245, v163
    s_waitcnt lgkmcnt(3)
    v_mfma_f32_32x32x16_bf16 v[176:191], v[40:43], v[192:195], v[176:191]
    ds_read_b128 v[208:211], v248 offset:14336
    v_exp_f32 v245, v245
    v_add_f32 v244, 1.0, v244
    v_rcp_f32 v244, v244
    v_add_f32 v245, 1.0, v245
    v_rcp_f32 v245, v245
    v_mul_f32 v162, v162, v244
    v_mul_f32 v163, v163, v245
    s_waitcnt lgkmcnt(3)
    v_mfma_f32_32x32x16_bf16 v[176:191], v[44:47], v[196:199], v[176:191]
    ds_read_b128 v[192:195], v248 offset:15360
    v_cvt_pk_bf16_f32 v233, v162, v163
    v_cvt_pk_bf16_f32 v243, v164, v165
    v_lshlrev_b32 v164, 16, v243
    v_and_b32 v165, 0xffff0000, v243
    v_add_f32 v164, v164, v220
    v_add_f32 v165, v165, v221
    v_cvt_pk_bf16_f32 v243, v164, v165
    s_waitcnt lgkmcnt(3)
    v_mfma_f32_32x32x16_bf16 v[176:191], v[48:51], v[200:203], v[176:191]
    ds_read_b128 v[196:199], v248 offset:16384
    v_lshlrev_b32 v164, 16, v243
    v_and_b32 v165, 0xffff0000, v243
    v_mul_f32 v244, v164, v164
    v_mul_f32 v244, s41, v244
    v_add_f32 v244, s40, v244
    v_mul_f32 v244, v244, v164
    v_exp_f32 v244, v244
    s_waitcnt lgkmcnt(3)
    v_mfma_f32_32x32x16_bf16 v[176:191], v[52:55], v[204:207], v[176:191]
    ds_read_b128 v[200:203], v248 offset:17408
    v_mul_f32 v245, v165, v165
    v_mul_f32 v245, s41, v245
    v_add_f32 v245, s40, v245
    v_mul_f32 v245, v245, v165
    v_exp_f32 v245, v245
    v_add_f32 v244, 1.0, v244
    v_rcp_f32 v244, v244
    s_waitcnt lgkmcnt(3)
    v_mfma_f32_32x32x16_bf16 v[176:191], v[56:59], v[208:211], v[176:191]
    ds_read_b128 v[204:207], v248 offset:18432
    v_add_f32 v245, 1.0, v245
    v_rcp_f32 v245, v245
    v_mul_f32 v164, v164, v244
    v_mul_f32 v165, v165, v245
    v_cvt_pk_bf16_f32 v234, v164, v165
    v_cvt_pk_bf16_f32 v243, v166, v167
    v_lshlrev_b32 v166, 16, v243
    s_waitcnt lgkmcnt(3)
    v_mfma_f32_32x32x16_bf16 v[176:191], v[60:63], v[192:195], v[176:191]
    ds_read_b128 v[208:211], v248 offset:19456
    v_and_b32 v167, 0xffff0000, v243
    v_add_f32 v166, v166, v222
    v_add_f32 v167, v167, v223
    v_cvt_pk_bf16_f32 v243, v166, v167
    v_lshlrev_b32 v166, 16, v243
    v_and_b32 v167, 0xffff0000, v243
    v_mul_f32 v244, v166, v166
    s_waitcnt lgkmcnt(3)
    v_mfma_f32_32x32x16_bf16 v[176:191], v[64:67], v[196:199], v[176:191]
    ds_read_b128 v[192:195], v248 offset:20480
    v_mul_f32 v244, s41, v244
    v_add_f32 v244, s40, v244
    v_mul_f32 v244, v244, v166
    v_exp_f32 v244, v244
    v_mul_f32 v245, v167, v167
    v_mul_f32 v245, s41, v245
    v_add_f32 v245, s40, v245
    s_waitcnt lgkmcnt(3)
    v_mfma_f32_32x32x16_bf16 v[176:191], v[68:71], v[200:203], v[176:191]
    ds_read_b128 v[196:199], v248 offset:21504
    v_mul_f32 v245, v245, v167
    v_exp_f32 v245, v245
    v_add_f32 v244, 1.0, v244
    v_rcp_f32 v244, v244
    v_add_f32 v245, 1.0, v245
    v_rcp_f32 v245, v245
    v_mul_f32 v166, v166, v244
    s_waitcnt lgkmcnt(3)
    v_mfma_f32_32x32x16_bf16 v[176:191], v[72:75], v[204:207], v[176:191]
    ds_read_b128 v[200:203], v248 offset:22528
    v_mul_f32 v167, v167, v245
    v_cvt_pk_bf16_f32 v235, v166, v167
    v_cvt_pk_bf16_f32 v243, v168, v169
    v_lshlrev_b32 v168, 16, v243
    v_and_b32 v169, 0xffff0000, v243
    v_add_f32 v168, v168, v224
    v_add_f32 v169, v169, v225
    s_waitcnt lgkmcnt(3)
    v_mfma_f32_32x32x16_bf16 v[176:191], v[76:79], v[208:211], v[176:191]
    ds_read_b128 v[204:207], v248 offset:23552
    v_cvt_pk_bf16_f32 v243, v168, v169
    v_lshlrev_b32 v168, 16, v243
    v_and_b32 v169, 0xffff0000, v243
    v_mul_f32 v244, v168, v168
    v_mul_f32 v244, s41, v244
    v_add_f32 v244, s40, v244
    v_mul_f32 v244, v244, v168
    s_waitcnt lgkmcnt(3)
    v_mfma_f32_32x32x16_bf16 v[176:191], v[80:83], v[192:195], v[176:191]
    ds_read_b128 v[208:211], v248 offset:24576
    v_exp_f32 v244, v244
    v_mul_f32 v245, v169, v169
    v_mul_f32 v245, s41, v245
    v_add_f32 v245, s40, v245
    v_mul_f32 v245, v245, v169
    v_exp_f32 v245, v245
    v_add_f32 v244, 1.0, v244
    s_waitcnt lgkmcnt(3)
    v_mfma_f32_32x32x16_bf16 v[176:191], v[84:87], v[196:199], v[176:191]
    ds_read_b128 v[192:195], v248 offset:25600
    v_rcp_f32 v244, v244
    v_add_f32 v245, 1.0, v245
    v_rcp_f32 v245, v245
    v_mul_f32 v168, v168, v244
    v_mul_f32 v169, v169, v245
    v_cvt_pk_bf16_f32 v236, v168, v169
    v_cvt_pk_bf16_f32 v243, v170, v171
    s_waitcnt lgkmcnt(3)
    v_mfma_f32_32x32x16_bf16 v[176:191], v[88:91], v[200:203], v[176:191]
    ds_read_b128 v[196:199], v248 offset:26624
    v_lshlrev_b32 v170, 16, v243
    v_and_b32 v171, 0xffff0000, v243
    v_add_f32 v170, v170, v226
    v_add_f32 v171, v171, v227
    v_cvt_pk_bf16_f32 v243, v170, v171
    v_lshlrev_b32 v170, 16, v243
    v_and_b32 v171, 0xffff0000, v243
    s_waitcnt lgkmcnt(3)
    v_mfma_f32_32x32x16_bf16 v[176:191], v[92:95], v[204:207], v[176:191]
    ds_read_b128 v[200:203], v248 offset:27648
    v_mul_f32 v244, v170, v170
    v_mul_f32 v244, s41, v244
    v_add_f32 v244, s40, v244
    v_mul_f32 v244, v244, v170
    v_exp_f32 v244, v244
    v_mul_f32 v245, v171, v171
    v_mul_f32 v245, s41, v245
    s_waitcnt lgkmcnt(3)
    v_mfma_f32_32x32x16_bf16 v[176:191], v[96:99], v[208:211], v[176:191]
    ds_read_b128 v[204:207], v248 offset:28672
    v_add_f32 v245, s40, v245
    v_mul_f32 v245, v245, v171
    v_exp_f32 v245, v245
    v_add_f32 v244, 1.0, v244
    v_rcp_f32 v244, v244
    v_add_f32 v245, 1.0, v245
    v_rcp_f32 v245, v245
    s_waitcnt lgkmcnt(3)
    v_mfma_f32_32x32x16_bf16 v[176:191], v[100:103], v[192:195], v[176:191]
    ds_read_b128 v[208:211], v248 offset:29696
    v_mul_f32 v170, v170, v244
    v_mul_f32 v171, v171, v245
    v_cvt_pk_bf16_f32 v237, v170, v171
    v_cvt_pk_bf16_f32 v243, v172, v173
    v_lshlrev_b32 v172, 16, v243
    v_and_b32 v173, 0xffff0000, v243
    v_add_f32 v172, v172, v228
    s_waitcnt lgkmcnt(3)
    v_mfma_f32_32x32x16_bf16 v[176:191], v[104:107], v[196:199], v[176:191]
    ds_read_b128 v[192:195], v248 offset:30720
    v_add_f32 v173, v173, v229
    v_cvt_pk_bf16_f32 v243, v172, v173
    v_lshlrev_b32 v172, 16, v243
    v_and_b32 v173, 0xffff0000, v243
    v_mul_f32 v244, v172, v172
    v_mul_f32 v244, s41, v244
    v_add_f32 v244, s40, v244
    s_waitcnt vmcnt(0)
    s_barrier
    s_cmp_lg_u32 s17, 0
    s_cbranch_scc1 BIG_np_65
    s_sub_u32 s33, s42, 1
    v_mov_b32 v247, s33
    buffer_store_dword v247, v246, s[12:15], s93 offen sc1
BIG_np_65:
    s_add_u32 s35, s42, 3
    s_cmp_ge_u32 s35, 64
    s_cbranch_scc1 BIG_nopf_66
    s_and_b32 s35, s35, 3
    s_mul_i32 s35, s35, 40960
    s_mul_i32 s34, s17, 5120
    s_add_u32 s34, s34, s35
    s_mov_b32 m0, s34
    s_nop 0
    buffer_load_dwordx4 v240, s[12:15], s43 offen offset:0 sc1 lds
    buffer_load_dwordx4 v240, s[12:15], s43 offen offset:1024 sc1 lds
    buffer_load_dwordx4 v240, s[12:15], s43 offen offset:2048 sc1 lds
    buffer_load_dwordx4 v240, s[12:15], s43 offen offset:3072 sc1 lds
    s_add_u32 s34, s34, 4096
    s_mov_b32 m0, s34
    s_add_u32 s33, s43, 4096
    buffer_load_dwordx4 v240, s[12:15], s33 offen sc1 lds
    s_add_u32 s43, s43, 40960
BIG_nopf_66:
    s_waitcnt lgkmcnt(3)
    v_mfma_f32_32x32x16_bf16 v[176:191], v[108:111], v[200:203], v[176:191]
    ds_read_b128 v[196:199], v248 offset:31744
    v_mul_f32 v244, v244, v172
    v_exp_f32 v244, v244
    v_mul_f32 v245, v173, v173
    v_mul_f32 v245, s41, v245
    v_add_f32 v245, s40, v245
    v_mul_f32 v245, v245, v173
    v_exp_f32 v245, v245
    s_waitcnt lgkmcnt(3)
    v_mfma_f32_32x32x16_bf16 v[176:191], v[112:115], v[204:207], v[176:191]
    ds_read_b128 v[200:203], v248 offset:32768
    v_add_f32 v244, 1.0, v244
    v_rcp_f32 v244, v244
    v_add_f32 v245, 1.0, v245
    v_rcp_f32 v245, v245
    v_mul_f32 v172, v172, v244
    v_mul_f32 v173, v173, v245
    v_cvt_pk_bf16_f32 v238, v172, v173
    s_waitcnt lgkmcnt(3)
    v_mfma_f32_32x32x16_bf16 v[176:191], v[116:119], v[208:211], v[176:191]
    ds_read_b128 v[204:207], v248 offset:33792
    v_cvt_pk_bf16_f32 v243, v174, v175
    v_lshlrev_b32 v174, 16, v243
    v_and_b32 v175, 0xffff0000, v243
    v_add_f32 v174, v174, v230
    v_add_f32 v175, v175, v231
    v_cvt_pk_bf16_f32 v243, v174, v175
    v_lshlrev_b32 v174, 16, v243
    s_waitcnt lgkmcnt(3)
    v_mfma_f32_32x32x16_bf16 v[176:191], v[120:123], v[192:195], v[176:191]
    ds_read_b128 v[208:211], v248 offset:34816
    v_and_b32 v175, 0xffff0000, v243
    v_mul_f32 v244, v174, v174
    v_mul_f32 v244, s41, v244
    v_add_f32 v244, s40, v244
    v_mul_f32 v244, v244, v174
    v_exp_f32 v244, v244
    v_mul_f32 v245, v175, v175
    s_waitcnt lgkmcnt(3)
    v_mfma_f32_32x32x16_bf16 v[176:191], v[124:127], v[196:199], v[176:191]
    ds_read_b128 v[192:195], v248 offset:35840
    v_mul_f32 v245, s41, v245
    v_add_f32 v245, s40, v245
    v_mul_f32 v245, v245, v175
    v_exp_f32 v245, v245
    v_add_f32 v244, 1.0, v244
    v_rcp_f32 v244, v244
    v_add_f32 v245, 1.0, v245
    s_waitcnt lgkmcnt(3)
    v_mfma_f32_32x32x16_bf16 v[176:191], v[128:131], v[200:203], v[176:191]
    ds_read_b128 v[196:199], v248 offset:36864
    v_rcp_f32 v245, v245
    v_mul_f32 v174, v174, v244
    v_mul_f32 v175, v175, v245
    v_cvt_pk_bf16_f32 v239, v174, v175
    buffer_store_dwordx4 v[232:235], v242, s[12:15], s44 offen sc1
    buffer_store_dwordx4 v[236:239], v242, s[12:15], s44 offen offset:1024 sc1
    s_waitcnt lgkmcnt(3)
    v_mfma_f32_32x32x16_bf16 v[176:191], v[132:135], v[204:207], v[176:191]
    ds_read_b128 v[200:203], v248 offset:37888
    s_waitcnt lgkmcnt(3)
    v_mfma_f32_32x32x16_bf16 v[176:191], v[136:139], v[208:211], v[176:191]
    ds_read_b128 v[204:207], v248 offset:38912
    s_waitcnt lgkmcnt(3)
    v_mfma_f32_32x32x16_bf16 v[176:191], v[140:143], v[192:195], v[176:191]
    ds_read_b128 v[208:211], v248 offset:39936
    s_waitcnt lgkmcnt(3)
    v_mfma_f32_32x32x16_bf16 v[176:191], v[144:147], v[196:199], v[176:191]
    ds_read_b128 v[192:195], v241 offset:0
    s_waitcnt lgkmcnt(3)
    v_mfma_f32_32x32x16_bf16 v[176:191], v[148:151], v[200:203], v[176:191]
    ds_read_b128 v[196:199], v241 offset:1024
    s_waitcnt lgkmcnt(3)
    v_mfma_f32_32x32x16_bf16 v[176:191], v[152:155], v[204:207], v[176:191]
    ds_read_b128 v[200:203], v241 offset:2048
    s_waitcnt lgkmcnt(3)
    v_mfma_f32_32x32x16_bf16 v[176:191], v[156:159], v[208:211], v[176:191]
    ds_read_b128 v[204:207], v241 offset:3072
    s_add_u32 s42, s42, 1
    s_add_u32 s44, s44, s22
    s_cmp_ge_u32 s42, 64
    s_cbranch_scc1 BIG_fin1
    s_add_u32 s35, s42, 1
    s_and_b32 s35, s35, 3
    s_mul_i32 s35, s35, 40960
    v_add_u32 v248, s35, v242
    s_waitcnt lgkmcnt(3)
    v_mfma_f32_32x32x16_bf16 v[160:175], v[0:3], v[192:195], 0
    ds_read_b128 v[208:211], v241 offset:4096
    s_waitcnt lgkmcnt(3)
    v_mfma_f32_32x32x16_bf16 v[160:175], v[4:7], v[196:199], v[160:175]
    ds_read_b128 v[192:195], v241 offset:5120
    s_waitcnt lgkmcnt(3)
    v_mfma_f32_32x32x16_bf16 v[160:175], v[8:11], v[200:203], v[160:175]
    ds_read_b128 v[196:199], v241 offset:6144
    s_waitcnt lgkmcnt(3)
    v_mfma_f32_32x32x16_bf16 v[160:175], v[12:15], v[204:207], v[160:175]
    ds_read_b128 v[200:203], v241 offset:7168
    s_waitcnt lgkmcnt(3)
    v_mfma_f32_32x32x16_bf16 v[160:175], v[16:19], v[208:211], v[160:175]
    ds_read_b128 v[204:207], v241 offset:8192
    v_cvt_pk_bf16_f32 v243, v176, v177
    v_lshlrev_b32 v176, 16, v243
    v_and_b32 v177, 0xffff0000, v243
    v_add_f32 v176, v176, v216
    v_add_f32 v177, v177, v217
    v_cvt_pk_bf16_f32 v243, v176, v177
    v_lshlrev_b32 v176, 16, v243
    s_waitcnt lgkmcnt(3)
    v_mfma_f32_32x32x16_bf16 v[160:175], v[20:23], v[192:195], v[160:175]
    ds_read_b128 v[208:211], v241 offset:9216
    v_and_b32 v177, 0xffff0000, v243
    v_mul_f32 v244, v176, v176
    v_mul_f32 v244, s41, v244
    v_add_f32 v244, s40, v244
    v_mul_f32 v244, v244, v176
    v_exp_f32 v244, v244
    v_mul_f32 v245, v177, v177
    s_waitcnt lgkmcnt(3)
    v_mfma_f32_32x32x16_bf16 v[160:175], v[24:27], v[196:199], v[160:175]
    ds_read_b128 v[192:195], v241 offset:10240
    v_mul_f32 v245, s41, v245
    v_add_f32 v245, s40, v245
    v_mul_f32 v245, v245, v177
    v_exp_f32 v245, v245
    v_add_f32 v244, 1.0, v244
    v_rcp_f32 v244, v244
    v_add_f32 v245, 1.0, v245
    s_waitcnt lgkmcnt(3)
    v_mfma_f32_32x32x16_bf16 v[160:175], v[28:31], v[200:203], v[160:175]
    ds_read_b128 v[196:199], v241 offset:11264
    v_rcp_f32 v245, v245
    v_mul_f32 v176, v176, v244
    v_mul_f32 v177, v177, v245
    v_cvt_pk_bf16_f32 v232, v176, v177
    v_cvt_pk_bf16_f32 v243, v178, v179
    v_lshlrev_b32 v178, 16, v243
    v_and_b32 v179, 0xffff0000, v243
    s_waitcnt lgkmcnt(3)
    v_mfma_f32_32x32x16_bf16 v[160:175], v[32:35], v[204:207], v[160:175]
    ds_read_b128 v[200:203], v241 offset:12288
    v_add_f32 v178, v178, v218
    v_add_f32 v179, v179, v219
    v_cvt_pk_bf16_f32 v243, v178, v179
    v_lshlrev_b32 v178, 16, v243
    v_and_b32 v179, 0xffff0000, v243
    v_mul_f32 v244, v178, v178
    v_mul_f32 v244, s41, v244
    s_waitcnt lgkmcnt(3)
    v_mfma_f32_32x32x16_bf16 v[160:175], v[36:39], v[208:211], v[160:175]
    ds_read_b128 v[204:207], v241 offset:13312
    v_add_f32 v244, s40, v244
    v_mul_f32 v244, v244, v178
    v_exp_f32 v244, v244
    v_mul_f32 v245, v179, v179
    v_mul_f32 v245, s41, v245
    v_add_f32 v245, s40, v245
    v_mul_f32 v245, v245, v179
    s_waitcnt lgkmcnt(3)
    v_mfma_f32_32x32x16_bf16 v[160:175], v[40:43], v[192:195], v[160:175]
    ds_read_b128 v[208:211], v241 offset:14336
    v_exp_f32 v245, v245
    v_add_f32 v244, 1.0, v244
    v_rcp_f32 v244, v244
    v_add_f32 v245, 1.0, v245
    v_rcp_f32 v245, v245
    v_mul_f32 v178, v178, v244
    v_mul_f32 v179, v179, v245
    s_waitcnt lgkmcnt(3)
    v_mfma_f32_32x32x16_bf16 v[160:175], v[44:47], v[196:199], v[160:175]
    ds_read_b128 v[192:195], v241 offset:15360
    v_cvt_pk_bf16_f32 v233, v178, v179
    v_cvt_pk_bf16_f32 v243, v180, v181
    v_lshlrev_b32 v180, 16, v243
    v_and_b32 v181, 0xffff0000, v243
    v_add_f32 v180, v180, v220
    v_add_f32 v181, v181, v221
    v_cvt_pk_bf16_f32 v243, v180, v181
    s_waitcnt lgkmcnt(3)
    v_mfma_f32_32x32x16_bf16 v[160:175], v[48:51], v[200:203], v[160:175]
    ds_read_b128 v[196:199], v241 offset:16384
    v_lshlrev_b32 v180, 16, v243
    v_and_b32 v181, 0xffff0000, v243
    v_mul_f32 v244, v180, v180
    v_mul_f32 v244, s41, v244
    v_add_f32 v244, s40, v244
    v_mul_f32 v244, v244, v180
    v_exp_f32 v244, v244
    s_waitcnt lgkmcnt(3)
    v_mfma_f32_32x32x16_bf16 v[160:175], v[52:55], v[204:207], v[160:175]
    ds_read_b128 v[200:203], v241 offset:17408
    v_mul_f32 v245, v181, v181
    v_mul_f32 v245, s41, v245
    v_add_f32 v245, s40, v245
    v_mul_f32 v245, v245, v181
    v_exp_f32 v245, v245
    v_add_f32 v244, 1.0, v244
    v_rcp_f32 v244, v244
    s_waitcnt lgkmcnt(3)
    v_mfma_f32_32x32x16_bf16 v[160:175], v[56:59], v[208:211], v[160:175]
    ds_read_b128 v[204:207], v241 offset:18432
    v_add_f32 v245, 1.0, v245
    v_rcp_f32 v245, v245
    v_mul_f32 v180, v180, v244
    v_mul_f32 v181, v181, v245
    v_cvt_pk_bf16_f32 v234, v180, v181
    v_cvt_pk_bf16_f32 v243, v182, v183
    v_lshlrev_b32 v182, 16, v243
    s_waitcnt lgkmcnt(3)
    v_mfma_f32_32x32x16_bf16 v[160:175], v[60:63], v[192:195], v[160:175]
    ds_read_b128 v[208:211], v241 offset:19456
    v_and_b32 v183, 0xffff0000, v243
    v_add_f32 v182, v182, v222
    v_add_f32 v183, v183, v223
    v_cvt_pk_bf16_f32 v243, v182, v183
    v_lshlrev_b32 v182, 16, v243
    v_and_b32 v183, 0xffff0000, v243
    v_mul_f32 v244, v182, v182
    s_waitcnt lgkmcnt(3)
    v_mfma_f32_32x32x16_bf16 v[160:175], v[64:67], v[196:199], v[160:175]
    ds_read_b128 v[192:195], v241 offset:20480
    v_mul_f32 v244, s41, v244
    v_add_f32 v244, s40, v244
    v_mul_f32 v244, v244, v182
    v_exp_f32 v244, v244
    v_mul_f32 v245, v183, v183
    v_mul_f32 v245, s41, v245
    v_add_f32 v245, s40, v245
    s_waitcnt lgkmcnt(3)
    v_mfma_f32_32x32x16_bf16 v[160:175], v[68:71], v[200:203], v[160:175]
    ds_read_b128 v[196:199], v241 offset:21504
    v_mul_f32 v245, v245, v183
    v_exp_f32 v245, v245
    v_add_f32 v244, 1.0, v244
    v_rcp_f32 v244, v244
    v_add_f32 v245, 1.0, v245
    v_rcp_f32 v245, v245
    v_mul_f32 v182, v182, v244
    s_waitcnt lgkmcnt(3)
    v_mfma_f32_32x32x16_bf16 v[160:175], v[72:75], v[204:207], v[160:175]
    ds_read_b128 v[200:203], v241 offset:22528
    v_mul_f32 v183, v183, v245
    v_cvt_pk_bf16_f32 v235, v182, v183
    v_cvt_pk_bf16_f32 v243, v184, v185
    v_lshlrev_b32 v184, 16, v243
    v_and_b32 v185, 0xffff0000, v243
    v_add_f32 v184, v184, v224
    v_add_f32 v185, v185, v225
    s_waitcnt lgkmcnt(3)
    v_mfma_f32_32x32x16_bf16 v[160:175], v[76:79], v[208:211], v[160:175]
    ds_read_b128 v[204:207], v241 offset:23552
    v_cvt_pk_bf16_f32 v243, v184, v185
    v_lshlrev_b32 v184, 16, v243
    v_and_b32 v185, 0xffff0000, v243
    v_mul_f32 v244, v184, v184
    v_mul_f32 v244, s41, v244
    v_add_f32 v244, s40, v244
    v_mul_f32 v244, v244, v184
    s_waitcnt lgkmcnt(3)
    v_mfma_f32_32x32x16_bf16 v[160:175], v[80:83], v[192:195], v[160:175]
    ds_read_b128 v[208:211], v241 offset:24576
    v_exp_f32 v244, v244
    v_mul_f32 v245, v185, v185
    v_mul_f32 v245, s41, v245
    v_add_f32 v245, s40, v245
    v_mul_f32 v245, v245, v185
    v_exp_f32 v245, v245
    v_add_f32 v244, 1.0, v244
    s_waitcnt lgkmcnt(3)
    v_mfma_f32_32x32x16_bf16 v[160:175], v[84:87], v[196:199], v[160:175]
    ds_read_b128 v[192:195], v241 offset:25600
    v_rcp_f32 v244, v244
    v_add_f32 v245, 1.0, v245
    v_rcp_f32 v245, v245
    v_mul_f32 v184, v184, v244
    v_mul_f32 v185, v185, v245
    v_cvt_pk_bf16_f32 v236, v184, v185
    v_cvt_pk_bf16_f32 v243, v186, v187
    s_waitcnt lgkmcnt(3)
    v_mfma_f32_32x32x16_bf16 v[160:175], v[88:91], v[200:203], v[160:175]
    ds_read_b128 v[196:199], v241 offset:26624
    v_lshlrev_b32 v186, 16, v243
    v_and_b32 v187, 0xffff0000, v243
    v_add_f32 v186, v186, v226
    v_add_f32 v187, v187, v227
    v_cvt_pk_bf16_f32 v243, v186, v187
    v_lshlrev_b32 v186, 16, v243
    v_and_b32 v187, 0xffff0000, v243
    s_waitcnt lgkmcnt(3)
    v_mfma_f32_32x32x16_bf16 v[160:175], v[92:95], v[204:207], v[160:175]
    ds_read_b128 v[200:203], v241 offset:27648
    v_mul_f32 v244, v186, v186
    v_mul_f32 v244, s41, v244
    v_add_f32 v244, s40, v244
    v_mul_f32 v244, v244, v186
    v_exp_f32 v244, v244
    v_mul_f32 v245, v187, v187
    v_mul_f32 v245, s41, v245
    s_waitcnt lgkmcnt(3)
    v_mfma_f32_32x32x16_bf16 v[160:175], v[96:99], v[208:211], v[160:175]
    ds_read_b128 v[204:207], v241 offset:28672
    v_add_f32 v245, s40, v245
    v_mul_f32 v245, v245, v187
    v_exp_f32 v245, v245
    v_add_f32 v244, 1.0, v244
    v_rcp_f32 v244, v244
    v_add_f32 v245, 1.0, v245
    v_rcp_f32 v245, v245
    s_waitcnt lgkmcnt(3)
    v_mfma_f32_32x32x16_bf16 v[160:175], v[100:103], v[192:195], v[160:175]
    ds_read_b128 v[208:211], v241 offset:29696
    v_mul_f32 v186, v186, v244
    v_mul_f32 v187, v187, v245
    v_cvt_pk_bf16_f32 v237, v186, v187
    v_cvt_pk_bf16_f32 v243, v188, v189
    v_lshlrev_b32 v188, 16, v243
    v_and_b32 v189, 0xffff0000, v243
    v_add_f32 v188, v188, v228
    s_waitcnt lgkmcnt(3)
    v_mfma_f32_32x32x16_bf16 v[160:175], v[104:107], v[196:199], v[160:175]
    ds_read_b128 v[192:195], v241 offset:30720
    v_add_f32 v189, v189, v229
    v_cvt_pk_bf16_f32 v243, v188, v189
    v_lshlrev_b32 v188, 16, v243
    v_and_b32 v189, 0xffff0000, v243
    v_mul_f32 v244, v188, v188
    v_mul_f32 v244, s41, v244
    v_add_f32 v244, s40, v244
    s_waitcnt vmcnt(0)
    s_barrier
    s_cmp_lg_u32 s17, 0
    s_cbranch_scc1 BIG_np_67
    s_sub_u32 s33, s42, 1
    v_mov_b32 v247, s33
    buffer_store_dword v247, v246, s[12:15], s93 offen sc1
BIG_np_67:
    s_add_u32 s35, s42, 3
    s_cmp_ge_u32 s35, 64
    s_cbranch_scc1 BIG_nopf_68
    s_and_b32 s35, s35, 3
    s_mul_i32 s35, s35, 40960
    s_mul_i32 s34, s17, 5120
    s_add_u32 s34, s34, s35
    s_mov_b32 m0, s34
    s_nop 0
    buffer_load_dwordx4 v240, s[12:15], s43 offen offset:0 sc1 lds
    buffer_load_dwordx4 v240, s[12:15], s43 offen offset:1024 sc1 lds
    buffer_load_dwordx4 v240, s[12:15], s43 offen offset:2048 sc1 lds
    buffer_load_dwordx4 v240, s[12:15], s43 offen offset:3072 sc1 lds
    s_add_u32 s34, s34, 4096
    s_mov_b32 m0, s34
    s_add_u32 s33, s43, 4096
    buffer_load_dwordx4 v240, s[12:15], s33 offen sc1 lds
    s_add_u32 s43, s43, 40960
BIG_nopf_68:
    s_waitcnt lgkmcnt(3)
    v_mfma_f32_32x32x16_bf16 v[160:175], v[108:111], v[200:203], v[160:175]
    ds_read_b128 v[196:199], v241 offset:31744
    v_mul_f32 v244, v244, v188
    v_exp_f32 v244, v244
    v_mul_f32 v245, v189, v189
    v_mul_f32 v245, s41, v245
    v_add_f32 v245, s40, v245
    v_mul_f32 v245, v245, v189
    v_exp_f32 v245, v245
    s_waitcnt lgkmcnt(3)
    v_mfma_f32_32x32x16_bf16 v[160:175], v[112:115], v[204:207], v[160:175]
    ds_read_b128 v[200:203], v241 offset:32768
    v_add_f32 v244, 1.0, v244
    v_rcp_f32 v244, v244
    v_add_f32 v245, 1.0, v245
    v_rcp_f32 v245, v245
    v_mul_f32 v188, v188, v244
    v_mul_f32 v189, v189, v245
    v_cvt_pk_bf16_f32 v238, v188, v189
    s_waitcnt lgkmcnt(3)
    v_mfma_f32_32x32x16_bf16 v[160:175], v[116:119], v[208:211], v[160:175]
    ds_read_b128 v[204:207], v241 offset:33792
    v_cvt_pk_bf16_f32 v243, v190, v191
    v_lshlrev_b32 v190, 16, v243
    v_and_b32 v191, 0xffff0000, v243
    v_add_f32 v190, v190, v230
    v_add_f32 v191, v191, v231
    v_cvt_pk_bf16_f32 v243, v190, v191
    v_lshlrev_b32 v190, 16, v243
    s_waitcnt lgkmcnt(3)
    v_mfma_f32_32x32x16_bf16 v[160:175], v[120:123], v[192:195], v[160:175]
    ds_read_b128 v[208:211], v241 offset:34816
    v_and_b32 v191, 0xffff0000, v243
    v_mul_f32 v244, v190, v190
    v_mul_f32 v244, s41, v244
    v_add_f32 v244, s40, v244
    v_mul_f32 v244, v244, v190
    v_exp_f32 v244, v244
    v_mul_f32 v245, v191, v191
    s_waitcnt lgkmcnt(3)
    v_mfma_f32_32x32x16_bf16 v[160:175], v[124:127], v[196:199], v[160:175]
    ds_read_b128 v[192:195], v241 offset:35840
    v_mul_f32 v245, s41, v245
    v_add_f32 v245, s40, v245
    v_mul_f32 v245, v245, v191
    v_exp_f32 v245, v245
    v_add_f32 v244, 1.0, v244
    v_rcp_f32 v244, v244
    v_add_f32 v245, 1.0, v245
    s_waitcnt lgkmcnt(3)
    v_mfma_f32_32x32x16_bf16 v[160:175], v[128:131], v[200:203], v[160:175]
    ds_read_b128 v[196:199], v241 offset:36864
    v_rcp_f32 v245, v245
    v_mul_f32 v190, v190, v244
    v_mul_f32 v191, v191, v245
    v_cvt_pk_bf16_f32 v239, v190, v191
    buffer_store_dwordx4 v[232:235], v242, s[12:15], s44 offen sc1
    buffer_store_dwordx4 v[236:239], v242, s[12:15], s44 offen offset:1024 sc1
    s_waitcnt lgkmcnt(3)
    v_mfma_f32_32x32x16_bf16 v[160:175], v[132:135], v[204:207], v[160:175]
    ds_read_b128 v[200:203], v241 offset:37888
    s_waitcnt lgkmcnt(3)
    v_mfma_f32_32x32x16_bf16 v[160:175], v[136:139], v[208:211], v[160:175]
    ds_read_b128 v[204:207], v241 offset:38912
    s_waitcnt lgkmcnt(3)
    v_mfma_f32_32x32x16_bf16 v[160:175], v[140:143], v[192:195], v[160:175]
    ds_read_b128 v[208:211], v241 offset:39936
    s_waitcnt lgkmcnt(3)
    v_mfma_f32_32x32x16_bf16 v[160:175], v[144:147], v[196:199], v[160:175]
    ds_read_b128 v[192:195], v248 offset:0
    s_waitcnt lgkmcnt(3)
    v_mfma_f32_32x32x16_bf16 v[160:175], v[148:151], v[200:203], v[160:175]
    ds_read_b128 v[196:199], v248 offset:1024
    s_waitcnt lgkmcnt(3)
    v_mfma_f32_32x32x16_bf16 v[160:175], v[152:155], v[204:207], v[160:175]
    ds_read_b128 v[200:203], v248 offset:2048
    s_waitcnt lgkmcnt(3)
    v_mfma_f32_32x32x16_bf16 v[160:175], v[156:159], v[208:211], v[160:175]
    ds_read_b128 v[204:207], v248 offset:3072
    s_add_u32 s42, s42, 1
    s_add_u32 s44, s44, s22
    s_branch BIG_loop1
BIG_fin1:
    s_nop 15
    s_waitcnt lgkmcnt(0)
    v_cvt_pk_bf16_f32 v243, v176, v177
    v_lshlrev_b32 v176, 16, v243
    v_and_b32 v177, 0xffff0000, v243
    v_add_f32 v176, v176, v216
    v_add_f32 v177, v177, v217
    v_cvt_pk_bf16_f32 v243, v176, v177
    v_lshlrev_b32 v176, 16, v243
    v_and_b32 v177, 0xffff0000, v243
    v_mul_f32 v244, v176, v176
    v_mul_f32 v244, s41, v244
    v_add_f32 v244, s40, v244
    v_mul_f32 v244, v244, v176
    v_exp_f32 v244, v244
    v_mul_f32 v245, v177, v177
    v_mul_f32 v245, s41, v245
    v_add_f32 v245, s40, v245
    v_mul_f32 v245, v245, v177
    v_exp_f32 v245, v245
    v_add_f32 v244, 1.0, v244
    v_rcp_f32 v244, v244
    v_add_f32 v245, 1.0, v245
    v_rcp_f32 v245, v245
    v_mul_f32 v176, v176, v244
    v_mul_f32 v177, v177, v245
    v_cvt_pk_bf16_f32 v232, v176, v177
    v_cvt_pk_bf16_f32 v243, v178, v179
    v_lshlrev_b32 v178, 16, v243
    v_and_b32 v179, 0xffff0000, v243
    v_add_f32 v178, v178, v218
    v_add_f32 v179, v179, v219
    v_cvt_pk_bf16_f32 v243, v178, v179
    v_lshlrev_b32 v178, 16, v243
    v_and_b32 v179, 0xffff0000, v243
    v_mul_f32 v244, v178, v178
    v_mul_f32 v244, s41, v244
    v_add_f32 v244, s40, v244
    v_mul_f32 v244, v244, v178
    v_exp_f32 v244, v244
    v_mul_f32 v245, v179, v179
    v_mul_f32 v245, s41, v245
    v_add_f32 v245, s40, v245
    v_mul_f32 v245, v245, v179
    v_exp_f32 v245, v245
    v_add_f32 v244, 1.0, v244
    v_rcp_f32 v244, v244
    v_add_f32 v245, 1.0, v245
    v_rcp_f32 v245, v245
    v_mul_f32 v178, v178, v244
    v_mul_f32 v179, v179, v245
    v_cvt_pk_bf16_f32 v233, v178, v179
    v_cvt_pk_bf16_f32 v243, v180, v181
    v_lshlrev_b32 v180, 16, v243
    v_and_b32 v181, 0xffff0000, v243
    v_add_f32 v180, v180, v220
    v_add_f32 v181, v181, v221
    v_cvt_pk_bf16_f32 v243, v180, v181
    v_lshlrev_b32 v180, 16, v243
    v_and_b32 v181, 0xffff0000, v243
    v_mul_f32 v244, v180, v180
    v_mul_f32 v244, s41, v244
    v_add_f32 v244, s40, v244
    v_mul_f32 v244, v244, v180
    v_exp_f32 v244, v244
    v_mul_f32 v245, v181, v181
    v_mul_f32 v245, s41, v245
    v_add_f32 v245, s40, v245
    v_mul_f32 v245, v245, v181
    v_exp_f32 v245, v245
    v_add_f32 v244, 1.0, v244
    v_rcp_f32 v244, v244
    v_add_f32 v245, 1.0, v245
    v_rcp_f32 v245, v245
    v_mul_f32 v180, v180, v244
    v_mul_f32 v181, v181, v245
    v_cvt_pk_bf16_f32 v234, v180, v181
    v_cvt_pk_bf16_f32 v243, v182, v183
    v_lshlrev_b32 v182, 16, v243
    v_and_b32 v183, 0xffff0000, v243
    v_add_f32 v182, v182, v222
    v_add_f32 v183, v183, v223
    v_cvt_pk_bf16_f32 v243, v182, v183
    v_lshlrev_b32 v182, 16, v243
    v_and_b32 v183, 0xffff0000, v243
    v_mul_f32 v244, v182, v182
    v_mul_f32 v244, s41, v244
    v_add_f32 v244, s40, v244
    v_mul_f32 v244, v244, v182
    v_exp_f32 v244, v244
    v_mul_f32 v245, v183, v183
    v_mul_f32 v245, s41, v245
    v_add_f32 v245, s40, v245
    v_mul_f32 v245, v245, v183
    v_exp_f32 v245, v245
    v_add_f32 v244, 1.0, v244
    v_rcp_f32 v244, v244
    v_add_f32 v245, 1.0, v245
    v_rcp_f32 v245, v245
    v_mul_f32 v182, v182, v244
    v_mul_f32 v183, v183, v245
    v_cvt_pk_bf16_f32 v235, v182, v183
    v_cvt_pk_bf16_f32 v243, v184, v185
    v_lshlrev_b32 v184, 16, v243
    v_and_b32 v185, 0xffff0000, v243
    v_add_f32 v184, v184, v224
    v_add_f32 v185, v185, v225
    v_cvt_pk_bf16_f32 v243, v184, v185
    v_lshlrev_b32 v184, 16, v243
    v_and_b32 v185, 0xffff0000, v243
    v_mul_f32 v244, v184, v184
    v_mul_f32 v244, s41, v244
    v_add_f32 v244, s40, v244
    v_mul_f32 v244, v244, v184
    v_exp_f32 v244, v244
    v_mul_f32 v245, v185, v185
    v_mul_f32 v245, s41, v245
    v_add_f32 v245, s40, v245
    v_mul_f32 v245, v245, v185
    v_exp_f32 v245, v245
    v_add_f32 v244, 1.0, v244
    v_rcp_f32 v244, v244
    v_add_f32 v245, 1.0, v245
    v_rcp_f32 v245, v245
    v_mul_f32 v184, v184, v244
    v_mul_f32 v185, v185, v245
    v_cvt_pk_bf16_f32 v236, v184, v185
    v_cvt_pk_bf16_f32 v243, v186, v187
    v_lshlrev_b32 v186, 16, v243
    v_and_b32 v187, 0xffff0000, v243
    v_add_f32 v186, v186, v226
    v_add_f32 v187, v187, v227
    v_cvt_pk_bf16_f32 v243, v186, v187
    v_lshlrev_b32 v186, 16, v243
    v_and_b32 v187, 0xffff0000, v243
    v_mul_f32 v244, v186, v186
    v_mul_f32 v244, s41, v244
    v_add_f32 v244, s40, v244
    v_mul_f32 v244, v244, v186
    v_exp_f32 v244, v244
    v_mul_f32 v245, v187, v187
    v_mul_f32 v245, s41, v245
    v_add_f32 v245, s40, v245
    v_mul_f32 v245, v245, v187
    v_exp_f32 v245, v245
    v_add_f32 v244, 1.0, v244
    v_rcp_f32 v244, v244
    v_add_f32 v245, 1.0, v245
    v_rcp_f32 v245, v245
    v_mul_f32 v186, v186, v244
    v_mul_f32 v187, v187, v245
    v_cvt_pk_bf16_f32 v237, v186, v187
    v_cvt_pk_bf16_f32 v243, v188, v189
    v_lshlrev_b32 v188, 16, v243
    v_and_b32 v189, 0xffff0000, v243
    v_add_f32 v188, v188, v228
    v_add_f32 v189, v189, v229
    v_cvt_pk_bf16_f32 v243, v188, v189
    v_lshlrev_b32 v188, 16, v243
    v_and_b32 v189, 0xffff0000, v243
    v_mul_f32 v244, v188, v188
    v_mul_f32 v244, s41, v244
    v_add_f32 v244, s40, v244
    v_mul_f32 v244, v244, v188
    v_exp_f32 v244, v244
    v_mul_f32 v245, v189, v189
    v_mul_f32 v245, s41, v245
    v_add_f32 v245, s40, v245
    v_mul_f32 v245, v245, v189
    v_exp_f32 v245, v245
    v_add_f32 v244, 1.0, v244
    v_rcp_f32 v244, v244
    v_add_f32 v245, 1.0, v245
    v_rcp_f32 v245, v245
    v_mul_f32 v188, v188, v244
    v_mul_f32 v189, v189, v245
    v_cvt_pk_bf16_f32 v238, v188, v189
    v_cvt_pk_bf16_f32 v243, v190, v191
    v_lshlrev_b32 v190, 16, v243
    v_and_b32 v191, 0xffff0000, v243
    v_add_f32 v190, v190, v230
    v_add_f32 v191, v191, v231
    v_cvt_pk_bf16_f32 v243, v190, v191
    v_lshlrev_b32 v190, 16, v243
    v_and_b32 v191, 0xffff0000, v243
    v_mul_f32 v244, v190, v190
    v_mul_f32 v244, s41, v244
    v_add_f32 v244, s40, v244
    v_mul_f32 v244, v244, v190
    v_exp_f32 v244, v244
    v_mul_f32 v245, v191, v191
    v_mul_f32 v245, s41, v245
    v_add_f32 v245, s40, v245
    v_mul_f32 v245, v245, v191
    v_exp_f32 v245, v245
    v_add_f32 v244, 1.0, v244
    v_rcp_f32 v244, v244
    v_add_f32 v245, 1.0, v245
    v_rcp_f32 v245, v245
    v_mul_f32 v190, v190, v244
    v_mul_f32 v191, v191, v245
    v_cvt_pk_bf16_f32 v239, v190, v191
    buffer_store_dwordx4 v[232:235], v242, s[12:15], s44 offen sc1
    buffer_store_dwordx4 v[236:239], v242, s[12:15], s44 offen offset:1024 sc1
    s_waitcnt vmcnt(0)
    s_barrier
    s_cmp_lg_u32 s17, 0
    s_cbranch_scc1 BIG_np_69
    s_add_u32 s33, s42, 0
    v_mov_b32 v247, s33
    buffer_store_dword v247, v246, s[12:15], s93 offen sc1
BIG_np_69:
    s_branch BIG_done
BIG_idle:
    s_waitcnt vmcnt(0)
    s_barrier
    s_add_u32 s35, s42, 3
    s_cmp_ge_u32 s35, 64
    s_cbranch_scc1 BIG_nopf_70
    s_and_b32 s35, s35, 3
    s_mul_i32 s35, s35, 40960
    s_mul_i32 s34, s17, 5120
    s_add_u32 s34, s34, s35
    s_mov_b32 m0, s34
    s_nop 0
    buffer_load_dwordx4 v240, s[12:15], s43 offen offset:0 sc1 lds
    buffer_load_dwordx4 v240, s[12:15], s43 offen offset:1024 sc1 lds
    buffer_load_dwordx4 v240, s[12:15], s43 offen offset:2048 sc1 lds
    buffer_load_dwordx4 v240, s[12:15], s43 offen offset:3072 sc1 lds
    s_add_u32 s34, s34, 4096
    s_mov_b32 m0, s34
    s_add_u32 s33, s43, 4096
    buffer_load_dwordx4 v240, s[12:15], s33 offen sc1 lds
    s_add_u32 s43, s43, 40960
BIG_nopf_70:
    s_add_u32 s42, s42, 1
    s_cmp_lt_u32 s42, 64
    s_cbranch_scc1 BIG_idle
    s_barrier
BIG_done:
    s_branch MAIN_post
MAIN_small:
    s_sub_u32 s16, s16, 84
    s_load_dwordx2 s[4:5], s[0:1], 112
    s_cmp_ge_u32 s16, 32
    s_cbranch_scc1 SM_rg
    s_load_dwordx2 s[6:7], s[0:1], 40
    s_mov_b32 s10, 7864320
    s_mov_b32 s27, s16
    s_mul_i32 s20, s16, 12288
    s_add_u32 s20, s20, 59768832
    s_mov_b32 s23, 393216
    s_mul_i32 s21, s16, 40960
    s_add_u32 s21, s21, 91226112
    s_mov_b32 s22, 1310720
    s_mov_b32 s26, 2048
    s_mul_i32 s46, s16, 6
    s_mov_b32 s51, 3
    s_mov_b32 s52, 48
    s_branch SM_rdone
SM_rg:
    s_load_dwordx2 s[6:7], s[0:1], 80
    s_mov_b32 s10, 1966080
    s_sub_u32 s27, s16, 32
    s_mul_i32 s20, s27, 12288
    s_add_u32 s20, s20, 84934656
    s_mov_b32 s23, 98304
    s_mul_i32 s21, s27, 40960
    s_add_u32 s21, s21, 175112192
    s_mov_b32 s22, 327680
    s_mov_b32 s26, 2048
    s_mul_i32 s46, s27, 6
    s_mov_b32 s51, 2
    s_mov_b32 s52, 72
SM_rdone:
    s_mul_i32 s19, s27, 245760
    s_mul_i32 s28, s17, 3
    s_lshl_b32 s29, s17, 1
    s_add_u32 s29, s29, 4
    s_cmp_lt_u32 s17, 4
    s_cselect_b32 s28, s28, s29
    s_mul_i32 s29, s28, s26
    s_add_u32 s21, s21, s29
    s_waitcnt lgkmcnt(0)
    s_mov_b32 s8, s6
    s_mov_b32 s9, s7
    s_mov_b32 s11, 0x00020000
    s_mov_b32 s12, s4
    s_mov_b32 s13, s5
    s_mov_b32 s14, 268435456
    s_mov_b32 s15, 0x00020000
    s_lshl_b32 s30, s17, 6
    s_add_u32 s30, s30, 0
    v_add_u32 v224, s30, v255
    v_mul_u32_u24 v225, 52429, v224
    v_lshrrev_b32 v225, 22, v225
    v_mul_u32_u24 v226, 80, v225
    v_sub_u32 v226, v224, v226
    v_and_b32 v227, 3, v225
    v_lshlrev_b32 v227, 2, v227
    v_xor_b32 v226, v226, v227
    v_mul_u32_u24 v225, 1280, v225
    v_lshl_add_u32 v144, v226, 4, v225
    s_lshl_b32 s30, s17, 6
    s_add_u32 s30, s30, 512
    v_add_u32 v224, s30, v255
    v_mul_u32_u24 v225, 52429, v224
    v_lshrrev_b32 v225, 22, v225
    v_mul_u32_u24 v226, 80, v225
    v_sub_u32 v226, v224, v226
    v_and_b32 v227, 3, v225
    v_lshlrev_b32 v227, 2, v227
    v_xor_b32 v226, v226, v227
    v_mul_u32_u24 v225, 1280, v225
    v_lshl_add_u32 v145, v226, 4, v225
    s_lshl_b32 s30, s17, 6
    s_add_u32 s30, s30, 1024
    v_add_u32 v224, s30, v255
    v_mul_u32_u24 v225, 52429, v224
    v_lshrrev_b32 v225, 22, v225
    v_mul_u32_u24 v226, 80, v225
    v_sub_u32 v226, v224, v226
    v_and_b32 v227, 3, v225
    v_lshlrev_b32 v227, 2, v227
    v_xor_b32 v226, v226, v227
    v_mul_u32_u24 v225, 1280, v225
    v_lshl_add_u32 v146, v226, 4, v225
    s_lshl_b32 s30, s17, 6
    s_add_u32 s30, s30, 1536
    v_add_u32 v224, s30, v255
    v_mul_u32_u24 v225, 52429, v224
    v_lshrrev_b32 v225, 22, v225
    v_mul_u32_u24 v226, 80, v225
    v_sub_u32 v226, v224, v226
    v_and_b32 v227, 3, v225
    v_lshlrev_b32 v227, 2, v227
    v_xor_b32 v226, v226, v227
    v_mul_u32_u24 v225, 1280, v225
    v_lshl_add_u32 v147, v226, 4, v225
    s_lshl_b32 s30, s17, 6
    s_add_u32 s30, s30, 2048
    v_add_u32 v224, s30, v255
    v_mul_u32_u24 v225, 52429, v224
    v_lshrrev_b32 v225, 22, v225
    v_mul_u32_u24 v226, 80, v225
    v_sub_u32 v226, v224, v226
    v_and_b32 v227, 3, v225
    v_lshlrev_b32 v227, 2, v227
    v_xor_b32 v226, v226, v227
    v_mul_u32_u24 v225, 1280, v225
    v_lshl_add_u32 v148, v226, 4, v225
    v_lshrrev_b32 v224, 5, v255
    v_lshlrev_b32 v224, 2, v224
    v_bfe_u32 v225, v255, 2, 2
    v_add_u32 v224, v224, v225
    v_mul_u32_u24 v224, 1280, v224
    v_bfe_u32 v226, v255, 4, 1
    v_lshl_add_u32 v224, v226, 5, v224
    v_and_b32 v226, 3, v255
    v_lshl_add_u32 v224, v226, 3, v224
    s_add_u32 s30, s28, 0
    s_min_u32 s30, s30, 19
    v_xor_b32 v226, s30, v225
    v_lshl_add_u32 v152, v226, 6, v224
    s_add_u32 s30, s28, 1
    s_min_u32 s30, s30, 19
    v_xor_b32 v226, s30, v225
    v_lshl_add_u32 v153, v226, 6, v224
    s_add_u32 s30, s28, 2
    s_min_u32 s30, s30, 19
    v_xor_b32 v226, s30, v225
    v_lshl_add_u32 v154, v226, 6, v224
    s_add_u32 s33, s19, 0
    s_lshl_b32 s34, s17, 10
    s_add_u32 s34, s34, 0
    s_mov_b32 m0, s34
    s_nop 0
    buffer_load_dwordx4 v144, s[8:11], s33 offen lds
    s_lshl_b32 s34, s17, 10
    s_add_u32 s34, s34, 8192
    s_mov_b32 m0, s34
    s_nop 0
    buffer_load_dwordx4 v145, s[8:11], s33 offen lds
    s_lshl_b32 s34, s17, 10
    s_add_u32 s34, s34, 16384
    s_mov_b32 m0, s34
    s_nop 0
    buffer_load_dwordx4 v146, s[8:11], s33 offen lds
    s_lshl_b32 s34, s17, 10
    s_add_u32 s34, s34, 24576
    s_mov_b32 m0, s34
    s_nop 0
    buffer_load_dwordx4 v147, s[8:11], s33 offen lds
    s_lshl_b32 s34, s17, 10
    s_add_u32 s34, s34, 32768
    s_mov_b32 m0, s34
    s_nop 0
    buffer_load_dwordx4 v148, s[8:11], s33 offen lds
    s_add_u32 s33, s19, 40960
    s_lshl_b32 s34, s17, 10
    s_add_u32 s34, s34, 40960
    s_mov_b32 m0, s34
    s_nop 0
    buffer_load_dwordx4 v144, s[8:11], s33 offen lds
    s_lshl_b32 s34, s17, 10
    s_add_u32 s34, s34, 49152
    s_mov_b32 m0, s34
    s_nop 0
    buffer_load_dwordx4 v145, s[8:11], s33 offen lds
    s_lshl_b32 s34, s17, 10
    s_add_u32 s34, s34, 57344
    s_mov_b32 m0, s34
    s_nop 0
    buffer_load_dwordx4 v146, s[8:11], s33 offen lds
    s_lshl_b32 s34, s17, 10
    s_add_u32 s34, s34, 65536
    s_mov_b32 m0, s34
    s_nop 0
    buffer_load_dwordx4 v147, s[8:11], s33 offen lds
    s_lshl_b32 s34, s17, 10
    s_add_u32 s34, s34, 73728
    s_mov_b32 m0, s34
    s_nop 0
    buffer_load_dwordx4 v148, s[8:11], s33 offen lds
    s_add_u32 s33, s19, 81920
    s_lshl_b32 s34, s17, 10
    s_add_u32 s34, s34, 81920
    s_mov_b32 m0, s34
    s_nop 0
    buffer_load_dwordx4 v144, s[8:11], s33 offen lds
    s_lshl_b32 s34, s17, 10
    s_add_u32 s34, s34, 90112
    s_mov_b32 m0, s34
    s_nop 0
    buffer_load_dwordx4 v145, s[8:11], s33 offen lds
    s_lshl_b32 s34, s17, 10
    s_add_u32 s34, s34, 98304
    s_mov_b32 m0, s34
    s_nop 0
    buffer_load_dwordx4 v146, s[8:11], s33 offen lds
    s_lshl_b32 s34, s17, 10
    s_add_u32 s34, s34, 106496
    s_mov_b32 m0, s34
    s_nop 0
    buffer_load_dwordx4 v147, s[8:11], s33 offen lds
    s_lshl_b32 s34, s17, 10
    s_add_u32 s34, s34, 114688
    s_mov_b32 m0, s34
    s_nop 0
    buffer_load_dwordx4 v148, s[8:11], s33 offen lds
    s_add_u32 s33, s19, 122880
    s_lshl_b32 s34, s17, 10
    s_add_u32 s34, s34, 122880
    s_mov_b32 m0, s34
    s_nop 0
    buffer_load_dwordx4 v144, s[8:11], s33 offen lds
    s_lshl_b32 s34, s17, 10
    s_add_u32 s34, s34, 131072
    s_mov_b32 m0, s34
    s_nop 0
    buffer_load_dwordx4 v145, s[8:11], s33 offen lds
    s_lshl_b32 s34, s17, 10
    s_add_u32 s34, s34, 139264
    s_mov_b32 m0, s34
    s_nop 0
    buffer_load_dwordx4 v146, s[8:11], s33 offen lds
    s_lshl_b32 s34, s17, 10
    s_add_u32 s34, s34, 147456
    s_mov_b32 m0, s34
    s_nop 0
    buffer_load_dwordx4 v147, s[8:11], s33 offen lds
    s_lshl_b32 s34, s17, 10
    s_add_u32 s34, s34, 155648
    s_mov_b32 m0, s34
    s_nop 0
    buffer_load_dwordx4 v148, s[8:11], s33 offen lds
    s_waitcnt vmcnt(15)
    s_barrier
    v_add_u32 v228, 0, v152
    ds_read_b64_tr_b16 v[0:1], v228 offset:0
    ds_read_b64_tr_b16 v[2:3], v228 offset:10240
    ds_read_b64_tr_b16 v[4:5], v228 offset:20480
    ds_read_b64_tr_b16 v[6:7], v228 offset:30720
    v_add_u32 v228, 0, v153
    ds_read_b64_tr_b16 v[48:49], v228 offset:0
    ds_read_b64_tr_b16 v[50:51], v228 offset:10240
    ds_read_b64_tr_b16 v[52:53], v228 offset:20480
    ds_read_b64_tr_b16 v[54:55], v228 offset:30720
    v_add_u32 v228, 0, v154
    ds_read_b64_tr_b16 v[96:97], v228 offset:0
    ds_read_b64_tr_b16 v[98:99], v228 offset:10240
    ds_read_b64_tr_b16 v[100:101], v228 offset:20480
    ds_read_b64_tr_b16 v[102:103], v228 offset:30720
    s_waitcnt lgkmcnt(0)
    s_barrier
    s_add_u32 s33, s19, 163840
    s_lshl_b32 s34, s17, 10
    s_add_u32 s34, s34, 0
    s_mov_b32 m0, s34
    s_nop 0
    buffer_load_dwordx4 v144, s[8:11], s33 offen lds
    s_lshl_b32 s34, s17, 10
    s_add_u32 s34, s34, 8192
    s_mov_b32 m0, s34
    s_nop 0
    buffer_load_dwordx4 v145, s[8:11], s33 offen lds
    s_lshl_b32 s34, s17, 10
    s_add_u32 s34, s34, 16384
    s_mov_b32 m0, s34
    s_nop 0
    buffer_load_dwordx4 v146, s[8:11], s33 offen lds
    s_lshl_b32 s34, s17, 10
    s_add_u32 s34, s34, 24576
    s_mov_b32 m0, s34
    s_nop 0
    buffer_load_dwordx4 v147, s[8:11], s33 offen lds
    s_lshl_b32 s34, s17, 10
    s_add_u32 s34, s34, 32768
    s_mov_b32 m0, s34
    s_nop 0
    buffer_load_dwordx4 v148, s[8:11], s33 offen lds
    s_waitcnt vmcnt(15)
    s_barrier
    v_add_u32 v228, 40960, v152
    ds_read_b64_tr_b16 v[8:9], v228 offset:0
    ds_read_b64_tr_b16 v[10:11], v228 offset:10240
    ds_read_b64_tr_b16 v[12:13], v228 offset:20480
    ds_read_b64_tr_b16 v[14:15], v228 offset:30720
    v_add_u32 v228, 40960, v153
    ds_read_b64_tr_b16 v[56:57], v228 offset:0
    ds_read_b64_tr_b16 v[58:59], v228 offset:10240
    ds_read_b64_tr_b16 v[60:61], v228 offset:20480
    ds_read_b64_tr_b16 v[62:63], v228 offset:30720
    v_add_u32 v228, 40960, v154
    ds_read_b64_tr_b16 v[104:105], v228 offset:0
    ds_read_b64_tr_b16 v[106:107], v228 offset:10240
    ds_read_b64_tr_b16 v[108:109], v228 offset:20480
    ds_read_b64_tr_b16 v[110:111], v228 offset:30720
    s_waitcnt lgkmcnt(0)
    s_barrier
    s_add_u32 s33, s19, 204800
    s_lshl_b32 s34, s17, 10
    s_add_u32 s34, s34, 40960
    s_mov_b32 m0, s34
    s_nop 0
    buffer_load_dwordx4 v144, s[8:11], s33 offen lds
    s_lshl_b32 s34, s17, 10
    s_add_u32 s34, s34, 49152
    s_mov_b32 m0, s34
    s_nop 0
    buffer_load_dwordx4 v145, s[8:11], s33 offen lds
    s_lshl_b32 s34, s17, 10
    s_add_u32 s34, s34, 57344
    s_mov_b32 m0, s34
    s_nop 0
    buffer_load_dwordx4 v146, s[8:11], s33 offen lds
    s_lshl_b32 s34, s17, 10
    s_add_u32 s34, s34, 65536
    s_mov_b32 m0, s34
    s_nop 0
    buffer_load_dwordx4 v147, s[8:11], s33 offen lds
    s_lshl_b32 s34, s17, 10
    s_add_u32 s34, s34, 73728
    s_mov_b32 m0, s34
    s_nop 0
    buffer_load_dwordx4 v148, s[8:11], s33 offen lds
    s_waitcnt vmcnt(15)
    s_barrier
    v_add_u32 v228, 81920, v152
    ds_read_b64_tr_b16 v[16:17], v228 offset:0
    ds_read_b64_tr_b16 v[18:19], v228 offset:10240
    ds_read_b64_tr_b16 v[20:21], v228 offset:20480
    ds_read_b64_tr_b16 v[22:23], v228 offset:30720
    v_add_u32 v228, 81920, v153
    ds_read_b64_tr_b16 v[64:65], v228 offset:0
    ds_read_b64_tr_b16 v[66:67], v228 offset:10240
    ds_read_b64_tr_b16 v[68:69], v228 offset:20480
    ds_read_b64_tr_b16 v[70:71], v228 offset:30720
    v_add_u32 v228, 81920, v154
    ds_read_b64_tr_b16 v[112:113], v228 offset:0
    ds_read_b64_tr_b16 v[114:115], v228 offset:10240
    ds_read_b64_tr_b16 v[116:117], v228 offset:20480
    ds_read_b64_tr_b16 v[118:119], v228 offset:30720
    s_waitcnt lgkmcnt(0)
    s_barrier
    s_waitcnt vmcnt(10)
    s_barrier
    v_add_u32 v228, 122880, v152
    ds_read_b64_tr_b16 v[24:25], v228 offset:0
    ds_read_b64_tr_b16 v[26:27], v228 offset:10240
    ds_read_b64_tr_b16 v[28:29], v228 offset:20480
    ds_read_b64_tr_b16 v[30:31], v228 offset:30720
    v_add_u32 v228, 122880, v153
    ds_read_b64_tr_b16 v[72:73], v228 offset:0
    ds_read_b64_tr_b16 v[74:75], v228 offset:10240
    ds_read_b64_tr_b16 v[76:77], v228 offset:20480
    ds_read_b64_tr_b16 v[78:79], v228 offset:30720
    v_add_u32 v228, 122880, v154
    ds_read_b64_tr_b16 v[120:121], v228 offset:0
    ds_read_b64_tr_b16 v[122:123], v228 offset:10240
    ds_read_b64_tr_b16 v[124:125], v228 offset:20480
    ds_read_b64_tr_b16 v[126:127], v228 offset:30720
    s_waitcnt lgkmcnt(0)
    s_barrier
    s_waitcnt vmcnt(5)
    s_barrier
    v_add_u32 v228, 0, v152
    ds_read_b64_tr_b16 v[32:33], v228 offset:0
    ds_read_b64_tr_b16 v[34:35], v228 offset:10240
    ds_read_b64_tr_b16 v[36:37], v228 offset:20480
    ds_read_b64_tr_b16 v[38:39], v228 offset:30720
    v_add_u32 v228, 0, v153
    ds_read_b64_tr_b16 v[80:81], v228 offset:0
    ds_read_b64_tr_b16 v[82:83], v228 offset:10240
    ds_read_b64_tr_b16 v[84:85], v228 offset:20480
    ds_read_b64_tr_b16 v[86:87], v228 offset:30720
    v_add_u32 v228, 0, v154
    ds_read_b64_tr_b16 v[128:129], v228 offset:0
    ds_read_b64_tr_b16 v[130:131], v228 offset:10240
    ds_read_b64_tr_b16 v[132:133], v228 offset:20480
    ds_read_b64_tr_b16 v[134:135], v228 offset:30720
    s_waitcnt lgkmcnt(0)
    s_barrier
    s_waitcnt vmcnt(0)
    s_barrier
    v_add_u32 v228, 40960, v152
    ds_read_b64_tr_b16 v[40:41], v228 offset:0
    ds_read_b64_tr_b16 v[42:43], v228 offset:10240
    ds_read_b64_tr_b16 v[44:45], v228 offset:20480
    ds_read_b64_tr_b16 v[46:47], v228 offset:30720
    v_add_u32 v228, 40960, v153
    ds_read_b64_tr_b16 v[88:89], v228 offset:0
    ds_read_b64_tr_b16 v[90:91], v228 offset:10240
    ds_read_b64_tr_b16 v[92:93], v228 offset:20480
    ds_read_b64_tr_b16 v[94:95], v228 offset:30720
    v_add_u32 v228, 40960, v154
    ds_read_b64_tr_b16 v[136:137], v228 offset:0
    ds_read_b64_tr_b16 v[138:139], v228 offset:10240
    ds_read_b64_tr_b16 v[140:141], v228 offset:20480
    ds_read_b64_tr_b16 v[142:143], v228 offset:30720
    s_waitcnt lgkmcnt(0)
    s_barrier
    v_min_u32 v243, 5, v255
    v_add_u32 v243, s46, v243
    v_lshrrev_b32 v243, s51, v243
    v_add_u32 v243, s52, v243
    v_lshlrev_b32 v243, 6, v243
    v_add_u32 v243, 3637248, v243
    v_mov_b32 v244, 0
    s_lshl_b32 s47, s16, 4
    s_add_u32 s47, s47, s17
    s_lshl_b32 s47, s47, 2
    s_add_u32 s47, s47, 3604480
    v_mov_b32 v245, s47
    s_mov_b32 s48, 8000000
    v_mov_b32 v148, 0
    s_mov_b32 s73, 3000000
    s_mov_b32 s93, 0
WINI_71:
    buffer_load_dwordx4 v[144:147], v148, s[68:71], 0 offen sc1
    s_sub_u32 s73, s73, 1
    s_cbranch_scc1 WINI_71_ok
    s_waitcnt vmcnt(0)
    v_readfirstlane_b32 s72, v146
    s_cmp_lt_u32 s72, 64
    s_cbranch_scc1 WINI_71_sl
    v_readfirstlane_b32 s93, v147
    s_cmp_lg_u32 s93, 0
    s_cbranch_scc1 WINI_71_ok
WINI_71_sl:
    s_sleep 8
    s_branch WINI_71
WINI_71_ok:
    s_waitcnt vmcnt(0)
    s_and_b32 s93, s93, 8192
    v_lshlrev_b32 v240, 4, v255
    s_lshl_b32 s30, s17, 10
    v_add_u32 v242, s30, v240
    s_cmp_ge_u32 s16, 32
    s_cbranch_scc1 SM_gsel
    s_cmp_ge_u32 s17, 4
    s_cbranch_scc1 SM_v02
    s_mov_b32 s43, s20
    s_mov_b32 s35, 0
    s_mov_b32 s49, 1
    v_cmp_gt_u32 vcc, s49, v244
    s_cbranch_vccz SM_fok_72
SM_flp_73:
    buffer_load_dword v244, v243, s[12:15], s93 offen sc1
    s_sub_u32 s48, s48, 1
    s_cbranch_scc1 SM_fok_72_x
    s_waitcnt vmcnt(0)
    v_cmp_gt_u32 vcc, s49, v244
    s_cbranch_vccz SM_fok_72
    s_sleep 6
    s_branch SM_flp_73
SM_fok_72_x:
    s_mov_b32 s48, 0
SM_fok_72:
    s_lshl_b32 s34, s17, 10
    s_add_u32 s34, s34, s35
    s_mov_b32 m0, s34
    s_nop 0
    buffer_load_dwordx4 v242, s[12:15], s43 offen sc1 lds
    s_add_u32 s34, s34, 8192
    s_mov_b32 m0, s34
    s_add_u32 s33, s43, 8192
    buffer_load_dwordx4 v242, s[12:15], s33 offen sc1 lds
    s_add_u32 s43, s43, s23
    s_mov_b32 s42, 0
    s_mov_b32 s44, s21
    s_waitcnt vmcnt(0)
SM_loop03:
    s_barrier
    s_and_b32 s35, s42, 3
    s_mul_i32 s35, s35, 12288
    v_add_u32 v241, s35, v240
    ds_read_b128 v[144:147], v241 offset:0
    ds_read_b128 v[148:151], v241 offset:1024
    ds_read_b128 v[152:155], v241 offset:2048
    ds_read_b128 v[156:159], v241 offset:3072
    ds_read_b128 v[160:163], v241 offset:4096
    ds_read_b128 v[164:167], v241 offset:5120
    ds_read_b128 v[168:171], v241 offset:6144
    ds_read_b128 v[172:175], v241 offset:7168
    ds_read_b128 v[176:179], v241 offset:8192
    ds_read_b128 v[180:183], v241 offset:9216
    ds_read_b128 v[184:187], v241 offset:10240
    ds_read_b128 v[188:191], v241 offset:11264
    s_mov_b32 s50, 1
    s_add_u32 s35, s42, 1
    s_cmp_ge_u32 s35, 64
    s_cbranch_scc1 SM_nopf_74
    s_add_u32 s49, s42, 2
    s_mov_b32 s50, 0
    v_cmp_gt_u32 vcc, s49, v244
    s_cbranch_vccnz SM_nopf_74
    s_mov_b32 s50, 1
    s_and_b32 s35, s35, 3
    s_mul_i32 s35, s35, 12288
    s_lshl_b32 s34, s17, 10
    s_add_u32 s34, s34, s35
    s_mov_b32 m0, s34
    s_nop 0
    buffer_load_dwordx4 v242, s[12:15], s43 offen sc1 lds
    s_add_u32 s34, s34, 8192
    s_mov_b32 m0, s34
    s_add_u32 s33, s43, 8192
    buffer_load_dwordx4 v242, s[12:15], s33 offen sc1 lds
    s_add_u32 s43, s43, s23
SM_nopf_74:
    buffer_load_dword v247, v243, s[12:15], s93 offen sc1
    s_waitcnt lgkmcnt(11)
    v_mfma_f32_32x32x16_bf16 v[192:207], v[144:147], v[0:3], 0
    s_waitcnt lgkmcnt(10)
    v_mfma_f32_32x32x16_bf16 v[192:207], v[148:151], v[4:7], v[192:207]
    s_waitcnt lgkmcnt(9)
    v_mfma_f32_32x32x16_bf16 v[192:207], v[152:155], v[8:11], v[192:207]
    s_waitcnt lgkmcnt(8)
    v_mfma_f32_32x32x16_bf16 v[192:207], v[156:159], v[12:15], v[192:207]
    s_waitcnt lgkmcnt(7)
    v_mfma_f32_32x32x16_bf16 v[192:207], v[160:163], v[16:19], v[192:207]
    s_waitcnt lgkmcnt(6)
    v_mfma_f32_32x32x16_bf16 v[192:207], v[164:167], v[20:23], v[192:207]
    s_waitcnt lgkmcnt(5)
    v_mfma_f32_32x32x16_bf16 v[192:207], v[168:171], v[24:27], v[192:207]
    s_waitcnt lgkmcnt(4)
    v_mfma_f32_32x32x16_bf16 v[192:207], v[172:175], v[28:31], v[192:207]
    s_waitcnt lgkmcnt(3)
    v_mfma_f32_32x32x16_bf16 v[192:207], v[176:179], v[32:35], v[192:207]
    s_waitcnt lgkmcnt(2)
    v_mfma_f32_32x32x16_bf16 v[192:207], v[180:183], v[36:39], v[192:207]
    s_waitcnt lgkmcnt(1)
    v_mfma_f32_32x32x16_bf16 v[192:207], v[184:187], v[40:43], v[192:207]
    s_waitcnt lgkmcnt(0)
    v_mfma_f32_32x32x16_bf16 v[192:207], v[188:191], v[44:47], v[192:207]
    v_mfma_f32_32x32x16_bf16 v[208:223], v[144:147], v[48:51], 0
    v_mfma_f32_32x32x16_bf16 v[208:223], v[148:151], v[52:55], v[208:223]
    v_mfma_f32_32x32x16_bf16 v[208:223], v[152:155], v[56:59], v[208:223]
    v_mfma_f32_32x32x16_bf16 v[208:223], v[156:159], v[60:63], v[208:223]
    s_nop 7
    v_cvt_pk_bf16_f32 v224, v192, v193
    v_cvt_pk_bf16_f32 v225, v194, v195
    v_mfma_f32_32x32x16_bf16 v[208:223], v[160:163], v[64:67], v[208:223]
    v_cvt_pk_bf16_f32 v226, v196, v197
    v_cvt_pk_bf16_f32 v227, v198, v199
    v_mfma_f32_32x32x16_bf16 v[208:223], v[164:167], v[68:71], v[208:223]
    v_cvt_pk_bf16_f32 v228, v200, v201
    v_cvt_pk_bf16_f32 v229, v202, v203
    v_mfma_f32_32x32x16_bf16 v[208:223], v[168:171], v[72:75], v[208:223]
    v_cvt_pk_bf16_f32 v230, v204, v205
    v_cvt_pk_bf16_f32 v231, v206, v207
    v_mfma_f32_32x32x16_bf16 v[208:223], v[172:175], v[76:79], v[208:223]
    s_add_u32 s33, s44, 0
    buffer_store_dwordx4 v[224:227], v240, s[12:15], s33 offen sc1
    v_mfma_f32_32x32x16_bf16 v[208:223], v[176:179], v[80:83], v[208:223]
    buffer_store_dwordx4 v[228:231], v240, s[12:15], s33 offen offset:1024 sc1
    v_mfma_f32_32x32x16_bf16 v[208:223], v[180:183], v[84:87], v[208:223]
    v_mfma_f32_32x32x16_bf16 v[208:223], v[184:187], v[88:91], v[208:223]
    v_mfma_f32_32x32x16_bf16 v[208:223], v[188:191], v[92:95], v[208:223]
    v_mfma_f32_32x32x16_bf16 v[192:207], v[144:147], v[96:99], 0
    v_mfma_f32_32x32x16_bf16 v[192:207], v[148:151], v[100:103], v[192:207]
    v_mfma_f32_32x32x16_bf16 v[192:207], v[152:155], v[104:107], v[192:207]
    v_mfma_f32_32x32x16_bf16 v[192:207], v[156:159], v[108:111], v[192:207]
    s_nop 7
    v_cvt_pk_bf16_f32 v224, v208, v209
    v_cvt_pk_bf16_f32 v225, v210, v211
    v_mfma_f32_32x32x16_bf16 v[192:207], v[160:163], v[112:115], v[192:207]
    v_cvt_pk_bf16_f32 v226, v212, v213
    v_cvt_pk_bf16_f32 v227, v214, v215
    v_mfma_f32_32x32x16_bf16 v[192:207], v[164:167], v[116:119], v[192:207]
    v_cvt_pk_bf16_f32 v228, v216, v217
    v_cvt_pk_bf16_f32 v229, v218, v219
    v_mfma_f32_32x32x16_bf16 v[192:207], v[168:171], v[120:123], v[192:207]
    v_cvt_pk_bf16_f32 v230, v220, v221
    v_cvt_pk_bf16_f32 v231, v222, v223
    v_mfma_f32_32x32x16_bf16 v[192:207], v[172:175], v[124:127], v[192:207]
    s_add_u32 s33, s44, 2048
    buffer_store_dwordx4 v[224:227], v240, s[12:15], s33 offen sc1
    v_mfma_f32_32x32x16_bf16 v[192:207], v[176:179], v[128:131], v[192:207]
    buffer_store_dwordx4 v[228:231], v240, s[12:15], s33 offen offset:1024 sc1
    v_mfma_f32_32x32x16_bf16 v[192:207], v[180:183], v[132:135], v[192:207]
    v_mfma_f32_32x32x16_bf16 v[192:207], v[184:187], v[136:139], v[192:207]
    v_mfma_f32_32x32x16_bf16 v[192:207], v[188:191], v[140:143], v[192:207]
    s_nop 11
    v_cvt_pk_bf16_f32 v224, v192, v193
    v_cvt_pk_bf16_f32 v225, v194, v195
    v_cvt_pk_bf16_f32 v226, v196, v197
    v_cvt_pk_bf16_f32 v227, v198, v199
    v_cvt_pk_bf16_f32 v228, v200, v201
    v_cvt_pk_bf16_f32 v229, v202, v203
    v_cvt_pk_bf16_f32 v230, v204, v205
    v_cvt_pk_bf16_f32 v231, v206, v207
    s_add_u32 s33, s44, 4096
    buffer_store_dwordx4 v[224:227], v240, s[12:15], s33 offen sc1
    buffer_store_dwordx4 v[228:231], v240, s[12:15], s33 offen offset:1024 sc1
    s_cmp_eq_u32 s50, 0
    s_cbranch_scc1 SM_blk_76
    s_waitcnt vmcnt(6)
    v_mov_b32 v244, v247
    v_mov_b32 v246, s42
    buffer_store_dword v246, v245, s[12:15], s93 offen sc1
    s_add_u32 s42, s42, 1
    s_add_u32 s44, s44, s22
    s_branch SM_pfd_75
SM_blk_76:
    s_add_u32 s42, s42, 1
    s_add_u32 s44, s44, s22
    s_waitcnt vmcnt(0)
    v_mov_b32 v244, v247
    v_mov_b32 v246, s42
    buffer_store_dword v246, v245, s[12:15], s93 offen sc1
    v_cmp_gt_u32 vcc, s49, v244
    s_cbranch_vccz SM_fok_77
SM_flp_78:
    buffer_load_dword v244, v243, s[12:15], s93 offen sc1
    s_sub_u32 s48, s48, 1
    s_cbranch_scc1 SM_fok_77_x
    s_waitcnt vmcnt(0)
    v_cmp_gt_u32 vcc, s49, v244
    s_cbranch_vccz SM_fok_77
    s_sleep 6
    s_branch SM_flp_78
SM_fok_77_x:
    s_mov_b32 s48, 0
SM_fok_77:
    s_and_b32 s35, s42, 3
    s_mul_i32 s35, s35, 12288
    s_lshl_b32 s34, s17, 10
    s_add_u32 s34, s34, s35
    s_mov_b32 m0, s34
    s_nop 0
    buffer_load_dwordx4 v242, s[12:15], s43 offen sc1 lds
    s_add_u32 s34, s34, 8192
    s_mov_b32 m0, s34
    s_add_u32 s33, s43, 8192
    buffer_load_dwordx4 v242, s[12:15], s33 offen sc1 lds
    s_add_u32 s43, s43, s23
    s_waitcnt vmcnt(0)
SM_pfd_75:
    s_cmp_lt_u32 s42, 64
    s_cbranch_scc1 SM_loop03
    s_waitcnt vmcnt(0)
    v_mov_b32 v246, s42
    buffer_store_dword v246, v245, s[12:15], s93 offen sc1
    s_branch SM_done
SM_v02:
    s_mov_b32 s43, s20
    s_mov_b32 s35, 0
    s_mov_b32 s49, 1
    v_cmp_gt_u32 vcc, s49, v244
    s_cbranch_vccz SM_fok_79
SM_flp_80:
    buffer_load_dword v244, v243, s[12:15], s93 offen sc1
    s_sub_u32 s48, s48, 1
    s_cbranch_scc1 SM_fok_79_x
    s_waitcnt vmcnt(0)
    v_cmp_gt_u32 vcc, s49, v244
    s_cbranch_vccz SM_fok_79
    s_sleep 6
    s_branch SM_flp_80
SM_fok_79_x:
    s_mov_b32 s48, 0
SM_fok_79:
    s_lshl_b32 s34, s17, 10
    s_add_u32 s34, s34, s35
    s_mov_b32 m0, s34
    s_nop 0
    buffer_load_dwordx4 v242, s[12:15], s43 offen sc1 lds
    s_add_u32 s43, s43, s23
    s_mov_b32 s42, 0
    s_mov_b32 s44, s21
    s_waitcnt vmcnt(0)
SM_loop02:
    s_barrier
    s_and_b32 s35, s42, 3
    s_mul_i32 s35, s35, 12288
    v_add_u32 v241, s35, v240
    ds_read_b128 v[144:147], v241 offset:0
    ds_read_b128 v[148:151], v241 offset:1024
    ds_read_b128 v[152:155], v241 offset:2048
    ds_read_b128 v[156:159], v241 offset:3072
    ds_read_b128 v[160:163], v241 offset:4096
    ds_read_b128 v[164:167], v241 offset:5120
    ds_read_b128 v[168:171], v241 offset:6144
    ds_read_b128 v[172:175], v241 offset:7168
    ds_read_b128 v[176:179], v241 offset:8192
    ds_read_b128 v[180:183], v241 offset:9216
    ds_read_b128 v[184:187], v241 offset:10240
    ds_read_b128 v[188:191], v241 offset:11264
    s_mov_b32 s50, 1
    s_add_u32 s35, s42, 1
    s_cmp_ge_u32 s35, 64
    s_cbranch_scc1 SM_nopf_81
    s_add_u32 s49, s42, 2
    s_mov_b32 s50, 0
    v_cmp_gt_u32 vcc, s49, v244
    s_cbranch_vccnz SM_nopf_81
    s_mov_b32 s50, 1
    s_and_b32 s35, s35, 3
    s_mul_i32 s35, s35, 12288
    s_lshl_b32 s34, s17, 10
    s_add_u32 s34, s34, s35
    s_mov_b32 m0, s34
    s_nop 0
    buffer_load_dwordx4 v242, s[12:15], s43 offen sc1 lds
    s_add_u32 s43, s43, s23
SM_nopf_81:
    buffer_load_dword v247, v243, s[12:15], s93 offen sc1
    s_waitcnt lgkmcnt(11)
    v_mfma_f32_32x32x16_bf16 v[192:207], v[144:147], v[0:3], 0
    s_waitcnt lgkmcnt(10)
    v_mfma_f32_32x32x16_bf16 v[192:207], v[148:151], v[4:7], v[192:207]
    s_waitcnt lgkmcnt(9)
    v_mfma_f32_32x32x16_bf16 v[192:207], v[152:155], v[8:11], v[192:207]
    s_waitcnt lgkmcnt(8)
    v_mfma_f32_32x32x16_bf16 v[192:207], v[156:159], v[12:15], v[192:207]
    s_waitcnt lgkmcnt(7)
    v_mfma_f32_32x32x16_bf16 v[192:207], v[160:163], v[16:19], v[192:207]
    s_waitcnt lgkmcnt(6)
    v_mfma_f32_32x32x16_bf16 v[192:207], v[164:167], v[20:23], v[192:207]
    s_waitcnt lgkmcnt(5)
    v_mfma_f32_32x32x16_bf16 v[192:207], v[168:171], v[24:27], v[192:207]
    s_waitcnt lgkmcnt(4)
    v_mfma_f32_32x32x16_bf16 v[192:207], v[172:175], v[28:31], v[192:207]
    s_waitcnt lgkmcnt(3)
    v_mfma_f32_32x32x16_bf16 v[192:207], v[176:179], v[32:35], v[192:207]
    s_waitcnt lgkmcnt(2)
    v_mfma_f32_32x32x16_bf16 v[192:207], v[180:183], v[36:39], v[192:207]
    s_waitcnt lgkmcnt(1)
    v_mfma_f32_32x32x16_bf16 v[192:207], v[184:187], v[40:43], v[192:207]
    s_waitcnt lgkmcnt(0)
    v_mfma_f32_32x32x16_bf16 v[192:207], v[188:191], v[44:47], v[192:207]
    v_mfma_f32_32x32x16_bf16 v[208:223], v[144:147], v[48:51], 0
    v_mfma_f32_32x32x16_bf16 v[208:223], v[148:151], v[52:55], v[208:223]
    v_mfma_f32_32x32x16_bf16 v[208:223], v[152:155], v[56:59], v[208:223]
    v_mfma_f32_32x32x16_bf16 v[208:223], v[156:159], v[60:63], v[208:223]
    s_nop 7
    v_cvt_pk_bf16_f32 v224, v192, v193
    v_cvt_pk_bf16_f32 v225, v194, v195
    v_mfma_f32_32x32x16_bf16 v[208:223], v[160:163], v[64:67], v[208:223]
    v_cvt_pk_bf16_f32 v226, v196, v197
    v_cvt_pk_bf16_f32 v227, v198, v199
    v_mfma_f32_32x32x16_bf16 v[208:223], v[164:167], v[68:71], v[208:223]
    v_cvt_pk_bf16_f32 v228, v200, v201
    v_cvt_pk_bf16_f32 v229, v202, v203
    v_mfma_f32_32x32x16_bf16 v[208:223], v[168:171], v[72:75], v[208:223]
    v_cvt_pk_bf16_f32 v230, v204, v205
    v_cvt_pk_bf16_f32 v231, v206, v207
    v_mfma_f32_32x32x16_bf16 v[208:223], v[172:175], v[76:79], v[208:223]
    s_add_u32 s33, s44, 0
    buffer_store_dwordx4 v[224:227], v240, s[12:15], s33 offen sc1
    v_mfma_f32_32x32x16_bf16 v[208:223], v[176:179], v[80:83], v[208:223]
    buffer_store_dwordx4 v[228:231], v240, s[12:15], s33 offen offset:1024 sc1
    v_mfma_f32_32x32x16_bf16 v[208:223], v[180:183], v[84:87], v[208:223]
    v_mfma_f32_32x32x16_bf16 v[208:223], v[184:187], v[88:91], v[208:223]
    v_mfma_f32_32x32x16_bf16 v[208:223], v[188:191], v[92:95], v[208:223]
    s_nop 11
    v_cvt_pk_bf16_f32 v224, v208, v209
    v_cvt_pk_bf16_f32 v225, v210, v211
    v_cvt_pk_bf16_f32 v226, v212, v213
    v_cvt_pk_bf16_f32 v227, v214, v215
    v_cvt_pk_bf16_f32 v228, v216, v217
    v_cvt_pk_bf16_f32 v229, v218, v219
    v_cvt_pk_bf16_f32 v230, v220, v221
    v_cvt_pk_bf16_f32 v231, v222, v223
    s_add_u32 s33, s44, 2048
    buffer_store_dwordx4 v[224:227], v240, s[12:15], s33 offen sc1
    buffer_store_dwordx4 v[228:231], v240, s[12:15], s33 offen offset:1024 sc1
    s_cmp_eq_u32 s50, 0
    s_cbranch_scc1 SM_blk_83
    s_waitcnt vmcnt(4)
    v_mov_b32 v244, v247
    v_mov_b32 v246, s42
    buffer_store_dword v246, v245, s[12:15], s93 offen sc1
    s_add_u32 s42, s42, 1
    s_add_u32 s44, s44, s22
    s_branch SM_pfd_82
SM_blk_83:
    s_add_u32 s42, s42, 1
    s_add_u32 s44, s44, s22
    s_waitcnt vmcnt(0)
    v_mov_b32 v244, v247
    v_mov_b32 v246, s42
    buffer_store_dword v246, v245, s[12:15], s93 offen sc1
    v_cmp_gt_u32 vcc, s49, v244
    s_cbranch_vccz SM_fok_84
SM_flp_85:
    buffer_load_dword v244, v243, s[12:15], s93 offen sc1
    s_sub_u32 s48, s48, 1
    s_cbranch_scc1 SM_fok_84_x
    s_waitcnt vmcnt(0)
    v_cmp_gt_u32 vcc, s49, v244
    s_cbranch_vccz SM_fok_84
    s_sleep 6
    s_branch SM_flp_85
SM_fok_84_x:
    s_mov_b32 s48, 0
SM_fok_84:
    s_and_b32 s35, s42, 3
    s_mul_i32 s35, s35, 12288
    s_lshl_b32 s34, s17, 10
    s_add_u32 s34, s34, s35
    s_mov_b32 m0, s34
    s_nop 0
    buffer_load_dwordx4 v242, s[12:15], s43 offen sc1 lds
    s_add_u32 s43, s43, s23
    s_waitcnt vmcnt(0)
SM_pfd_82:
    s_cmp_lt_u32 s42, 64
    s_cbranch_scc1 SM_loop02
    s_waitcnt vmcnt(0)
    v_mov_b32 v246, s42
    buffer_store_dword v246, v245, s[12:15], s93 offen sc1
    s_branch SM_done
SM_gsel:
    s_cmp_ge_u32 s17, 4
    s_cbranch_scc1 SM_v12
SM_v13:
    s_mov_b32 s43, s20
    s_mov_b32 s35, 0
    s_mov_b32 s49, 1
    v_cmp_gt_u32 vcc, s49, v244
    s_cbranch_vccz SM_fok_86
SM_flp_87:
    buffer_load_dword v244, v243, s[12:15], s93 offen sc1
    s_sub_u32 s48, s48, 1
    s_cbranch_scc1 SM_fok_86_x
    s_waitcnt vmcnt(0)
    v_cmp_gt_u32 vcc, s49, v244
    s_cbranch_vccz SM_fok_86
    s_sleep 6
    s_branch SM_flp_87
SM_fok_86_x:
    s_mov_b32 s48, 0
SM_fok_86:
    s_lshl_b32 s34, s17, 10
    s_add_u32 s34, s34, s35
    s_mov_b32 m0, s34
    s_nop 0
    buffer_load_dwordx4 v242, s[12:15], s43 offen sc1 lds
    s_add_u32 s34, s34, 8192
    s_mov_b32 m0, s34
    s_add_u32 s33, s43, 8192
    buffer_load_dwordx4 v242, s[12:15], s33 offen sc1 lds
    s_add_u32 s43, s43, s23
    s_mov_b32 s42, 0
    s_mov_b32 s44, s21
    s_waitcnt vmcnt(0)
SM_loop13:
    s_barrier
    s_and_b32 s35, s42, 3
    s_mul_i32 s35, s35, 12288
    v_add_u32 v241, s35, v240
    ds_read_b128 v[144:147], v241 offset:0
    ds_read_b128 v[148:151], v241 offset:1024
    ds_read_b128 v[152:155], v241 offset:2048
    ds_read_b128 v[156:159], v241 offset:3072
    ds_read_b128 v[160:163], v241 offset:4096
    ds_read_b128 v[164:167], v241 offset:5120
    ds_read_b128 v[168:171], v241 offset:6144
    ds_read_b128 v[172:175], v241 offset:7168
    ds_read_b128 v[176:179], v241 offset:8192
    ds_read_b128 v[180:183], v241 offset:9216
    ds_read_b128 v[184:187], v241 offset:10240
    ds_read_b128 v[188:191], v241 offset:11264
    s_mov_b32 s50, 1
    s_add_u32 s35, s42, 1
    s_cmp_ge_u32 s35, 64
    s_cbranch_scc1 SM_nopf_88
    s_add_u32 s49, s42, 2
    s_mov_b32 s50, 0
    v_cmp_gt_u32 vcc, s49, v244
    s_cbranch_vccnz SM_nopf_88
    s_mov_b32 s50, 1
    s_and_b32 s35, s35, 3
    s_mul_i32 s35, s35, 12288
    s_lshl_b32 s34, s17, 10
    s_add_u32 s34, s34, s35
    s_mov_b32 m0, s34
    s_nop 0
    buffer_load_dwordx4 v242, s[12:15], s43 offen sc1 lds
    s_add_u32 s34, s34, 8192
    s_mov_b32 m0, s34
    s_add_u32 s33, s43, 8192
    buffer_load_dwordx4 v242, s[12:15], s33 offen sc1 lds
    s_add_u32 s43, s43, s23
SM_nopf_88:
    buffer_load_dword v247, v243, s[12:15], s93 offen sc1
    s_waitcnt lgkmcnt(11)
    v_mfma_f32_32x32x16_bf16 v[192:207], v[0:3], v[144:147], 0
    s_waitcnt lgkmcnt(10)
    v_mfma_f32_32x32x16_bf16 v[192:207], v[4:7], v[148:151], v[192:207]
    s_waitcnt lgkmcnt(9)
    v_mfma_f32_32x32x16_bf16 v[192:207], v[8:11], v[152:155], v[192:207]
    s_waitcnt lgkmcnt(8)
    v_mfma_f32_32x32x16_bf16 v[192:207], v[12:15], v[156:159], v[192:207]
    s_waitcnt lgkmcnt(7)
    v_mfma_f32_32x32x16_bf16 v[192:207], v[16:19], v[160:163], v[192:207]
    s_waitcnt lgkmcnt(6)
    v_mfma_f32_32x32x16_bf16 v[192:207], v[20:23], v[164:167], v[192:207]
    s_waitcnt lgkmcnt(5)
    v_mfma_f32_32x32x16_bf16 v[192:207], v[24:27], v[168:171], v[192:207]
    s_waitcnt lgkmcnt(4)
    v_mfma_f32_32x32x16_bf16 v[192:207], v[28:31], v[172:175], v[192:207]
    s_waitcnt lgkmcnt(3)
    v_mfma_f32_32x32x16_bf16 v[192:207], v[32:35], v[176:179], v[192:207]
    s_waitcnt lgkmcnt(2)
    v_mfma_f32_32x32x16_bf16 v[192:207], v[36:39], v[180:183], v[192:207]
    s_waitcnt lgkmcnt(1)
    v_mfma_f32_32x32x16_bf16 v[192:207], v[40:43], v[184:187], v[192:207]
    s_waitcnt lgkmcnt(0)
    v_mfma_f32_32x32x16_bf16 v[192:207], v[44:47], v[188:191], v[192:207]
    v_mfma_f32_32x32x16_bf16 v[208:223], v[48:51], v[144:147], 0
    v_mfma_f32_32x32x16_bf16 v[208:223], v[52:55], v[148:151], v[208:223]
    v_mfma_f32_32x32x16_bf16 v[208:223], v[56:59], v[152:155], v[208:223]
    v_mfma_f32_32x32x16_bf16 v[208:223], v[60:63], v[156:159], v[208:223]
    s_nop 7
    v_cvt_pk_bf16_f32 v224, v192, v193
    v_cvt_pk_bf16_f32 v225, v194, v195
    v_mfma_f32_32x32x16_bf16 v[208:223], v[64:67], v[160:163], v[208:223]
    v_cvt_pk_bf16_f32 v226, v196, v197
    v_cvt_pk_bf16_f32 v227, v198, v199
    v_mfma_f32_32x32x16_bf16 v[208:223], v[68:71], v[164:167], v[208:223]
    v_cvt_pk_bf16_f32 v228, v200, v201
    v_cvt_pk_bf16_f32 v229, v202, v203
    v_mfma_f32_32x32x16_bf16 v[208:223], v[72:75], v[168:171], v[208:223]
    v_cvt_pk_bf16_f32 v230, v204, v205
    v_cvt_pk_bf16_f32 v231, v206, v207
    v_mfma_f32_32x32x16_bf16 v[208:223], v[76:79], v[172:175], v[208:223]
    s_add_u32 s33, s44, 0
    buffer_store_dwordx4 v[224:227], v240, s[12:15], s33 offen sc1
    v_mfma_f32_32x32x16_bf16 v[208:223], v[80:83], v[176:179], v[208:223]
    buffer_store_dwordx4 v[228:231], v240, s[12:15], s33 offen offset:1024 sc1
    v_mfma_f32_32x32x16_bf16 v[208:223], v[84:87], v[180:183], v[208:223]
    v_mfma_f32_32x32x16_bf16 v[208:223], v[88:91], v[184:187], v[208:223]
    v_mfma_f32_32x32x16_bf16 v[208:223], v[92:95], v[188:191], v[208:223]
    v_mfma_f32_32x32x16_bf16 v[192:207], v[96:99], v[144:147], 0
    v_mfma_f32_32x32x16_bf16 v[192:207], v[100:103], v[148:151], v[192:207]
    v_mfma_f32_32x32x16_bf16 v[192:207], v[104:107], v[152:155], v[192:207]
    v_mfma_f32_32x32x16_bf16 v[192:207], v[108:111], v[156:159], v[192:207]
    s_nop 7
    v_cvt_pk_bf16_f32 v224, v208, v209
    v_cvt_pk_bf16_f32 v225, v210, v211
    v_mfma_f32_32x32x16_bf16 v[192:207], v[112:115], v[160:163], v[192:207]
    v_cvt_pk_bf16_f32 v226, v212, v213
    v_cvt_pk_bf16_f32 v227, v214, v215
    v_mfma_f32_32x32x16_bf16 v[192:207], v[116:119], v[164:167], v[192:207]
    v_cvt_pk_bf16_f32 v228, v216, v217
    v_cvt_pk_bf16_f32 v229, v218, v219
    v_mfma_f32_32x32x16_bf16 v[192:207], v[120:123], v[168:171], v[192:207]
    v_cvt_pk_bf16_f32 v230, v220, v221
    v_cvt_pk_bf16_f32 v231, v222, v223
    v_mfma_f32_32x32x16_bf16 v[192:207], v[124:127], v[172:175], v[192:207]
    s_add_u32 s33, s44, 2048
    buffer_store_dwordx4 v[224:227], v240, s[12:15], s33 offen sc1
    v_mfma_f32_32x32x16_bf16 v[192:207], v[128:131], v[176:179], v[192:207]
    buffer_store_dwordx4 v[228:231], v240, s[12:15], s33 offen offset:1024 sc1
    v_mfma_f32_32x32x16_bf16 v[192:207], v[132:135], v[180:183], v[192:207]
    v_mfma_f32_32x32x16_bf16 v[192:207], v[136:139], v[184:187], v[192:207]
    v_mfma_f32_32x32x16_bf16 v[192:207], v[140:143], v[188:191], v[192:207]
    s_nop 11
    v_cvt_pk_bf16_f32 v224, v192, v193
    v_cvt_pk_bf16_f32 v225, v194, v195
    v_cvt_pk_bf16_f32 v226, v196, v197
    v_cvt_pk_bf16_f32 v227, v198, v199
    v_cvt_pk_bf16_f32 v228, v200, v201
    v_cvt_pk_bf16_f32 v229, v202, v203
    v_cvt_pk_bf16_f32 v230, v204, v205
    v_cvt_pk_bf16_f32 v231, v206, v207
    s_add_u32 s33, s44, 4096
    buffer_store_dwordx4 v[224:227], v240, s[12:15], s33 offen sc1
    buffer_store_dwordx4 v[228:231], v240, s[12:15], s33 offen offset:1024 sc1
    s_cmp_eq_u32 s50, 0
    s_cbranch_scc1 SM_blk_90
    s_waitcnt vmcnt(6)
    v_mov_b32 v244, v247
    v_mov_b32 v246, s42
    buffer_store_dword v246, v245, s[12:15], s93 offen sc1
    s_add_u32 s42, s42, 1
    s_add_u32 s44, s44, s22
    s_branch SM_pfd_89
SM_blk_90:
    s_add_u32 s42, s42, 1
    s_add_u32 s44, s44, s22
    s_waitcnt vmcnt(0)
    v_mov_b32 v244, v247
    v_mov_b32 v246, s42
    buffer_store_dword v246, v245, s[12:15], s93 offen sc1
    v_cmp_gt_u32 vcc, s49, v244
    s_cbranch_vccz SM_fok_91
SM_flp_92:
    buffer_load_dword v244, v243, s[12:15], s93 offen sc1
    s_sub_u32 s48, s48, 1
    s_cbranch_scc1 SM_fok_91_x
    s_waitcnt vmcnt(0)
    v_cmp_gt_u32 vcc, s49, v244
    s_cbranch_vccz SM_fok_91
    s_sleep 6
    s_branch SM_flp_92
SM_fok_91_x:
    s_mov_b32 s48, 0
SM_fok_91:
    s_and_b32 s35, s42, 3
    s_mul_i32 s35, s35, 12288
    s_lshl_b32 s34, s17, 10
    s_add_u32 s34, s34, s35
    s_mov_b32 m0, s34
    s_nop 0
    buffer_load_dwordx4 v242, s[12:15], s43 offen sc1 lds
    s_add_u32 s34, s34, 8192
    s_mov_b32 m0, s34
    s_add_u32 s33, s43, 8192
    buffer_load_dwordx4 v242, s[12:15], s33 offen sc1 lds
    s_add_u32 s43, s43, s23
    s_waitcnt vmcnt(0)
SM_pfd_89:
    s_cmp_lt_u32 s42, 64
    s_cbranch_scc1 SM_loop13
    s_waitcnt vmcnt(0)
    v_mov_b32 v246, s42
    buffer_store_dword v246, v245, s[12:15], s93 offen sc1
    s_branch SM_done
SM_v12:
    s_mov_b32 s43, s20
    s_mov_b32 s35, 0
    s_mov_b32 s49, 1
    v_cmp_gt_u32 vcc, s49, v244
    s_cbranch_vccz SM_fok_93
SM_flp_94:
    buffer_load_dword v244, v243, s[12:15], s93 offen sc1
    s_sub_u32 s48, s48, 1
    s_cbranch_scc1 SM_fok_93_x
    s_waitcnt vmcnt(0)
    v_cmp_gt_u32 vcc, s49, v244
    s_cbranch_vccz SM_fok_93
    s_sleep 6
    s_branch SM_flp_94
SM_fok_93_x:
    s_mov_b32 s48, 0
SM_fok_93:
    s_lshl_b32 s34, s17, 10
    s_add_u32 s34, s34, s35
    s_mov_b32 m0, s34
    s_nop 0
    buffer_load_dwordx4 v242, s[12:15], s43 offen sc1 lds
    s_add_u32 s43, s43, s23
    s_mov_b32 s42, 0
    s_mov_b32 s44, s21
    s_waitcnt vmcnt(0)
SM_loop12:
    s_barrier
    s_and_b32 s35, s42, 3
    s_mul_i32 s35, s35, 12288
    v_add_u32 v241, s35, v240
    ds_read_b128 v[144:147], v241 offset:0
    ds_read_b128 v[148:151], v241 offset:1024
    ds_read_b128 v[152:155], v241 offset:2048
    ds_read_b128 v[156:159], v241 offset:3072
    ds_read_b128 v[160:163], v241 offset:4096
    ds_read_b128 v[164:167], v241 offset:5120
    ds_read_b128 v[168:171], v241 offset:6144
    ds_read_b128 v[172:175], v241 offset:7168
    ds_read_b128 v[176:179], v241 offset:8192
    ds_read_b128 v[180:183], v241 offset:9216
    ds_read_b128 v[184:187], v241 offset:10240
    ds_read_b128 v[188:191], v241 offset:11264
    s_mov_b32 s50, 1
    s_add_u32 s35, s42, 1
    s_cmp_ge_u32 s35, 64
    s_cbranch_scc1 SM_nopf_95
    s_add_u32 s49, s42, 2
    s_mov_b32 s50, 0
    v_cmp_gt_u32 vcc, s49, v244
    s_cbranch_vccnz SM_nopf_95
    s_mov_b32 s50, 1
    s_and_b32 s35, s35, 3
    s_mul_i32 s35, s35, 12288
    s_lshl_b32 s34, s17, 10
    s_add_u32 s34, s34, s35
    s_mov_b32 m0, s34
    s_nop 0
    buffer_load_dwordx4 v242, s[12:15], s43 offen sc1 lds
    s_add_u32 s43, s43, s23
SM_nopf_95:
    buffer_load_dword v247, v243, s[12:15], s93 offen sc1
    s_waitcnt lgkmcnt(11)
    v_mfma_f32_32x32x16_bf16 v[192:207], v[0:3], v[144:147], 0
    s_waitcnt lgkmcnt(10)
    v_mfma_f32_32x32x16_bf16 v[192:207], v[4:7], v[148:151], v[192:207]
    s_waitcnt lgkmcnt(9)
    v_mfma_f32_32x32x16_bf16 v[192:207], v[8:11], v[152:155], v[192:207]
    s_waitcnt lgkmcnt(8)
    v_mfma_f32_32x32x16_bf16 v[192:207], v[12:15], v[156:159], v[192:207]
    s_waitcnt lgkmcnt(7)
    v_mfma_f32_32x32x16_bf16 v[192:207], v[16:19], v[160:163], v[192:207]
    s_waitcnt lgkmcnt(6)
    v_mfma_f32_32x32x16_bf16 v[192:207], v[20:23], v[164:167], v[192:207]
    s_waitcnt lgkmcnt(5)
    v_mfma_f32_32x32x16_bf16 v[192:207], v[24:27], v[168:171], v[192:207]
    s_waitcnt lgkmcnt(4)
    v_mfma_f32_32x32x16_bf16 v[192:207], v[28:31], v[172:175], v[192:207]
    s_waitcnt lgkmcnt(3)
    v_mfma_f32_32x32x16_bf16 v[192:207], v[32:35], v[176:179], v[192:207]
    s_waitcnt lgkmcnt(2)
    v_mfma_f32_32x32x16_bf16 v[192:207], v[36:39], v[180:183], v[192:207]
    s_waitcnt lgkmcnt(1)
    v_mfma_f32_32x32x16_bf16 v[192:207], v[40:43], v[184:187], v[192:207]
    s_waitcnt lgkmcnt(0)
    v_mfma_f32_32x32x16_bf16 v[192:207], v[44:47], v[188:191], v[192:207]
    v_mfma_f32_32x32x16_bf16 v[208:223], v[48:51], v[144:147], 0
    v_mfma_f32_32x32x16_bf16 v[208:223], v[52:55], v[148:151], v[208:223]
    v_mfma_f32_32x32x16_bf16 v[208:223], v[56:59], v[152:155], v[208:223]
    v_mfma_f32_32x32x16_bf16 v[208:223], v[60:63], v[156:159], v[208:223]
    s_nop 7
    v_cvt_pk_bf16_f32 v224, v192, v193
    v_cvt_pk_bf16_f32 v225, v194, v195
    v_mfma_f32_32x32x16_bf16 v[208:223], v[64:67], v[160:163], v[208:223]
    v_cvt_pk_bf16_f32 v226, v196, v197
    v_cvt_pk_bf16_f32 v227, v198, v199
    v_mfma_f32_32x32x16_bf16 v[208:223], v[68:71], v[164:167], v[208:223]
    v_cvt_pk_bf16_f32 v228, v200, v201
    v_cvt_pk_bf16_f32 v229, v202, v203
    v_mfma_f32_32x32x16_bf16 v[208:223], v[72:75], v[168:171], v[208:223]
    v_cvt_pk_bf16_f32 v230, v204, v205
    v_cvt_pk_bf16_f32 v231, v206, v207
    v_mfma_f32_32x32x16_bf16 v[208:223], v[76:79], v[172:175], v[208:223]
    s_add_u32 s33, s44, 0
    buffer_store_dwordx4 v[224:227], v240, s[12:15], s33 offen sc1
    v_mfma_f32_32x32x16_bf16 v[208:223], v[80:83], v[176:179], v[208:223]
    buffer_store_dwordx4 v[228:231], v240, s[12:15], s33 offen offset:1024 sc1
    v_mfma_f32_32x32x16_bf16 v[208:223], v[84:87], v[180:183], v[208:223]
    v_mfma_f32_32x32x16_bf16 v[208:223], v[88:91], v[184:187], v[208:223]
    v_mfma_f32_32x32x16_bf16 v[208:223], v[92:95], v[188:191], v[208:223]
    s_nop 11
    v_cvt_pk_bf16_f32 v224, v208, v209
    v_cvt_pk_bf16_f32 v225, v210, v211
    v_cvt_pk_bf16_f32 v226, v212, v213
    v_cvt_pk_bf16_f32 v227, v214, v215
    v_cvt_pk_bf16_f32 v228, v216, v217
    v_cvt_pk_bf16_f32 v229, v218, v219
    v_cvt_pk_bf16_f32 v230, v220, v221
    v_cvt_pk_bf16_f32 v231, v222, v223
    s_add_u32 s33, s44, 2048
    buffer_store_dwordx4 v[224:227], v240, s[12:15], s33 offen sc1
    buffer_store_dwordx4 v[228:231], v240, s[12:15], s33 offen offset:1024 sc1
    s_cmp_eq_u32 s50, 0
    s_cbranch_scc1 SM_blk_97
    s_waitcnt vmcnt(4)
    v_mov_b32 v244, v247
    v_mov_b32 v246, s42
    buffer_store_dword v246, v245, s[12:15], s93 offen sc1
    s_add_u32 s42, s42, 1
    s_add_u32 s44, s44, s22
    s_branch SM_pfd_96
SM_blk_97:
    s_add_u32 s42, s42, 1
    s_add_u32 s44, s44, s22
    s_waitcnt vmcnt(0)
    v_mov_b32 v244, v247
    v_mov_b32 v246, s42
    buffer_store_dword v246, v245, s[12:15], s93 offen sc1
    v_cmp_gt_u32 vcc, s49, v244
    s_cbranch_vccz SM_fok_98
SM_flp_99:
    buffer_load_dword v244, v243, s[12:15], s93 offen sc1
    s_sub_u32 s48, s48, 1
    s_cbranch_scc1 SM_fok_98_x
    s_waitcnt vmcnt(0)
    v_cmp_gt_u32 vcc, s49, v244
    s_cbranch_vccz SM_fok_98
    s_sleep 6
    s_branch SM_flp_99
SM_fok_98_x:
    s_mov_b32 s48, 0
SM_fok_98:
    s_and_b32 s35, s42, 3
    s_mul_i32 s35, s35, 12288
    s_lshl_b32 s34, s17, 10
    s_add_u32 s34, s34, s35
    s_mov_b32 m0, s34
    s_nop 0
    buffer_load_dwordx4 v242, s[12:15], s43 offen sc1 lds
    s_add_u32 s43, s43, s23
    s_waitcnt vmcnt(0)
SM_pfd_96:
    s_cmp_lt_u32 s42, 64
    s_cbranch_scc1 SM_loop12
    s_waitcnt vmcnt(0)
    v_mov_b32 v246, s42
    buffer_store_dword v246, v245, s[12:15], s93 offen sc1
    s_branch SM_done
SM_done:
MAIN_post:
    s_load_dwordx2 s[4:5], s[0:1], 112
    s_waitcnt lgkmcnt(0) vmcnt(0)
    s_barrier
    s_mov_b32 s46, 8000000
    s_mov_b32 s12, s4
    s_mov_b32 s13, s5
    s_mov_b32 s14, 268435456
    s_mov_b32 s15, 0x00020000
MAIN_ploop:
    s_add_u32 s16, s93, 3609088
    v_mov_b32 v3, 1
    v_mov_b32 v4, s16
    v_mov_b32 v5, 0
    s_cmp_lg_u32 s17, 0
    s_cbranch_scc1 MAIN_tk2
    s_mov_b64 exec, 1
    buffer_atomic_add v3, v4, s[12:15], 0 offen sc0
    s_waitcnt vmcnt(0)
    ds_write_b32 v5, v3
    s_waitcnt lgkmcnt(0)
    s_mov_b64 exec, -1
MAIN_tk2:
    s_barrier
    ds_read_b32 v3, v5
    s_waitcnt lgkmcnt(0)
    v_readfirstlane_b32 s16, v3
    s_barrier
    s_cmp_ge_u32 s16, 960
    s_cbranch_scc1 MAIN_end
    s_mul_i32 s40, s16, 4370
    s_lshr_b32 s40, s40, 16
    s_mul_i32 s41, s40, 15
    s_sub_u32 s19, s16, s41
    s_mov_b32 s16, s40
    v_lshlrev_b32 v1, 4, v255
    v_min_u32 v2, 496, v1
    v_min_u32 v3, 240, v1
    s_cmp_eq_u32 s19, 0
    s_cbranch_scc1 MAIN_gi
    s_cmp_ge_u32 s19, 5
    s_cbranch_scc1 MAIN_zi
    s_sub_u32 s19, s19, 1
    s_cmp_lg_u32 s17, 0
    s_cbranch_scc1 MAIN_pgo
    v_and_b32 v220, 3, v255
    v_lshlrev_b32 v220, 7, v220
    s_add_u32 s42, s93, 3609600
    s_add_u32 s43, s16, 0
MAIN_wc0:
    buffer_load_dword v221, v220, s[12:15], s42 offen sc1
    s_sub_u32 s46, s46, 1
    s_cbranch_scc1 MAIN_wc0_x
    s_waitcnt vmcnt(0)
    v_mov_b32 v222, v221
    v_cmp_ge_u32 vcc, s43, v222
    s_cbranch_vccz MAIN_wc0_ok
    s_sleep 16
    s_branch MAIN_wc0
MAIN_wc0_x:
    s_mov_b32 s46, 0
    s_waitcnt vmcnt(0)
MAIN_wc0_ok:
    s_add_u32 s40, s93, 3637248
    v_min_u32 v5, 47, v255
    v_lshlrev_b32 v5, 6, v5
MAIN_wp0:
    buffer_load_dword v8, v5, s[12:15], s40 offen sc1
    s_sub_u32 s46, s46, 1
    s_cbranch_scc1 MAIN_wp0_x
    s_waitcnt vmcnt(0)
    v_mov_b32 v4, v8
    v_cmp_ge_u32 vcc, s16, v4
    s_cbranch_vccz MAIN_wp0_ok
    s_sleep 16
    s_branch MAIN_wp0
MAIN_wp0_x:
    s_mov_b32 s46, 0
    s_waitcnt vmcnt(0)
MAIN_wp0_ok:
MAIN_pgo:
    s_barrier
    v_lshlrev_b32 v254, 4, v255
    v_lshrrev_b32 v253, 5, v255
    v_and_b32 v252, 31, v255
    v_lshlrev_b32 v250, 3, v255
    v_and_b32 v251, 7, v255
    v_lshlrev_b32 v251, 4, v251
    v_lshl_add_u32 v251, v253, 7, v251
    v_lshlrev_b32 v249, 2, v253
    v_sub_u32 v249, v252, v249
    v_mov_b32 v248, 0xff800000
    s_mov_b32 s53, 0x3dd53b95
    s_lshl_b32 s20, s19, 3
    s_add_u32 s20, s20, s17
    s_mul_i32 s21, s16, 393216
    s_mul_i32 s40, s20, 12288
    s_add_u32 s21, s21, s40
    s_add_u32 s22, s21, 34603008
    s_add_u32 s21, s21, 9437184
    s_mul_i32 s23, s16, 98304
    s_mul_i32 s40, s20, 3072
    s_add_u32 s23, s23, s40
    s_add_u32 s23, s23, 196182016
    s_mul_i32 s24, s16, 81920
    s_mul_i32 s40, s20, 2560
    s_add_u32 s24, s24, s40
    s_add_u32 s24, s24, 223772672
    buffer_load_dwordx4 v[0:3], v254, s[12:15], s21 offen offset:0
    buffer_load_dwordx4 v[48:51], v254, s[12:15], s22 offen offset:0
    buffer_load_dwordx4 v[4:7], v254, s[12:15], s21 offen offset:1024
    buffer_load_dwordx4 v[52:55], v254, s[12:15], s22 offen offset:1024
    buffer_load_dwordx4 v[8:11], v254, s[12:15], s21 offen offset:2048
    buffer_load_dwordx4 v[56:59], v254, s[12:15], s22 offen offset:2048
    buffer_load_dwordx4 v[12:15], v254, s[12:15], s21 offen offset:3072
    buffer_load_dwordx4 v[60:63], v254, s[12:15], s22 offen offset:3072
    s_add_u32 s21, s21, 4096
    s_add_u32 s22, s22, 4096
    buffer_load_dwordx4 v[16:19], v254, s[12:15], s21 offen offset:0
    buffer_load_dwordx4 v[64:67], v254, s[12:15], s22 offen offset:0
    buffer_load_dwordx4 v[20:23], v254, s[12:15], s21 offen offset:1024
    buffer_load_dwordx4 v[68:71], v254, s[12:15], s22 offen offset:1024
    buffer_load_dwordx4 v[24:27], v254, s[12:15], s21 offen offset:2048
    buffer_load_dwordx4 v[72:75], v254, s[12:15], s22 offen offset:2048
    buffer_load_dwordx4 v[28:31], v254, s[12:15], s21 offen offset:3072
    buffer_load_dwordx4 v[76:79], v254, s[12:15], s22 offen offset:3072
    s_add_u32 s21, s21, 4096
    s_add_u32 s22, s22, 4096
    buffer_load_dwordx4 v[32:35], v254, s[12:15], s21 offen offset:0
    buffer_load_dwordx4 v[80:83], v254, s[12:15], s22 offen offset:0
    buffer_load_dwordx4 v[36:39], v254, s[12:15], s21 offen offset:1024
    buffer_load_dwordx4 v[84:87], v254, s[12:15], s22 offen offset:1024
    buffer_load_dwordx4 v[40:43], v254, s[12:15], s21 offen offset:2048
    buffer_load_dwordx4 v[88:91], v254, s[12:15], s22 offen offset:2048
    buffer_load_dwordx4 v[44:47], v254, s[12:15], s21 offen offset:3072
    buffer_load_dwordx4 v[92:95], v254, s[12:15], s22 offen offset:3072
    s_waitcnt vmcnt(22)
    v_mfma_f32_32x32x16_bf16 v[144:159], v[48:51], v[0:3], 0
    s_waitcnt vmcnt(20)
    v_mfma_f32_32x32x16_bf16 v[144:159], v[52:55], v[4:7], v[144:159]
    s_waitcnt vmcnt(18)
    v_mfma_f32_32x32x16_bf16 v[144:159], v[56:59], v[8:11], v[144:159]
    s_waitcnt vmcnt(16)
    v_mfma_f32_32x32x16_bf16 v[144:159], v[60:63], v[12:15], v[144:159]
    s_waitcnt vmcnt(14)
    v_mfma_f32_32x32x16_bf16 v[144:159], v[64:67], v[16:19], v[144:159]
    s_waitcnt vmcnt(12)
    v_mfma_f32_32x32x16_bf16 v[144:159], v[68:71], v[20:23], v[144:159]
    s_waitcnt vmcnt(10)
    v_mfma_f32_32x32x16_bf16 v[144:159], v[72:75], v[24:27], v[144:159]
    s_waitcnt vmcnt(8)
    v_mfma_f32_32x32x16_bf16 v[144:159], v[76:79], v[28:31], v[144:159]
    s_waitcnt vmcnt(6)
    v_mfma_f32_32x32x16_bf16 v[144:159], v[80:83], v[32:35], v[144:159]
    s_waitcnt vmcnt(4)
    v_mfma_f32_32x32x16_bf16 v[144:159], v[84:87], v[36:39], v[144:159]
    s_waitcnt vmcnt(2)
    v_mfma_f32_32x32x16_bf16 v[144:159], v[88:91], v[40:43], v[144:159]
    s_waitcnt vmcnt(0)
    v_mfma_f32_32x32x16_bf16 v[144:159], v[92:95], v[44:47], v[144:159]
    s_cmp_lg_u32 s17, 0
    s_cbranch_scc1 MAIN_pgo2
    v_and_b32 v220, 3, v255
    v_lshlrev_b32 v220, 7, v220
    s_add_u32 s42, s93, 3609600
    s_add_u32 s43, s16, 2
MAIN_wc:
    buffer_load_dword v221, v220, s[12:15], s42 offen sc1
    s_sub_u32 s46, s46, 1
    s_cbranch_scc1 MAIN_wc_x
    s_waitcnt vmcnt(0)
    v_mov_b32 v222, v221
    v_cmp_ge_u32 vcc, s43, v222
    s_cbranch_vccz MAIN_wc_ok
    s_sleep 16
    s_branch MAIN_wc
MAIN_wc_x:
    s_mov_b32 s46, 0
    s_waitcnt vmcnt(0)
MAIN_wc_ok:
    s_add_u32 s42, s93, 3612672
    v_lshlrev_b32 v220, 6, v255
    v_min_u32 v223, 1984, v220
    s_add_u32 s43, s42, 4096
MAIN_wp:
    buffer_load_dword v224, v220, s[12:15], s42 offen sc1
    buffer_load_dword v225, v223, s[12:15], s43 offen sc1
    s_sub_u32 s46, s46, 1
    s_cbranch_scc1 MAIN_wp_x
    s_waitcnt vmcnt(0)
    v_mov_b32 v222, v224
    v_min_u32 v222, v222, v225
    v_cmp_ge_u32 vcc, s16, v222
    s_cbranch_vccz MAIN_wp_ok
    s_sleep 4
    s_branch MAIN_wp
MAIN_wp_x:
    s_mov_b32 s46, 0
    s_waitcnt vmcnt(0)
MAIN_wp_ok:
MAIN_pgo2:
    s_barrier
    buffer_load_dwordx4 v[96:99], v251, s[12:15], s23 offen offset:0
    buffer_load_dwordx4 v[100:103], v251, s[12:15], s23 offen offset:256
    buffer_load_dwordx4 v[104:107], v251, s[12:15], s23 offen offset:512
    buffer_load_dwordx4 v[108:111], v251, s[12:15], s23 offen offset:768
    buffer_load_dwordx4 v[112:115], v251, s[12:15], s23 offen offset:1024
    buffer_load_dwordx4 v[116:119], v251, s[12:15], s23 offen offset:1280
    buffer_load_dwordx4 v[120:123], v251, s[12:15], s23 offen offset:1536
    buffer_load_dwordx4 v[124:127], v251, s[12:15], s23 offen offset:1792
    buffer_load_dwordx4 v[128:131], v251, s[12:15], s23 offen offset:2048
    buffer_load_dwordx4 v[132:135], v251, s[12:15], s23 offen offset:2304
    buffer_load_dwordx4 v[136:139], v251, s[12:15], s23 offen offset:2560
    buffer_load_dwordx4 v[140:143], v251, s[12:15], s23 offen offset:2816
    s_waitcnt vmcnt(11)
    v_mfma_f32_32x32x16_bf16 v[160:175], v[96:99], v[0:3], 0
    s_waitcnt vmcnt(10)
    v_mfma_f32_32x32x16_bf16 v[160:175], v[100:103], v[4:7], v[160:175]
    s_waitcnt vmcnt(9)
    v_mfma_f32_32x32x16_bf16 v[160:175], v[104:107], v[8:11], v[160:175]
    s_waitcnt vmcnt(8)
    v_mfma_f32_32x32x16_bf16 v[160:175], v[108:111], v[12:15], v[160:175]
    s_waitcnt vmcnt(7)
    v_mfma_f32_32x32x16_bf16 v[160:175], v[112:115], v[16:19], v[160:175]
    s_waitcnt vmcnt(6)
    v_mfma_f32_32x32x16_bf16 v[160:175], v[116:119], v[20:23], v[160:175]
    s_waitcnt vmcnt(5)
    v_mfma_f32_32x32x16_bf16 v[160:175], v[120:123], v[24:27], v[160:175]
    s_waitcnt vmcnt(4)
    v_mfma_f32_32x32x16_bf16 v[160:175], v[124:127], v[28:31], v[160:175]
    s_waitcnt vmcnt(3)
    v_mfma_f32_32x32x16_bf16 v[160:175], v[128:131], v[32:35], v[160:175]
    s_waitcnt vmcnt(2)
    v_mfma_f32_32x32x16_bf16 v[160:175], v[132:135], v[36:39], v[160:175]
    s_waitcnt vmcnt(1)
    v_mfma_f32_32x32x16_bf16 v[160:175], v[136:139], v[40:43], v[160:175]
    s_waitcnt vmcnt(0)
    v_mfma_f32_32x32x16_bf16 v[160:175], v[140:143], v[44:47], v[160:175]
    s_nop 15
    v_cmp_le_i32 vcc, 0, v249
    s_nop 1
    v_cndmask_b32 v144, v248, v144, vcc
    v_cmp_le_i32 vcc, 1, v249
    s_nop 1
    v_cndmask_b32 v145, v248, v145, vcc
    v_cmp_le_i32 vcc, 2, v249
    s_nop 1
    v_cndmask_b32 v146, v248, v146, vcc
    v_cmp_le_i32 vcc, 3, v249
    s_nop 1
    v_cndmask_b32 v147, v248, v147, vcc
    v_cmp_le_i32 vcc, 8, v249
    s_nop 1
    v_cndmask_b32 v148, v248, v148, vcc
    v_cmp_le_i32 vcc, 9, v249
    s_nop 1
    v_cndmask_b32 v149, v248, v149, vcc
    v_cmp_le_i32 vcc, 10, v249
    s_nop 1
    v_cndmask_b32 v150, v248, v150, vcc
    v_cmp_le_i32 vcc, 11, v249
    s_nop 1
    v_cndmask_b32 v151, v248, v151, vcc
    v_cmp_le_i32 vcc, 16, v249
    s_nop 1
    v_cndmask_b32 v152, v248, v152, vcc
    v_cmp_le_i32 vcc, 17, v249
    s_nop 1
    v_cndmask_b32 v153, v248, v153, vcc
    v_cmp_le_i32 vcc, 18, v249
    s_nop 1
    v_cndmask_b32 v154, v248, v154, vcc
    v_cmp_le_i32 vcc, 19, v249
    s_nop 1
    v_cndmask_b32 v155, v248, v155, vcc
    v_cmp_le_i32 vcc, 24, v249
    s_nop 1
    v_cndmask_b32 v156, v248, v156, vcc
    v_cmp_le_i32 vcc, 25, v249
    s_nop 1
    v_cndmask_b32 v157, v248, v157, vcc
    v_cmp_le_i32 vcc, 26, v249
    s_nop 1
    v_cndmask_b32 v158, v248, v158, vcc
    v_cmp_le_i32 vcc, 27, v249
    s_nop 1
    v_cndmask_b32 v159, v248, v159, vcc
    v_max3_f32 v176, v144, v145, v146
    v_max3_f32 v176, v176, v147, v148
    v_max3_f32 v176, v176, v149, v150
    v_max3_f32 v176, v176, v151, v152
    v_max3_f32 v176, v176, v153, v154
    v_max3_f32 v176, v176, v155, v156
    v_max3_f32 v176, v176, v157, v158
    v_max3_f32 v176, v176, v159, v160
    v_max3_f32 v176, v176, v161, v162
    v_max_f32 v176, v176, v163
    v_mov_b32 v177, v176
    s_nop 1
    v_permlane32_swap_b32 v176, v177
    v_max_f32 v176, v176, v177
    v_mul_f32 v176, s53, v176
    v_fma_f32 v144, v144, s53, -v176
    v_fma_f32 v145, v145, s53, -v176
    v_fma_f32 v146, v146, s53, -v176
    v_fma_f32 v147, v147, s53, -v176
    v_fma_f32 v148, v148, s53, -v176
    v_fma_f32 v149, v149, s53, -v176
    v_fma_f32 v150, v150, s53, -v176
    v_fma_f32 v151, v151, s53, -v176
    v_fma_f32 v152, v152, s53, -v176
    v_fma_f32 v153, v153, s53, -v176
    v_fma_f32 v154, v154, s53, -v176
    v_fma_f32 v155, v155, s53, -v176
    v_fma_f32 v156, v156, s53, -v176
    v_fma_f32 v157, v157, s53, -v176
    v_fma_f32 v158, v158, s53, -v176
    v_fma_f32 v159, v159, s53, -v176
    v_fma_f32 v160, v160, s53, -v176
    v_fma_f32 v161, v161, s53, -v176
    v_fma_f32 v162, v162, s53, -v176
    v_fma_f32 v163, v163, s53, -v176
    v_exp_f32 v144, v144
    v_exp_f32 v145, v145
    v_exp_f32 v146, v146
    v_exp_f32 v147, v147
    v_exp_f32 v148, v148
    v_exp_f32 v149, v149
    v_exp_f32 v150, v150
    v_exp_f32 v151, v151
    v_exp_f32 v152, v152
    v_exp_f32 v153, v153
    v_exp_f32 v154, v154
    v_exp_f32 v155, v155
    v_exp_f32 v156, v156
    v_exp_f32 v157, v157
    v_exp_f32 v158, v158
    v_exp_f32 v159, v159
    v_exp_f32 v160, v160
    v_exp_f32 v161, v161
    v_exp_f32 v162, v162
    v_exp_f32 v163, v163
    v_add_f32 v178, v144, v145
    v_add_f32 v178, v178, v146
    v_add_f32 v178, v178, v147
    v_add_f32 v178, v178, v148
    v_add_f32 v178, v178, v149
    v_add_f32 v178, v178, v150
    v_add_f32 v178, v178, v151
    v_add_f32 v178, v178, v152
    v_add_f32 v178, v178, v153
    v_add_f32 v178, v178, v154
    v_add_f32 v178, v178, v155
    v_add_f32 v178, v178, v156
    v_add_f32 v178, v178, v157
    v_add_f32 v178, v178, v158
    v_add_f32 v178, v178, v159
    v_add_f32 v178, v178, v160
    v_add_f32 v178, v178, v161
    v_add_f32 v178, v178, v162
    v_add_f32 v178, v178, v163
    v_mov_b32 v177, v178
    s_nop 1
    v_permlane32_swap_b32 v178, v177
    v_add_f32 v178, v178, v177
    v_rcp_f32 v178, v178
    s_nop 0
    v_mul_f32 v144, v144, v178
    v_mul_f32 v145, v145, v178
    v_mul_f32 v146, v146, v178
    v_mul_f32 v147, v147, v178
    v_mul_f32 v148, v148, v178
    v_mul_f32 v149, v149, v178
    v_mul_f32 v150, v150, v178
    v_mul_f32 v151, v151, v178
    v_mul_f32 v152, v152, v178
    v_mul_f32 v153, v153, v178
    v_mul_f32 v154, v154, v178
    v_mul_f32 v155, v155, v178
    v_mul_f32 v156, v156, v178
    v_mul_f32 v157, v157, v178
    v_mul_f32 v158, v158, v178
    v_mul_f32 v159, v159, v178
    v_mul_f32 v160, v160, v178
    v_mul_f32 v161, v161, v178
    v_mul_f32 v162, v162, v178
    v_mul_f32 v163, v163, v178
    v_cvt_pk_bf16_f32 v180, v144, v145
    v_cvt_pk_bf16_f32 v181, v146, v147
    v_cvt_pk_bf16_f32 v182, v148, v149
    v_cvt_pk_bf16_f32 v183, v150, v151
    v_cvt_pk_bf16_f32 v184, v152, v153
    v_cvt_pk_bf16_f32 v185, v154, v155
    v_cvt_pk_bf16_f32 v186, v156, v157
    v_cvt_pk_bf16_f32 v187, v158, v159
    v_cvt_pk_bf16_f32 v188, v160, v161
    v_cvt_pk_bf16_f32 v189, v162, v163
    buffer_store_dwordx4 v[180:183], v254, s[12:15], s24 offen sc1
    buffer_store_dwordx4 v[184:187], v254, s[12:15], s24 offen offset:1024 sc1
    buffer_store_dwordx2 v[188:189], v250, s[12:15], s24 offen offset:2048 sc1
    s_waitcnt vmcnt(0)
    s_barrier
    s_cmp_lg_u32 s17, 0
    s_cbranch_scc1 PFL_100
    s_lshl_b32 s40, s16, 7
    s_lshl_b32 s41, s19, 2
    s_add_u32 s40, s40, s41
    s_add_u32 s40, s40, 3620864
    v_mov_b32 v1, s40
    v_mov_b32 v2, 1
    buffer_store_dword v2, v1, s[12:15], s93 offen sc1
PFL_100:
    s_branch MAIN_ploop
MAIN_gi:
    s_cmp_lg_u32 s17, 0
    s_cbranch_scc1 MAIN_ggo
    s_add_u32 s41, s93, 3606528
    v_lshrrev_b32 v5, 3, v255
    v_lshlrev_b32 v5, 6, v5
    v_and_b32 v6, 7, v255
    v_lshl_add_u32 v5, v6, 2, v5
MAIN_wg:
    buffer_load_dword v8, v5, s[12:15], s41 offen sc1
    s_sub_u32 s46, s46, 1
    s_cbranch_scc1 MAIN_wg_x
    s_waitcnt vmcnt(0)
    v_mov_b32 v4, v8
    v_cmp_ge_u32 vcc, s16, v4
    s_cbranch_vccz MAIN_wg_ok
    s_sleep 32
    s_branch MAIN_wg
MAIN_wg_x:
    s_mov_b32 s46, 0
    s_waitcnt vmcnt(0)
MAIN_wg_ok:
MAIN_ggo:
    s_barrier
    v_lshlrev_b32 v254, 4, v255
    v_lshrrev_b32 v253, 5, v255
    v_and_b32 v252, 31, v255
    v_lshlrev_b32 v250, 3, v255
    s_load_dwordx2 s[32:33], s[0:1], 88
    s_mov_b32 s34, 1280
    s_mov_b32 s35, 0x00020000
    v_lshlrev_b32 v242, 3, v253
    s_mov_b32 s41, 0xbfb8aa3b
    s_mov_b32 s28, s17
    s_waitcnt lgkmcnt(0)
GI_gl:
    s_mul_i32 s21, s16, 327680
    s_lshl_b32 s40, s28, 11
    s_add_u32 s21, s21, s40
    s_add_u32 s21, s21, 175112192
    s_lshl_b32 s22, s28, 6
    s_mul_i32 s23, s16, 40960
    s_lshl_b32 s40, s28, 11
    s_add_u32 s23, s23, s40
    s_add_u32 s23, s23, 229015552
    s_add_u32 s40, s21, 0
    buffer_load_dwordx4 v[16:19], v254, s[12:15], s40 offen offset:0
    buffer_load_dwordx4 v[20:23], v254, s[12:15], s40 offen offset:1024
    s_add_u32 s40, s21, 40960
    buffer_load_dwordx4 v[24:27], v254, s[12:15], s40 offen offset:0
    buffer_load_dwordx4 v[28:31], v254, s[12:15], s40 offen offset:1024
    s_add_u32 s40, s21, 81920
    buffer_load_dwordx4 v[32:35], v254, s[12:15], s40 offen offset:0
    buffer_load_dwordx4 v[36:39], v254, s[12:15], s40 offen offset:1024
    s_add_u32 s40, s21, 122880
    buffer_load_dwordx4 v[40:43], v254, s[12:15], s40 offen offset:0
    buffer_load_dwordx4 v[44:47], v254, s[12:15], s40 offen offset:1024
    s_add_u32 s40, s21, 163840
    buffer_load_dwordx4 v[48:51], v254, s[12:15], s40 offen offset:0
    buffer_load_dwordx4 v[52:55], v254, s[12:15], s40 offen offset:1024
    s_add_u32 s40, s21, 204800
    buffer_load_dwordx4 v[56:59], v254, s[12:15], s40 offen offset:0
    buffer_load_dwordx4 v[60:63], v254, s[12:15], s40 offen offset:1024
    s_add_u32 s40, s21, 245760
    buffer_load_dwordx4 v[64:67], v254, s[12:15], s40 offen offset:0
    buffer_load_dwordx4 v[68:71], v254, s[12:15], s40 offen offset:1024
    s_add_u32 s40, s21, 286720
    buffer_load_dwordx4 v[72:75], v254, s[12:15], s40 offen offset:0
    buffer_load_dwordx4 v[76:79], v254, s[12:15], s40 offen offset:1024
    buffer_load_dwordx2 v[128:129], v242, s[32:35], s22 offen offset:0
    buffer_load_dwordx2 v[130:131], v242, s[32:35], s22 offen offset:16
    buffer_load_dwordx2 v[132:133], v242, s[32:35], s22 offen offset:32
    buffer_load_dwordx2 v[134:135], v242, s[32:35], s22 offen offset:48
    s_waitcnt vmcnt(18)
    v_lshlrev_b32 v0, 16, v16
    v_and_b32 v1, 0xffff0000, v16
    v_lshlrev_b32 v2, 16, v17
    v_and_b32 v3, 0xffff0000, v17
    v_lshlrev_b32 v4, 16, v18
    v_and_b32 v5, 0xffff0000, v18
    v_lshlrev_b32 v6, 16, v19
    v_and_b32 v7, 0xffff0000, v19
    v_lshlrev_b32 v8, 16, v20
    v_and_b32 v9, 0xffff0000, v20
    v_lshlrev_b32 v10, 16, v21
    v_and_b32 v11, 0xffff0000, v21
    v_lshlrev_b32 v12, 16, v22
    v_and_b32 v13, 0xffff0000, v22
    v_lshlrev_b32 v14, 16, v23
    v_and_b32 v15, 0xffff0000, v23
    s_waitcnt vmcnt(16)
    v_lshlrev_b32 v136, 16, v24
    v_and_b32 v137, 0xffff0000, v24
    v_pk_add_f32 v[0:1], v[0:1], v[136:137]
    v_lshlrev_b32 v136, 16, v25
    v_and_b32 v137, 0xffff0000, v25
    v_pk_add_f32 v[2:3], v[2:3], v[136:137]
    v_lshlrev_b32 v136, 16, v26
    v_and_b32 v137, 0xffff0000, v26
    v_pk_add_f32 v[4:5], v[4:5], v[136:137]
    v_lshlrev_b32 v136, 16, v27
    v_and_b32 v137, 0xffff0000, v27
    v_pk_add_f32 v[6:7], v[6:7], v[136:137]
    v_lshlrev_b32 v136, 16, v28
    v_and_b32 v137, 0xffff0000, v28
    v_pk_add_f32 v[8:9], v[8:9], v[136:137]
    v_lshlrev_b32 v136, 16, v29
    v_and_b32 v137, 0xffff0000, v29
    v_pk_add_f32 v[10:11], v[10:11], v[136:137]
    v_lshlrev_b32 v136, 16, v30
    v_and_b32 v137, 0xffff0000, v30
    v_pk_add_f32 v[12:13], v[12:13], v[136:137]
    v_lshlrev_b32 v136, 16, v31
    v_and_b32 v137, 0xffff0000, v31
    v_pk_add_f32 v[14:15], v[14:15], v[136:137]
    s_waitcnt vmcnt(14)
    v_lshlrev_b32 v136, 16, v32
    v_and_b32 v137, 0xffff0000, v32
    v_pk_add_f32 v[0:1], v[0:1], v[136:137]
    v_lshlrev_b32 v136, 16, v33
    v_and_b32 v137, 0xffff0000, v33
    v_pk_add_f32 v[2:3], v[2:3], v[136:137]
    v_lshlrev_b32 v136, 16, v34
    v_and_b32 v137, 0xffff0000, v34
    v_pk_add_f32 v[4:5], v[4:5], v[136:137]
    v_lshlrev_b32 v136, 16, v35
    v_and_b32 v137, 0xffff0000, v35
    v_pk_add_f32 v[6:7], v[6:7], v[136:137]
    v_lshlrev_b32 v136, 16, v36
    v_and_b32 v137, 0xffff0000, v36
    v_pk_add_f32 v[8:9], v[8:9], v[136:137]
    v_lshlrev_b32 v136, 16, v37
    v_and_b32 v137, 0xffff0000, v37
    v_pk_add_f32 v[10:11], v[10:11], v[136:137]
    v_lshlrev_b32 v136, 16, v38
    v_and_b32 v137, 0xffff0000, v38
    v_pk_add_f32 v[12:13], v[12:13], v[136:137]
    v_lshlrev_b32 v136, 16, v39
    v_and_b32 v137, 0xffff0000, v39
    v_pk_add_f32 v[14:15], v[14:15], v[136:137]
    s_waitcnt vmcnt(12)
    v_lshlrev_b32 v136, 16, v40
    v_and_b32 v137, 0xffff0000, v40
    v_pk_add_f32 v[0:1], v[0:1], v[136:137]
    v_lshlrev_b32 v136, 16, v41
    v_and_b32 v137, 0xffff0000, v41
    v_pk_add_f32 v[2:3], v[2:3], v[136:137]
    v_lshlrev_b32 v136, 16, v42
    v_and_b32 v137, 0xffff0000, v42
    v_pk_add_f32 v[4:5], v[4:5], v[136:137]
    v_lshlrev_b32 v136, 16, v43
    v_and_b32 v137, 0xffff0000, v43
    v_pk_add_f32 v[6:7], v[6:7], v[136:137]
    v_lshlrev_b32 v136, 16, v44
    v_and_b32 v137, 0xffff0000, v44
    v_pk_add_f32 v[8:9], v[8:9], v[136:137]
    v_lshlrev_b32 v136, 16, v45
    v_and_b32 v137, 0xffff0000, v45
    v_pk_add_f32 v[10:11], v[10:11], v[136:137]
    v_lshlrev_b32 v136, 16, v46
    v_and_b32 v137, 0xffff0000, v46
    v_pk_add_f32 v[12:13], v[12:13], v[136:137]
    v_lshlrev_b32 v136, 16, v47
    v_and_b32 v137, 0xffff0000, v47
    v_pk_add_f32 v[14:15], v[14:15], v[136:137]
    s_waitcnt vmcnt(10)
    v_lshlrev_b32 v136, 16, v48
    v_and_b32 v137, 0xffff0000, v48
    v_pk_add_f32 v[0:1], v[0:1], v[136:137]
    v_lshlrev_b32 v136, 16, v49
    v_and_b32 v137, 0xffff0000, v49
    v_pk_add_f32 v[2:3], v[2:3], v[136:137]
    v_lshlrev_b32 v136, 16, v50
    v_and_b32 v137, 0xffff0000, v50
    v_pk_add_f32 v[4:5], v[4:5], v[136:137]
    v_lshlrev_b32 v136, 16, v51
    v_and_b32 v137, 0xffff0000, v51
    v_pk_add_f32 v[6:7], v[6:7], v[136:137]
    v_lshlrev_b32 v136, 16, v52
    v_and_b32 v137, 0xffff0000, v52
    v_pk_add_f32 v[8:9], v[8:9], v[136:137]
    v_lshlrev_b32 v136, 16, v53
    v_and_b32 v137, 0xffff0000, v53
    v_pk_add_f32 v[10:11], v[10:11], v[136:137]
    v_lshlrev_b32 v136, 16, v54
    v_and_b32 v137, 0xffff0000, v54
    v_pk_add_f32 v[12:13], v[12:13], v[136:137]
    v_lshlrev_b32 v136, 16, v55
    v_and_b32 v137, 0xffff0000, v55
    v_pk_add_f32 v[14:15], v[14:15], v[136:137]
    s_waitcnt vmcnt(8)
    v_lshlrev_b32 v136, 16, v56
    v_and_b32 v137, 0xffff0000, v56
    v_pk_add_f32 v[0:1], v[0:1], v[136:137]
    v_lshlrev_b32 v136, 16, v57
    v_and_b32 v137, 0xffff0000, v57
    v_pk_add_f32 v[2:3], v[2:3], v[136:137]
    v_lshlrev_b32 v136, 16, v58
    v_and_b32 v137, 0xffff0000, v58
    v_pk_add_f32 v[4:5], v[4:5], v[136:137]
    v_lshlrev_b32 v136, 16, v59
    v_and_b32 v137, 0xffff0000, v59
    v_pk_add_f32 v[6:7], v[6:7], v[136:137]
    v_lshlrev_b32 v136, 16, v60
    v_and_b32 v137, 0xffff0000, v60
    v_pk_add_f32 v[8:9], v[8:9], v[136:137]
    v_lshlrev_b32 v136, 16, v61
    v_and_b32 v137, 0xffff0000, v61
    v_pk_add_f32 v[10:11], v[10:11], v[136:137]
    v_lshlrev_b32 v136, 16, v62
    v_and_b32 v137, 0xffff0000, v62
    v_pk_add_f32 v[12:13], v[12:13], v[136:137]
    v_lshlrev_b32 v136, 16, v63
    v_and_b32 v137, 0xffff0000, v63
    v_pk_add_f32 v[14:15], v[14:15], v[136:137]
    s_waitcnt vmcnt(6)
    v_lshlrev_b32 v136, 16, v64
    v_and_b32 v137, 0xffff0000, v64
    v_pk_add_f32 v[0:1], v[0:1], v[136:137]
    v_lshlrev_b32 v136, 16, v65
    v_and_b32 v137, 0xffff0000, v65
    v_pk_add_f32 v[2:3], v[2:3], v[136:137]
    v_lshlrev_b32 v136, 16, v66
    v_and_b32 v137, 0xffff0000, v66
    v_pk_add_f32 v[4:5], v[4:5], v[136:137]
    v_lshlrev_b32 v136, 16, v67
    v_and_b32 v137, 0xffff0000, v67
    v_pk_add_f32 v[6:7], v[6:7], v[136:137]
    v_lshlrev_b32 v136, 16, v68
    v_and_b32 v137, 0xffff0000, v68
    v_pk_add_f32 v[8:9], v[8:9], v[136:137]
    v_lshlrev_b32 v136, 16, v69
    v_and_b32 v137, 0xffff0000, v69
    v_pk_add_f32 v[10:11], v[10:11], v[136:137]
    v_lshlrev_b32 v136, 16, v70
    v_and_b32 v137, 0xffff0000, v70
    v_pk_add_f32 v[12:13], v[12:13], v[136:137]
    v_lshlrev_b32 v136, 16, v71
    v_and_b32 v137, 0xffff0000, v71
    v_pk_add_f32 v[14:15], v[14:15], v[136:137]
    s_waitcnt vmcnt(4)
    v_lshlrev_b32 v136, 16, v72
    v_and_b32 v137, 0xffff0000, v72
    v_pk_add_f32 v[0:1], v[0:1], v[136:137]
    v_lshlrev_b32 v136, 16, v73
    v_and_b32 v137, 0xffff0000, v73
    v_pk_add_f32 v[2:3], v[2:3], v[136:137]
    v_lshlrev_b32 v136, 16, v74
    v_and_b32 v137, 0xffff0000, v74
    v_pk_add_f32 v[4:5], v[4:5], v[136:137]
    v_lshlrev_b32 v136, 16, v75
    v_and_b32 v137, 0xffff0000, v75
    v_pk_add_f32 v[6:7], v[6:7], v[136:137]
    v_lshlrev_b32 v136, 16, v76
    v_and_b32 v137, 0xffff0000, v76
    v_pk_add_f32 v[8:9], v[8:9], v[136:137]
    v_lshlrev_b32 v136, 16, v77
    v_and_b32 v137, 0xffff0000, v77
    v_pk_add_f32 v[10:11], v[10:11], v[136:137]
    v_lshlrev_b32 v136, 16, v78
    v_and_b32 v137, 0xffff0000, v78
    v_pk_add_f32 v[12:13], v[12:13], v[136:137]
    v_lshlrev_b32 v136, 16, v79
    v_and_b32 v137, 0xffff0000, v79
    v_pk_add_f32 v[14:15], v[14:15], v[136:137]
    s_waitcnt vmcnt(0)
    v_cvt_pk_bf16_f32 v136, v0, v1
    v_lshlrev_b32 v0, 16, v136
    v_and_b32 v1, 0xffff0000, v136
    v_lshlrev_b32 v137, 16, v128
    v_and_b32 v138, 0xffff0000, v128
    v_add_f32 v0, v0, v137
    v_add_f32 v1, v1, v138
    v_cvt_pk_bf16_f32 v136, v0, v1
    v_lshlrev_b32 v0, 16, v136
    v_and_b32 v1, 0xffff0000, v136
    v_mul_f32 v137, s41, v0
    v_mul_f32 v138, s41, v1
    v_exp_f32 v137, v137
    v_exp_f32 v138, v138
    s_nop 0
    v_add_f32 v137, 1.0, v137
    v_add_f32 v138, 1.0, v138
    v_rcp_f32 v137, v137
    v_rcp_f32 v138, v138
    s_nop 0
    v_mul_f32 v0, v0, v137
    v_mul_f32 v1, v1, v138
    v_cvt_pk_bf16_f32 v140, v0, v1
    v_cvt_pk_bf16_f32 v136, v2, v3
    v_lshlrev_b32 v2, 16, v136
    v_and_b32 v3, 0xffff0000, v136
    v_lshlrev_b32 v137, 16, v129
    v_and_b32 v138, 0xffff0000, v129
    v_add_f32 v2, v2, v137
    v_add_f32 v3, v3, v138
    v_cvt_pk_bf16_f32 v136, v2, v3
    v_lshlrev_b32 v2, 16, v136
    v_and_b32 v3, 0xffff0000, v136
    v_mul_f32 v137, s41, v2
    v_mul_f32 v138, s41, v3
    v_exp_f32 v137, v137
    v_exp_f32 v138, v138
    s_nop 0
    v_add_f32 v137, 1.0, v137
    v_add_f32 v138, 1.0, v138
    v_rcp_f32 v137, v137
    v_rcp_f32 v138, v138
    s_nop 0
    v_mul_f32 v2, v2, v137
    v_mul_f32 v3, v3, v138
    v_cvt_pk_bf16_f32 v141, v2, v3
    v_cvt_pk_bf16_f32 v136, v4, v5
    v_lshlrev_b32 v4, 16, v136
    v_and_b32 v5, 0xffff0000, v136
    v_lshlrev_b32 v137, 16, v130
    v_and_b32 v138, 0xffff0000, v130
    v_add_f32 v4, v4, v137
    v_add_f32 v5, v5, v138
    v_cvt_pk_bf16_f32 v136, v4, v5
    v_lshlrev_b32 v4, 16, v136
    v_and_b32 v5, 0xffff0000, v136
    v_mul_f32 v137, s41, v4
    v_mul_f32 v138, s41, v5
    v_exp_f32 v137, v137
    v_exp_f32 v138, v138
    s_nop 0
    v_add_f32 v137, 1.0, v137
    v_add_f32 v138, 1.0, v138
    v_rcp_f32 v137, v137
    v_rcp_f32 v138, v138
    s_nop 0
    v_mul_f32 v4, v4, v137
    v_mul_f32 v5, v5, v138
    v_cvt_pk_bf16_f32 v142, v4, v5
    v_cvt_pk_bf16_f32 v136, v6, v7
    v_lshlrev_b32 v6, 16, v136
    v_and_b32 v7, 0xffff0000, v136
    v_lshlrev_b32 v137, 16, v131
    v_and_b32 v138, 0xffff0000, v131
    v_add_f32 v6, v6, v137
    v_add_f32 v7, v7, v138
    v_cvt_pk_bf16_f32 v136, v6, v7
    v_lshlrev_b32 v6, 16, v136
    v_and_b32 v7, 0xffff0000, v136
    v_mul_f32 v137, s41, v6
    v_mul_f32 v138, s41, v7
    v_exp_f32 v137, v137
    v_exp_f32 v138, v138
    s_nop 0
    v_add_f32 v137, 1.0, v137
    v_add_f32 v138, 1.0, v138
    v_rcp_f32 v137, v137
    v_rcp_f32 v138, v138
    s_nop 0
    v_mul_f32 v6, v6, v137
    v_mul_f32 v7, v7, v138
    v_cvt_pk_bf16_f32 v143, v6, v7
    v_cvt_pk_bf16_f32 v136, v8, v9
    v_lshlrev_b32 v8, 16, v136
    v_and_b32 v9, 0xffff0000, v136
    v_lshlrev_b32 v137, 16, v132
    v_and_b32 v138, 0xffff0000, v132
    v_add_f32 v8, v8, v137
    v_add_f32 v9, v9, v138
    v_cvt_pk_bf16_f32 v136, v8, v9
    v_lshlrev_b32 v8, 16, v136
    v_and_b32 v9, 0xffff0000, v136
    v_mul_f32 v137, s41, v8
    v_mul_f32 v138, s41, v9
    v_exp_f32 v137, v137
    v_exp_f32 v138, v138
    s_nop 0
    v_add_f32 v137, 1.0, v137
    v_add_f32 v138, 1.0, v138
    v_rcp_f32 v137, v137
    v_rcp_f32 v138, v138
    s_nop 0
    v_mul_f32 v8, v8, v137
    v_mul_f32 v9, v9, v138
    v_cvt_pk_bf16_f32 v144, v8, v9
    v_cvt_pk_bf16_f32 v136, v10, v11
    v_lshlrev_b32 v10, 16, v136
    v_and_b32 v11, 0xffff0000, v136
    v_lshlrev_b32 v137, 16, v133
    v_and_b32 v138, 0xffff0000, v133
    v_add_f32 v10, v10, v137
    v_add_f32 v11, v11, v138
    v_cvt_pk_bf16_f32 v136, v10, v11
    v_lshlrev_b32 v10, 16, v136
    v_and_b32 v11, 0xffff0000, v136
    v_mul_f32 v137, s41, v10
    v_mul_f32 v138, s41, v11
    v_exp_f32 v137, v137
    v_exp_f32 v138, v138
    s_nop 0
    v_add_f32 v137, 1.0, v137
    v_add_f32 v138, 1.0, v138
    v_rcp_f32 v137, v137
    v_rcp_f32 v138, v138
    s_nop 0
    v_mul_f32 v10, v10, v137
    v_mul_f32 v11, v11, v138
    v_cvt_pk_bf16_f32 v145, v10, v11
    v_cvt_pk_bf16_f32 v136, v12, v13
    v_lshlrev_b32 v12, 16, v136
    v_and_b32 v13, 0xffff0000, v136
    v_lshlrev_b32 v137, 16, v134
    v_and_b32 v138, 0xffff0000, v134
    v_add_f32 v12, v12, v137
    v_add_f32 v13, v13, v138
    v_cvt_pk_bf16_f32 v136, v12, v13
    v_lshlrev_b32 v12, 16, v136
    v_and_b32 v13, 0xffff0000, v136
    v_mul_f32 v137, s41, v12
    v_mul_f32 v138, s41, v13
    v_exp_f32 v137, v137
    v_exp_f32 v138, v138
    s_nop 0
    v_add_f32 v137, 1.0, v137
    v_add_f32 v138, 1.0, v138
    v_rcp_f32 v137, v137
    v_rcp_f32 v138, v138
    s_nop 0
    v_mul_f32 v12, v12, v137
    v_mul_f32 v13, v13, v138
    v_cvt_pk_bf16_f32 v146, v12, v13
    v_cvt_pk_bf16_f32 v136, v14, v15
    v_lshlrev_b32 v14, 16, v136
    v_and_b32 v15, 0xffff0000, v136
    v_lshlrev_b32 v137, 16, v135
    v_and_b32 v138, 0xffff0000, v135
    v_add_f32 v14, v14, v137
    v_add_f32 v15, v15, v138
    v_cvt_pk_bf16_f32 v136, v14, v15
    v_lshlrev_b32 v14, 16, v136
    v_and_b32 v15, 0xffff0000, v136
    v_mul_f32 v137, s41, v14
    v_mul_f32 v138, s41, v15
    v_exp_f32 v137, v137
    v_exp_f32 v138, v138
    s_nop 0
    v_add_f32 v137, 1.0, v137
    v_add_f32 v138, 1.0, v138
    v_rcp_f32 v137, v137
    v_rcp_f32 v138, v138
    s_nop 0
    v_mul_f32 v14, v14, v137
    v_mul_f32 v15, v15, v138
    v_cvt_pk_bf16_f32 v147, v14, v15
    buffer_store_dwordx4 v[140:143], v254, s[12:15], s23 offen sc1
    buffer_store_dwordx4 v[144:147], v254, s[12:15], s23 offen offset:1024 sc1
    s_add_u32 s28, s28, 8
    s_cmp_lt_u32 s28, 20
    s_cbranch_scc1 GI_gl
    s_mov_b32 s19, 4
    s_waitcnt vmcnt(0)
    s_barrier
    s_cmp_lg_u32 s17, 0
    s_cbranch_scc1 PFL_101
    s_lshl_b32 s40, s16, 7
    s_lshl_b32 s41, s19, 2
    s_add_u32 s40, s40, s41
    s_add_u32 s40, s40, 3620864
    v_mov_b32 v1, s40
    v_mov_b32 v2, 1
    buffer_store_dword v2, v1, s[12:15], s93 offen sc1
PFL_101:
    s_branch MAIN_ploop
MAIN_zi:
    s_sub_u32 s19, s19, 5
    s_cmp_lg_u32 s17, 0
    s_cbranch_scc1 MAIN_zgo
    v_and_b32 v220, 3, v255
    v_lshlrev_b32 v220, 7, v220
    s_add_u32 s42, s93, 3609600
    s_add_u32 s43, s16, 0
MAIN_wzc0:
    buffer_load_dword v221, v220, s[12:15], s42 offen sc1
    s_sub_u32 s46, s46, 1
    s_cbranch_scc1 MAIN_wzc0_x
    s_waitcnt vmcnt(0)
    v_mov_b32 v222, v221
    v_cmp_ge_u32 vcc, s43, v222
    s_cbranch_vccz MAIN_wzc0_ok
    s_sleep 16
    s_branch MAIN_wzc0
MAIN_wzc0_x:
    s_mov_b32 s46, 0
    s_waitcnt vmcnt(0)
MAIN_wzc0_ok:
MAIN_zgo:
    s_barrier
    v_lshlrev_b32 v254, 4, v255
    v_lshrrev_b32 v253, 5, v255
    v_and_b32 v252, 31, v255
    v_lshlrev_b32 v250, 3, v255
    s_load_dwordx2 s[8:9], s[0:1], 0
    s_load_dwordx2 s[36:37], s[0:1], 96
    s_and_b32 s28, s17, 1
    s_lshl_b32 s40, s19, 1
    s_add_u32 s28, s28, s40
    s_lshr_b32 s29, s17, 1
    s_lshl_b32 s20, s29, 3
    s_mul_i32 s21, s16, 1310720
    s_mul_i32 s40, s20, 40960
    s_add_u32 s21, s21, s40
    s_lshl_b32 s40, s28, 11
    s_add_u32 s21, s21, s40
    s_add_u32 s21, s21, 91226112
    s_mul_i32 s22, s16, 327680
    s_mul_i32 s40, s20, 10240
    s_add_u32 s22, s22, s40
    s_lshl_b32 s40, s28, 9
    s_add_u32 s22, s22, s40
    s_add_u32 s22, s22, 202801152
    s_mul_i32 s24, s16, 81920
    s_mul_i32 s40, s20, 2560
    s_add_u32 s24, s24, s40
    s_add_u32 s24, s24, 223772672
    v_mov_b32 v26, 0
    v_mov_b32 v27, 0
    v_mov_b32 v38, 0
    v_mov_b32 v39, 0
    buffer_load_dwordx4 v[16:19], v254, s[12:15], s21 offen
    buffer_load_dwordx4 v[20:23], v254, s[12:15], s21 offen offset:1024
    s_add_u32 s21, s21, 40960
    v_mov_b32 v50, 0
    v_mov_b32 v51, 0
    v_mov_b32 v62, 0
    v_mov_b32 v63, 0
    buffer_load_dwordx4 v[40:43], v254, s[12:15], s21 offen
    buffer_load_dwordx4 v[44:47], v254, s[12:15], s21 offen offset:1024
    s_add_u32 s21, s21, 40960
    v_mov_b32 v74, 0
    v_mov_b32 v75, 0
    v_mov_b32 v86, 0
    v_mov_b32 v87, 0
    buffer_load_dwordx4 v[64:67], v254, s[12:15], s21 offen
    buffer_load_dwordx4 v[68:71], v254, s[12:15], s21 offen offset:1024
    s_add_u32 s21, s21, 40960
    v_mov_b32 v98, 0
    v_mov_b32 v99, 0
    v_mov_b32 v110, 0
    v_mov_b32 v111, 0
    buffer_load_dwordx4 v[88:91], v254, s[12:15], s21 offen
    buffer_load_dwordx4 v[92:95], v254, s[12:15], s21 offen offset:1024
    s_add_u32 s21, s21, 40960
    v_mov_b32 v122, 0
    v_mov_b32 v123, 0
    v_mov_b32 v134, 0
    v_mov_b32 v135, 0
    buffer_load_dwordx4 v[112:115], v254, s[12:15], s21 offen
    buffer_load_dwordx4 v[116:119], v254, s[12:15], s21 offen offset:1024
    s_add_u32 s21, s21, 40960
    v_mov_b32 v146, 0
    v_mov_b32 v147, 0
    v_mov_b32 v158, 0
    v_mov_b32 v159, 0
    buffer_load_dwordx4 v[136:139], v254, s[12:15], s21 offen
    buffer_load_dwordx4 v[140:143], v254, s[12:15], s21 offen offset:1024
    s_add_u32 s21, s21, 40960
    v_mov_b32 v170, 0
    v_mov_b32 v171, 0
    v_mov_b32 v182, 0
    v_mov_b32 v183, 0
    buffer_load_dwordx4 v[160:163], v254, s[12:15], s21 offen
    buffer_load_dwordx4 v[164:167], v254, s[12:15], s21 offen offset:1024
    s_add_u32 s21, s21, 40960
    v_mov_b32 v194, 0
    v_mov_b32 v195, 0
    v_mov_b32 v206, 0
    v_mov_b32 v207, 0
    buffer_load_dwordx4 v[184:187], v254, s[12:15], s21 offen
    buffer_load_dwordx4 v[188:191], v254, s[12:15], s21 offen offset:1024
    s_add_u32 s21, s21, 40960
    s_cmp_lg_u32 s17, 0
    s_cbranch_scc1 MAIN_zgo2
    v_and_b32 v220, 3, v255
    v_lshlrev_b32 v220, 7, v220
    s_add_u32 s42, s93, 3609600
    s_add_u32 s43, s16, 2
MAIN_wzc:
    buffer_load_dword v221, v220, s[12:15], s42 offen sc1
    s_sub_u32 s46, s46, 1
    s_cbranch_scc1 MAIN_wzc_x
    s_waitcnt vmcnt(0)
    v_mov_b32 v222, v221
    v_cmp_ge_u32 vcc, s43, v222
    s_cbranch_vccz MAIN_wzc_ok
    s_sleep 16
    s_branch MAIN_wzc
MAIN_wzc_x:
    s_mov_b32 s46, 0
    s_waitcnt vmcnt(0)
MAIN_wzc_ok:
    v_min_u32 v220, 4, v255
    v_lshlrev_b32 v220, 2, v220
    s_lshl_b32 s42, s16, 7
    s_add_u32 s42, s42, 3620864
    s_add_u32 s42, s42, s93
    s_mov_b32 s43, 0
MAIN_wz:
    buffer_load_dword v221, v220, s[12:15], s42 offen sc1
    s_sub_u32 s46, s46, 1
    s_cbranch_scc1 MAIN_wz_x
    s_waitcnt vmcnt(0)
    v_mov_b32 v222, v221
    v_cmp_ge_u32 vcc, s43, v222
    s_cbranch_vccz MAIN_wz_ok
    s_sleep 4
    s_branch MAIN_wz
MAIN_wz_x:
    s_mov_b32 s46, 0
    s_waitcnt vmcnt(0)
MAIN_wz_ok:
MAIN_zgo2:
    s_barrier
    buffer_load_dwordx2 v[24:25], v250, s[12:15], s22 offen
    buffer_load_dwordx4 v[28:31], v254, s[12:15], s24 offen
    buffer_load_dwordx4 v[32:35], v254, s[12:15], s24 offen offset:1024
    buffer_load_dwordx2 v[36:37], v250, s[12:15], s24 offen offset:2048
    s_add_u32 s22, s22, 10240
    s_add_u32 s24, s24, 2560
    buffer_load_dwordx2 v[48:49], v250, s[12:15], s22 offen
    buffer_load_dwordx4 v[52:55], v254, s[12:15], s24 offen
    buffer_load_dwordx4 v[56:59], v254, s[12:15], s24 offen offset:1024
    buffer_load_dwordx2 v[60:61], v250, s[12:15], s24 offen offset:2048
    s_add_u32 s22, s22, 10240
    s_add_u32 s24, s24, 2560
    buffer_load_dwordx2 v[72:73], v250, s[12:15], s22 offen
    buffer_load_dwordx4 v[76:79], v254, s[12:15], s24 offen
    buffer_load_dwordx4 v[80:83], v254, s[12:15], s24 offen offset:1024
    buffer_load_dwordx2 v[84:85], v250, s[12:15], s24 offen offset:2048
    s_add_u32 s22, s22, 10240
    s_add_u32 s24, s24, 2560
    buffer_load_dwordx2 v[96:97], v250, s[12:15], s22 offen
    buffer_load_dwordx4 v[100:103], v254, s[12:15], s24 offen
    buffer_load_dwordx4 v[104:107], v254, s[12:15], s24 offen offset:1024
    buffer_load_dwordx2 v[108:109], v250, s[12:15], s24 offen offset:2048
    s_add_u32 s22, s22, 10240
    s_add_u32 s24, s24, 2560
    buffer_load_dwordx2 v[120:121], v250, s[12:15], s22 offen
    buffer_load_dwordx4 v[124:127], v254, s[12:15], s24 offen
    buffer_load_dwordx4 v[128:131], v254, s[12:15], s24 offen offset:1024
    buffer_load_dwordx2 v[132:133], v250, s[12:15], s24 offen offset:2048
    s_add_u32 s22, s22, 10240
    s_add_u32 s24, s24, 2560
    buffer_load_dwordx2 v[144:145], v250, s[12:15], s22 offen
    buffer_load_dwordx4 v[148:151], v254, s[12:15], s24 offen
    buffer_load_dwordx4 v[152:155], v254, s[12:15], s24 offen offset:1024
    buffer_load_dwordx2 v[156:157], v250, s[12:15], s24 offen offset:2048
    s_add_u32 s22, s22, 10240
    s_add_u32 s24, s24, 2560
    buffer_load_dwordx2 v[168:169], v250, s[12:15], s22 offen
    buffer_load_dwordx4 v[172:175], v254, s[12:15], s24 offen
    buffer_load_dwordx4 v[176:179], v254, s[12:15], s24 offen offset:1024
    buffer_load_dwordx2 v[180:181], v250, s[12:15], s24 offen offset:2048
    s_add_u32 s22, s22, 10240
    s_add_u32 s24, s24, 2560
    buffer_load_dwordx2 v[192:193], v250, s[12:15], s22 offen
    buffer_load_dwordx4 v[196:199], v254, s[12:15], s24 offen
    buffer_load_dwordx4 v[200:203], v254, s[12:15], s24 offen offset:1024
    buffer_load_dwordx2 v[204:205], v250, s[12:15], s24 offen offset:2048
    s_add_u32 s22, s22, 10240
    s_add_u32 s24, s24, 2560
    s_waitcnt lgkmcnt(0)
    s_mov_b32 s10, 2621440
    s_mov_b32 s11, 0x00020000
    s_mov_b32 s38, 2621440
    s_mov_b32 s39, 0x00020000
    s_lshl_b32 s40, s16, 5
    v_add_u32 v243, s40, v252
    v_mul_u32_u24 v243, 1280, v243
    v_lshl_add_u32 v243, v253, 3, v243
    s_lshl_b32 s22, s28, 6
    s_lshl_b32 s40, s29, 4
    s_add_u32 s22, s22, s40
    s_mul_i32 s23, s16, 40960
    s_lshl_b32 s40, s28, 11
    s_add_u32 s23, s23, s40
    s_lshr_b32 s40, s29, 1
    s_lshl_b32 s40, s40, 10
    s_add_u32 s23, s23, s40
    s_and_b32 s40, s29, 1
    s_lshl_b32 s40, s40, 3
    s_add_u32 s23, s23, s40
    s_add_u32 s23, s23, 229015552
    buffer_load_dwordx2 v[216:217], v243, s[8:11], s22 offen
    buffer_load_dwordx2 v[218:219], v254, s[12:15], s23 offen
    s_lshl_b32 s40, s17, 12
    v_add_u32 v245, s40, v254
    s_and_b32 s40, s17, 1
    s_lshl_b32 s40, s40, 12
    s_lshl_b32 s41, s29, 10
    s_add_u32 s40, s40, s41
    v_add_u32 v244, s40, v254
    s_waitcnt vmcnt(30)
    v_mfma_f32_32x32x16_bf16 v[0:15], v[16:19], v[28:31], 0
    v_mfma_f32_32x32x16_bf16 v[0:15], v[20:23], v[32:35], v[0:15]
    v_mfma_f32_32x32x16_bf16 v[0:15], v[24:27], v[36:39], v[0:15]
    s_waitcnt vmcnt(26)
    v_mfma_f32_32x32x16_bf16 v[0:15], v[40:43], v[52:55], v[0:15]
    v_mfma_f32_32x32x16_bf16 v[0:15], v[44:47], v[56:59], v[0:15]
    v_mfma_f32_32x32x16_bf16 v[0:15], v[48:51], v[60:63], v[0:15]
    s_waitcnt vmcnt(22)
    v_mfma_f32_32x32x16_bf16 v[0:15], v[64:67], v[76:79], v[0:15]
    v_mfma_f32_32x32x16_bf16 v[0:15], v[68:71], v[80:83], v[0:15]
    v_mfma_f32_32x32x16_bf16 v[0:15], v[72:75], v[84:87], v[0:15]
    s_waitcnt vmcnt(18)
    v_mfma_f32_32x32x16_bf16 v[0:15], v[88:91], v[100:103], v[0:15]
    v_mfma_f32_32x32x16_bf16 v[0:15], v[92:95], v[104:107], v[0:15]
    v_mfma_f32_32x32x16_bf16 v[0:15], v[96:99], v[108:111], v[0:15]
    s_waitcnt vmcnt(14)
    v_mfma_f32_32x32x16_bf16 v[0:15], v[112:115], v[124:127], v[0:15]
    v_mfma_f32_32x32x16_bf16 v[0:15], v[116:119], v[128:131], v[0:15]
    v_mfma_f32_32x32x16_bf16 v[0:15], v[120:123], v[132:135], v[0:15]
    s_waitcnt vmcnt(10)
    v_mfma_f32_32x32x16_bf16 v[0:15], v[136:139], v[148:151], v[0:15]
    v_mfma_f32_32x32x16_bf16 v[0:15], v[140:143], v[152:155], v[0:15]
    v_mfma_f32_32x32x16_bf16 v[0:15], v[144:147], v[156:159], v[0:15]
    s_waitcnt vmcnt(6)
    v_mfma_f32_32x32x16_bf16 v[0:15], v[160:163], v[172:175], v[0:15]
    v_mfma_f32_32x32x16_bf16 v[0:15], v[164:167], v[176:179], v[0:15]
    v_mfma_f32_32x32x16_bf16 v[0:15], v[168:171], v[180:183], v[0:15]
    s_waitcnt vmcnt(2)
    v_mfma_f32_32x32x16_bf16 v[0:15], v[184:187], v[196:199], v[0:15]
    v_mfma_f32_32x32x16_bf16 v[0:15], v[188:191], v[200:203], v[0:15]
    v_mfma_f32_32x32x16_bf16 v[0:15], v[192:195], v[204:207], v[0:15]
    s_nop 11
    ds_write_b128 v245, v[0:3] offset:0
    ds_write_b128 v245, v[4:7] offset:1024
    ds_write_b128 v245, v[8:11] offset:2048
    ds_write_b128 v245, v[12:15] offset:3072
    s_waitcnt lgkmcnt(0)
    s_barrier
    ds_read_b128 v[16:19], v244 offset:0
    ds_read_b128 v[20:23], v244 offset:8192
    ds_read_b128 v[24:27], v244 offset:16384
    ds_read_b128 v[28:31], v244 offset:24576
    s_waitcnt lgkmcnt(0) vmcnt(0)
    v_pk_add_f32 v[16:17], v[16:17], v[20:21]
    v_pk_add_f32 v[18:19], v[18:19], v[22:23]
    v_pk_add_f32 v[24:25], v[24:25], v[28:29]
    v_pk_add_f32 v[26:27], v[26:27], v[30:31]
    v_pk_add_f32 v[16:17], v[16:17], v[24:25]
    v_pk_add_f32 v[18:19], v[18:19], v[26:27]
    v_cvt_pk_bf16_f32 v40, v16, v17
    v_lshlrev_b32 v16, 16, v40
    v_and_b32 v17, 0xffff0000, v40
    v_lshlrev_b32 v41, 16, v218
    v_and_b32 v42, 0xffff0000, v218
    v_mul_f32 v16, v16, v41
    v_mul_f32 v17, v17, v42
    v_cvt_pk_bf16_f32 v40, v16, v17
    v_lshlrev_b32 v16, 16, v40
    v_and_b32 v17, 0xffff0000, v40
    v_lshlrev_b32 v41, 16, v216
    v_and_b32 v42, 0xffff0000, v216
    v_add_f32 v16, v16, v41
    v_add_f32 v17, v17, v42
    v_cvt_pk_bf16_f32 v44, v16, v17
    v_cvt_pk_bf16_f32 v40, v18, v19
    v_lshlrev_b32 v18, 16, v40
    v_and_b32 v19, 0xffff0000, v40
    v_lshlrev_b32 v41, 16, v219
    v_and_b32 v42, 0xffff0000, v219
    v_mul_f32 v18, v18, v41
    v_mul_f32 v19, v19, v42
    v_cvt_pk_bf16_f32 v40, v18, v19
    v_lshlrev_b32 v18, 16, v40
    v_and_b32 v19, 0xffff0000, v40
    v_lshlrev_b32 v41, 16, v217
    v_and_b32 v42, 0xffff0000, v217
    v_add_f32 v18, v18, v41
    v_add_f32 v19, v19, v42
    v_cvt_pk_bf16_f32 v45, v18, v19
    buffer_store_dwordx2 v[44:45], v243, s[36:39], s22 offen
    s_branch MAIN_ploop
MAIN_end:
    s_endpgm
.section .rodata,"a"
.p2align 6
.amdhsa_kernel main_kernel
  .amdhsa_next_free_vgpr 256
  .amdhsa_next_free_sgpr 102
  .amdhsa_accum_offset 256
  .amdhsa_group_segment_fixed_size 0
  .amdhsa_kernarg_size 120
  .amdhsa_user_sgpr_count 2
  .amdhsa_user_sgpr_kernarg_segment_ptr 1
  .amdhsa_system_sgpr_workgroup_id_x 1
.end_amdhsa_kernel
```
